```python
import torch

def _softmax(x, axis=-1):
    return torch.softmax(x, dim=axis)
def _gelu(x):
    return torch.nn.functional.gelu(x, approximate="tanh")
def _silu(x):
    return torch.nn.functional.silu(x)
def _sigmoid(x):
    return torch.sigmoid(x)
def _layernorm(x, axis=-1, eps=1e-5):
    m = x.mean(dim=axis, keepdim=True)
    v = x.var(dim=axis, keepdim=True, unbiased=False)
    return (x - m) / torch.sqrt(v + eps)
def _scatter_add(tgt, idx, src, axis=0):
    return tgt.clone().index_add_(axis, idx, src)
def _segment_sum(src, seg, n):
    out = torch.zeros((n,) + src.shape[1:], dtype=src.dtype)
    return out.index_add_(0, seg, src)
def _pad(x, pw):
    flat = tuple(v for pair in reversed(pw) for v in pair)
    return torch.nn.functional.pad(x, flat)

kernel_name = 'concat_heads__sliding_block__grouped_kv_mqa__prompt'

def setup_inputs():

    _w = (lambda a: (lambda t: t.to(torch.bfloat16) if t.is_floating_point() else t)(torch.as_tensor(a)))
    def _A_setup():
        B, S, D = 1, 2048, 1024
        return {
            "x": _w((lambda *s: torch.randn(*s, dtype=torch.bfloat16) * 0.2)(B, S, D)),
            "wqkv": _w((lambda *s: torch.randn(*s, dtype=torch.bfloat16) * 0.2)(D, 3 * D)),
            "wo": _w((lambda *s: torch.randn(*s, dtype=torch.bfloat16) * 0.05)(D, D)),
        }
    _A_in = _A_setup()

    def _B_setup():
        B, S, D, H = 1, 2048, 1024, 32
        Dh = D // H
        return {
            "x": _w((lambda *s: torch.randn(*s, dtype=torch.bfloat16) * 0.05)(B, S, D)),
            "wq": _w((lambda *s: torch.randn(*s, dtype=torch.bfloat16) * 0.8)(D, H * Dh)),
            "wk": _w((lambda *s: torch.randn(*s, dtype=torch.bfloat16) * 0.8)(D, Dh)),
            "wv": _w((lambda *s: torch.randn(*s, dtype=torch.bfloat16) * 0.2)(D, Dh)),
            "wo": _w((lambda *s: torch.randn(*s, dtype=torch.bfloat16) * 0.2)(H * Dh, D)),
        }
    _B_in = _B_setup()

    return {
        "A_x": _A_in["x"],
        "A_wqkv": _A_in["wqkv"],
        "A_wo": _A_in["wo"],
        "B_x": _B_in["x"],
        "B_wq": _B_in["wq"],
        "B_wk": _B_in["wk"],
        "B_wv": _B_in["wv"],
        "B_wo": _B_in["wo"],
    }

def reference(A_x, A_wqkv, A_wo, B_x, B_wq, B_wk, B_wv, B_wo):
    def _A_ref(x, wqkv, wo):
        B, S, D = x.shape
        H = 32; Dh = D // H; W = 256
        qkv = (lambda x, *d: x.permute(*d))((x @ wqkv).reshape(B, S, 3, H, Dh), 2, 0, 3, 1, 4)
        q, k, v = qkv[0], qkv[1], qkv[2]
        scores = torch.einsum("bhqd,bhkd->bhqk", q, k) * (Dh ** -0.5)
        idx = torch.arange(S)
        mask = (idx[:, None] - idx[None, :] >= 0) & (idx[:, None] - idx[None, :] < W)
        scores = torch.where(mask[None, None], scores, -1e9)
        p = _softmax(scores, axis=-1)
        o = torch.einsum("bhqk,bhkd->bhqd", p, v)
        return (lambda x, *d: x.permute(*d))(o, 0, 2, 1, 3).reshape(B, S, D) @ wo

    def _B_ref(x, wq, wk, wv, wo):
        B, S, D = x.shape
        H = 32
        Dh = D // H
        q = (lambda x, *d: x.permute(*d))((x @ wq).reshape(B, S, H, Dh), 0, 2, 1, 3)
        k = x @ wk
        v = x @ wv
        scores = torch.einsum("bhqd,bkd->bhqk", q, k) * (Dh ** -0.5)
        p = _softmax(scores, axis=-1)
        o = torch.einsum("bhqk,bkd->bhqd", p, v)
        return (lambda x, *d: x.permute(*d))(o, 0, 2, 1, 3).reshape(B, S, H * Dh) @ wo

    a = _A_ref(A_x, A_wqkv, A_wo)
    b = _B_ref(B_x, B_wq, B_wk, B_wv, B_wo)
    return torch.concatenate([a, b], axis=-1)
```

```asm
; @launch kernel=p1_kernel grid=(256,1,1) block=(512,1,1) lds=159744
; @launch kernel=p2_kernel grid=(256,1,1) block=(512,1,1) lds=147456
; @launch kernel=concat_heads__sliding_block__grouped_kv_mqa__prompt_kernel grid=(256,1,1) block=(512,1,1) lds=131072
.amdgcn_target "amdgcn-amd-amdhsa--gfx950"
.text
  .globl p1_kernel
  .p2align 8
  .type p1_kernel,@function
p1_kernel:
  s_cmp_ge_u32 s2, 256
  s_cbranch_scc1 p1_exit
  v_lshrrev_b32 v1, 6, v0
  v_and_b32 v0, 63, v0
  s_and_b32 s7, s2, 7
  v_readfirstlane_b32 s3, v1
  s_lshr_b32 s4, s7, 1
  s_and_b32 s7, s7, 1
  s_lshl_b32 s7, s7, 3
  s_lshr_b32 s6, s2, 3
  s_and_b32 s5, s6, 7
  s_add_u32 s5, s5, s7
  s_lshr_b32 s6, s6, 3
  s_lshl_b32 s4, s4, 1
  s_lshr_b32 s4, 99, s4
  s_and_b32 s4, s4, 3
  s_load_dwordx2 s[20:21], s[0:1], 80
  s_cmp_eq_u32 s4, 3
  s_cbranch_scc1 p1_isB
  s_load_dwordx2 s[8:9], s[0:1], 0
  s_load_dwordx2 s[12:13], s[0:1], 8
  s_load_dwordx2 s[16:17], s[0:1], 8
  s_load_dwordx2 s[60:61], s[0:1], 24
  s_load_dwordx2 s[62:63], s[0:1], 32
  s_mov_b32 s14, 0x600000
  s_mov_b32 s18, 0
  s_branch p1_ptrs
p1_isB:
  s_load_dwordx2 s[8:9], s[0:1], 24
  s_load_dwordx2 s[12:13], s[0:1], 32
  s_mov_b32 s14, 0x200000
  s_mov_b32 s18, 0x10000
  s_bitcmp1_b32 s6, 0
  s_cbranch_scc1 p1_isBV
  s_load_dwordx2 s[16:17], s[0:1], 40
  s_branch p1_ptrs
p1_isBV:
  s_load_dwordx2 s[16:17], s[0:1], 48
p1_ptrs:
  s_mov_b32 s10, 0x400000
  s_mov_b32 s11, 0x20000
  s_mov_b32 s15, 0x20000
  s_mov_b32 s19, 0x20000
  s_mov_b32 s22, 0x2000000
  s_mov_b32 s23, 0x20000
  s_cmp_ge_u32 s3, 4
  s_cbranch_scc0 p1_compute
p1_loader:
  s_sub_u32 s24, s3, 4
  s_and_b32 s25, s24, 1
  v_lshrrev_b32 v4, 4, v0
  s_lshl_b32 s7, s25, 2
  v_add_u32 v4, s7, v4
  v_and_b32 v4, 7, v4
  v_and_b32 v5, 7, v0
  v_xor_b32 v4, v4, v5
  v_lshlrev_b32 v4, 4, v4
  v_lshrrev_b32 v5, 3, v0
  v_lshl_add_u32 v1, v5, 11, v4
  s_lshl_b32 s7, s5, 7
  s_lshl_b32 s26, s24, 3
  s_add_u32 s7, s7, s26
  s_lshl_b32 s7, s7, 11
  v_add_u32 v1, s7, v1
  v_lshrrev_b32 v5, 3, v0
  v_lshrrev_b32 v4, 4, v0
  v_and_b32 v4, 1, v4
  v_lshlrev_b32 v4, 1, v4
  v_and_b32 v6, 7, v0
  v_xor_b32 v4, v4, v6
  v_lshlrev_b32 v4, 4, v4
  s_lshl_b32 s7, s24, 7
  v_add_u32 v4, s7, v4
  v_lshlrev_b32 v3, 4, v0
  s_lshl_b32 s7, s24, 10
  v_add_u32 v3, s7, v3
  s_lshl_b32 s40, s24, 10
  s_mov_b32 s41, 0
  s_cmp_eq_u32 s4, 3
  s_cbranch_scc0 p1_loadA
  v_lshlrev_b32 v5, 11, v5
  v_add_u32 v2, v4, v5
  s_lshl_b32 s7, s6, 9
  v_add_u32 v2, s7, v2
  v_xor_b32 v12, 64, v2
  s_mov_b32 s42, s40
  s_lshr_b32 s7, s2, 3
  s_and_b32 s26, s2, 1
  s_lshl_b32 s26, s26, 10
  s_lshl_b32 s27, s7, 5
  s_add_u32 s26, s26, s27
  s_and_b32 s27, s24, 1
  s_lshl_b32 s28, s27, 4
  s_add_u32 s26, s26, s28
  s_lshl_b32 s26, s26, 11
  s_lshl_b32 s7, s7, 1
  s_add_u32 s7, s7, s27
  s_mul_i32 s7, s7, 2048
  v_lshrrev_b32 v6, 2, v0
  v_lshlrev_b32 v6, 11, v6
  v_and_b32 v7, 3, v0
  v_lshl_add_u32 v6, v7, 5, v6
  v_add_u32 v6, s26, v6
  v_lshlrev_b32 v7, 5, v0
  v_add_u32 v7, s7, v7
  s_mov_b32 s48, 128
  s_cmp_ge_u32 s24, 2
  s_cselect_b64 vcc, -1, 0
  s_cselect_b32 s48, 131072, s48
  v_cndmask_b32 v6, v6, v7, vcc
  s_waitcnt lgkmcnt(0)
  s_cmp_ge_u32 s24, 2
  s_cselect_b32 s52, s12, s8
  s_cselect_b32 s53, s13, s9
  s_cselect_b32 s54, s14, s10
  s_mov_b32 s55, 0x20000
  s_lshl_b32 s43, s41, 7
  s_mul_i32 s44, s41, 131072
  s_lshl_b32 s46, s41, 12
  s_add_u32 m0, s42, 0
  s_add_u32 s45, s43, 0
  buffer_load_dwordx4 v1, s[8:11], s45 offen lds
  s_add_u32 m0, s42, 16384
  s_add_u32 s45, s44, 0
  buffer_load_dwordx4 v2, s[12:15], s45 offen lds
  s_add_u32 m0, s42, 20480
  s_add_u32 s45, s44, 16384
  buffer_load_dwordx4 v12, s[12:15], s45 offen lds
  s_add_u32 m0, s42, 4096
  s_add_u32 s45, s43, 65536
  buffer_load_dwordx4 v1, s[8:11], s45 offen lds
  s_add_u32 m0, s42, 24576
  s_add_u32 s45, s44, 32768
  buffer_load_dwordx4 v2, s[12:15], s45 offen lds
  s_add_u32 m0, s42, 28672
  s_add_u32 s45, s44, 49152
  buffer_load_dwordx4 v12, s[12:15], s45 offen lds
  s_add_u32 m0, s42, 8192
  s_add_u32 s45, s43, 131072
  buffer_load_dwordx4 v1, s[8:11], s45 offen lds
  s_add_u32 m0, s42, 32768
  s_add_u32 s45, s44, 65536
  buffer_load_dwordx4 v2, s[12:15], s45 offen lds
  s_add_u32 m0, s42, 36864
  s_add_u32 s45, s44, 81920
  buffer_load_dwordx4 v12, s[12:15], s45 offen lds
  s_add_u32 m0, s42, 12288
  s_add_u32 s45, s43, 196608
  buffer_load_dwordx4 v1, s[8:11], s45 offen lds
  s_add_u32 m0, s42, 40960
  s_add_u32 s45, s44, 98304
  buffer_load_dwordx4 v2, s[12:15], s45 offen lds
  s_add_u32 m0, s42, 45056
  s_add_u32 s45, s44, 114688
  buffer_load_dwordx4 v12, s[12:15], s45 offen lds
  s_add_u32 m0, s42, 49152
  s_nop 0
  buffer_load_dwordx4 v3, s[16:19], s46 offen lds
  s_add_u32 s41, s41, 1
  s_and_b32 s41, s41, 15
  s_add_u32 s42, s42, 53248
  s_cmp_ge_u32 s42, 159744
  s_cselect_b32 s42, s40, s42
  s_mul_i32 s7, s48, 2
  buffer_load_dword v24, v6, s[52:55], s7 offen
  s_mul_i32 s7, s48, 3
  buffer_load_dword v25, v6, s[52:55], s7 offen
  s_lshr_b32 s7, s2, 3
  s_lshr_b32 s26, s7, 4
  s_lshl_b32 s26, s26, 3
  s_and_b32 s7, s7, 7
  s_add_u32 s7, s7, s26
  s_lshl_b32 s7, s7, 12
  buffer_load_dword v9, v3, s[16:19], s7 offen
  s_lshl_b32 s43, s41, 7
  s_mul_i32 s44, s41, 131072
  s_lshl_b32 s46, s41, 12
  s_add_u32 m0, s42, 0
  s_add_u32 s45, s43, 0
  buffer_load_dwordx4 v1, s[8:11], s45 offen lds
  s_add_u32 m0, s42, 16384
  s_add_u32 s45, s44, 0
  buffer_load_dwordx4 v2, s[12:15], s45 offen lds
  s_add_u32 m0, s42, 20480
  s_add_u32 s45, s44, 16384
  buffer_load_dwordx4 v12, s[12:15], s45 offen lds
  s_add_u32 m0, s42, 4096
  s_add_u32 s45, s43, 65536
  buffer_load_dwordx4 v1, s[8:11], s45 offen lds
  s_waitcnt vmcnt(7)
  s_barrier
  s_add_u32 m0, s42, 24576
  s_add_u32 s45, s44, 32768
  buffer_load_dwordx4 v2, s[12:15], s45 offen lds
  s_add_u32 m0, s42, 28672
  s_add_u32 s45, s44, 49152
  buffer_load_dwordx4 v12, s[12:15], s45 offen lds
  s_add_u32 m0, s42, 8192
  s_add_u32 s45, s43, 131072
  buffer_load_dwordx4 v1, s[8:11], s45 offen lds
  s_add_u32 m0, s42, 32768
  s_add_u32 s45, s44, 65536
  buffer_load_dwordx4 v2, s[12:15], s45 offen lds
  s_add_u32 m0, s42, 36864
  s_add_u32 s45, s44, 81920
  buffer_load_dwordx4 v12, s[12:15], s45 offen lds
  s_add_u32 m0, s42, 12288
  s_add_u32 s45, s43, 196608
  buffer_load_dwordx4 v1, s[8:11], s45 offen lds
  s_add_u32 m0, s42, 40960
  s_add_u32 s45, s44, 98304
  buffer_load_dwordx4 v2, s[12:15], s45 offen lds
  s_add_u32 m0, s42, 45056
  s_add_u32 s45, s44, 114688
  buffer_load_dwordx4 v12, s[12:15], s45 offen lds
  s_add_u32 m0, s42, 49152
  s_nop 0
  buffer_load_dwordx4 v3, s[16:19], s46 offen lds
  s_add_u32 s41, s41, 1
  s_and_b32 s41, s41, 15
  s_add_u32 s42, s42, 53248
  s_cmp_ge_u32 s42, 159744
  s_cselect_b32 s42, s40, s42
  s_mul_i32 s7, s48, 4
  buffer_load_dword v20, v6, s[52:55], s7 offen
  s_lshl_b32 s43, s41, 7
  s_mul_i32 s44, s41, 131072
  s_lshl_b32 s46, s41, 12
  s_add_u32 m0, s42, 0
  s_add_u32 s45, s43, 0
  buffer_load_dwordx4 v1, s[8:11], s45 offen lds
  s_add_u32 m0, s42, 16384
  s_add_u32 s45, s44, 0
  buffer_load_dwordx4 v2, s[12:15], s45 offen lds
  s_add_u32 m0, s42, 20480
  s_add_u32 s45, s44, 16384
  buffer_load_dwordx4 v12, s[12:15], s45 offen lds
  s_add_u32 m0, s42, 4096
  s_add_u32 s45, s43, 65536
  buffer_load_dwordx4 v1, s[8:11], s45 offen lds
  s_add_u32 m0, s42, 24576
  s_add_u32 s45, s44, 32768
  buffer_load_dwordx4 v2, s[12:15], s45 offen lds
  s_add_u32 m0, s42, 28672
  s_add_u32 s45, s44, 49152
  buffer_load_dwordx4 v12, s[12:15], s45 offen lds
  s_add_u32 m0, s42, 8192
  s_add_u32 s45, s43, 131072
  buffer_load_dwordx4 v1, s[8:11], s45 offen lds
  s_add_u32 m0, s42, 32768
  s_add_u32 s45, s44, 65536
  buffer_load_dwordx4 v2, s[12:15], s45 offen lds
  s_add_u32 m0, s42, 36864
  s_add_u32 s45, s44, 81920
  buffer_load_dwordx4 v12, s[12:15], s45 offen lds
  s_add_u32 m0, s42, 12288
  s_add_u32 s45, s43, 196608
  buffer_load_dwordx4 v1, s[8:11], s45 offen lds
  s_add_u32 m0, s42, 40960
  s_add_u32 s45, s44, 98304
  buffer_load_dwordx4 v2, s[12:15], s45 offen lds
  s_add_u32 m0, s42, 45056
  s_add_u32 s45, s44, 114688
  buffer_load_dwordx4 v12, s[12:15], s45 offen lds
  s_add_u32 m0, s42, 49152
  s_nop 0
  buffer_load_dwordx4 v3, s[16:19], s46 offen lds
  s_add_u32 s41, s41, 1
  s_and_b32 s41, s41, 15
  s_add_u32 s42, s42, 53248
  s_cmp_ge_u32 s42, 159744
  s_cselect_b32 s42, s40, s42
  s_mov_b32 s49, 5
  s_min_u32 s7, s49, 15
  s_mul_i32 s7, s7, s48
  s_add_u32 s49, s49, 1
  buffer_load_dword v21, v6, s[52:55], s7 offen
  s_mov_b32 s47, 13
p1_ld_2:
  s_waitcnt vmcnt(15)
  s_barrier
  s_lshl_b32 s43, s41, 7
  s_mul_i32 s44, s41, 131072
  s_lshl_b32 s46, s41, 12
  s_add_u32 m0, s42, 0
  s_add_u32 s45, s43, 0
  buffer_load_dwordx4 v1, s[8:11], s45 offen lds
  s_add_u32 m0, s42, 16384
  s_add_u32 s45, s44, 0
  buffer_load_dwordx4 v2, s[12:15], s45 offen lds
  s_add_u32 m0, s42, 20480
  s_add_u32 s45, s44, 16384
  buffer_load_dwordx4 v12, s[12:15], s45 offen lds
  s_add_u32 m0, s42, 4096
  s_add_u32 s45, s43, 65536
  buffer_load_dwordx4 v1, s[8:11], s45 offen lds
  s_add_u32 m0, s42, 24576
  s_add_u32 s45, s44, 32768
  buffer_load_dwordx4 v2, s[12:15], s45 offen lds
  s_add_u32 m0, s42, 28672
  s_add_u32 s45, s44, 49152
  buffer_load_dwordx4 v12, s[12:15], s45 offen lds
  s_add_u32 m0, s42, 8192
  s_add_u32 s45, s43, 131072
  buffer_load_dwordx4 v1, s[8:11], s45 offen lds
  s_add_u32 m0, s42, 32768
  s_add_u32 s45, s44, 65536
  buffer_load_dwordx4 v2, s[12:15], s45 offen lds
  s_add_u32 m0, s42, 36864
  s_add_u32 s45, s44, 81920
  buffer_load_dwordx4 v12, s[12:15], s45 offen lds
  s_add_u32 m0, s42, 12288
  s_add_u32 s45, s43, 196608
  buffer_load_dwordx4 v1, s[8:11], s45 offen lds
  s_add_u32 m0, s42, 40960
  s_add_u32 s45, s44, 98304
  buffer_load_dwordx4 v2, s[12:15], s45 offen lds
  s_add_u32 m0, s42, 45056
  s_add_u32 s45, s44, 114688
  buffer_load_dwordx4 v12, s[12:15], s45 offen lds
  s_add_u32 m0, s42, 49152
  s_nop 0
  buffer_load_dwordx4 v3, s[16:19], s46 offen lds
  s_add_u32 s41, s41, 1
  s_and_b32 s41, s41, 15
  s_add_u32 s42, s42, 53248
  s_cmp_ge_u32 s42, 159744
  s_cselect_b32 s42, s40, s42
  s_min_u32 s7, s49, 15
  s_mul_i32 s7, s7, s48
  s_add_u32 s49, s49, 1
  buffer_load_dword v22, v6, s[52:55], s7 offen
  s_sub_u32 s47, s47, 1
  s_cmp_lg_u32 s47, 0
  s_cbranch_scc1 p1_ld_2
  s_getpc_b64 s[56:57]
ct_3:
  s_add_u32 s56, s56, p2_kernel-ct_3
  s_addc_u32 s57, s57, 0
  s_mov_b32 s58, p2_exit-p2_kernel
  s_mov_b32 s59, 0x20000
  s_lshl_b32 s7, s24, 13
  v_lshlrev_b32 v13, 7, v0
  v_add_u32 v13, s7, v13
  buffer_load_dword v14, v13, s[56:59], 0 offen
  s_waitcnt vmcnt(16)
  s_barrier
  s_waitcnt vmcnt(2)
  s_barrier
  s_endpgm
p1_loadA:
  v_mul_u32_u24 v5, 6144, v5
  v_add_u32 v2, v4, v5
  s_lshl_b32 s7, s4, 11
  s_lshl_b32 s26, s6, 9
  s_add_u32 s7, s7, s26
  v_add_u32 v2, s7, v2
  v_xor_b32 v12, 64, v2
  s_mov_b32 s42, s40
  s_lshr_b32 s7, s2, 3
  s_and_b32 s26, s2, 1
  s_lshl_b32 s27, s26, 5
  s_add_u32 s27, s27, s7
  s_mov_b32 s48, 128
  s_mov_b32 s64, 0
  s_cmp_eq_u32 s24, 1
  s_cbranch_scc1 p1_xc1
  s_cmp_eq_u32 s24, 2
  s_cbranch_scc1 p1_xc2
  s_lshl_b32 s26, s27, 16
  v_lshrrev_b32 v6, 1, v0
  v_lshlrev_b32 v6, 11, v6
  v_and_b32 v7, 1, v0
  v_lshl_add_u32 v6, v7, 6, v6
  s_branch p1_xcj
p1_xc1:
  s_mul_i32 s26, s7, 12288
  s_lshl_b32 s27, s4, 11
  s_add_u32 s26, s26, s27
  v_lshrrev_b32 v6, 5, v0
  v_mul_u32_u24 v6, 6144, v6
  v_and_b32 v7, 31, v0
  v_lshl_add_u32 v6, v7, 6, v6
  s_mov_b32 s48, 393216
  s_branch p1_xcj
p1_xc2:
  s_mov_b32 s64, 2
  s_cmp_eq_u32 s4, 2
  s_cbranch_scc1 p1_xc3
  s_lshl_b32 s26, s4, 6
  s_add_u32 s26, s26, s27
  s_lshl_b32 s26, s26, 15
  v_lshrrev_b32 v6, 2, v0
  v_lshlrev_b32 v6, 11, v6
  v_and_b32 v7, 3, v0
  v_lshl_add_u32 v6, v7, 5, v6
  s_branch p1_xcj
p1_xc3:
  s_lshl_b32 s26, s27, 11
  v_lshlrev_b32 v6, 5, v0
  s_mov_b32 s48, 131072
p1_xcj:
  v_add_u32 v6, s26, v6
  s_waitcnt lgkmcnt(0)
  s_cmp_eq_u32 s24, 1
  s_cselect_b32 s52, s12, s8
  s_cselect_b32 s53, s13, s9
  s_cselect_b32 s54, s14, s10
  s_cmp_eq_u32 s4, 2
  s_cselect_b32 s60, s62, s60
  s_cselect_b32 s61, s63, s61
  s_mov_b32 s62, 0x400000
  s_cselect_b32 s62, 0x200000, s62
  s_cmp_eq_u32 s24, 2
  s_cselect_b32 s52, s60, s52
  s_cselect_b32 s53, s61, s53
  s_cselect_b32 s54, s62, s54
  s_cmp_eq_u32 s24, 3
  s_cselect_b32 s54, 0, s54
  s_mov_b32 s55, 0x20000
  s_lshl_b32 s43, s41, 7
  s_mul_i32 s44, s41, 393216
  s_add_u32 m0, s42, 0
  s_add_u32 s45, s43, 0
  buffer_load_dwordx4 v1, s[8:11], s45 offen lds
  s_add_u32 m0, s42, 16384
  s_add_u32 s45, s44, 0
  buffer_load_dwordx4 v2, s[12:15], s45 offen lds
  s_add_u32 m0, s42, 20480
  s_add_u32 s45, s44, 49152
  buffer_load_dwordx4 v12, s[12:15], s45 offen lds
  s_add_u32 m0, s42, 4096
  s_add_u32 s45, s43, 65536
  buffer_load_dwordx4 v1, s[8:11], s45 offen lds
  s_add_u32 m0, s42, 24576
  s_add_u32 s45, s44, 98304
  buffer_load_dwordx4 v2, s[12:15], s45 offen lds
  s_add_u32 m0, s42, 28672
  s_add_u32 s45, s44, 147456
  buffer_load_dwordx4 v12, s[12:15], s45 offen lds
  s_add_u32 m0, s42, 8192
  s_add_u32 s45, s43, 131072
  buffer_load_dwordx4 v1, s[8:11], s45 offen lds
  s_add_u32 m0, s42, 32768
  s_add_u32 s45, s44, 196608
  buffer_load_dwordx4 v2, s[12:15], s45 offen lds
  s_add_u32 m0, s42, 36864
  s_add_u32 s45, s44, 245760
  buffer_load_dwordx4 v12, s[12:15], s45 offen lds
  s_add_u32 m0, s42, 12288
  s_add_u32 s45, s43, 196608
  buffer_load_dwordx4 v1, s[8:11], s45 offen lds
  s_add_u32 m0, s42, 40960
  s_add_u32 s45, s44, 294912
  buffer_load_dwordx4 v2, s[12:15], s45 offen lds
  s_add_u32 m0, s42, 45056
  s_add_u32 s45, s44, 344064
  buffer_load_dwordx4 v12, s[12:15], s45 offen lds
  s_add_u32 s41, s41, 1
  s_and_b32 s41, s41, 15
  s_add_u32 s42, s42, 53248
  s_cmp_ge_u32 s42, 159744
  s_cselect_b32 s42, s40, s42
  s_add_u32 s7, s64, 2
  s_mul_i32 s7, s7, s48
  buffer_load_dword v24, v6, s[52:55], s7 offen
  s_add_u32 s7, s64, 3
  s_mul_i32 s7, s7, s48
  buffer_load_dword v25, v6, s[52:55], s7 offen
  s_lshl_b32 s43, s41, 7
  s_mul_i32 s44, s41, 393216
  s_add_u32 m0, s42, 0
  s_add_u32 s45, s43, 0
  buffer_load_dwordx4 v1, s[8:11], s45 offen lds
  s_add_u32 m0, s42, 16384
  s_add_u32 s45, s44, 0
  buffer_load_dwordx4 v2, s[12:15], s45 offen lds
  s_add_u32 m0, s42, 20480
  s_add_u32 s45, s44, 49152
  buffer_load_dwordx4 v12, s[12:15], s45 offen lds
  s_add_u32 m0, s42, 4096
  s_add_u32 s45, s43, 65536
  buffer_load_dwordx4 v1, s[8:11], s45 offen lds
  s_waitcnt vmcnt(6)
  s_barrier
  s_add_u32 m0, s42, 24576
  s_add_u32 s45, s44, 98304
  buffer_load_dwordx4 v2, s[12:15], s45 offen lds
  s_add_u32 m0, s42, 28672
  s_add_u32 s45, s44, 147456
  buffer_load_dwordx4 v12, s[12:15], s45 offen lds
  s_add_u32 m0, s42, 8192
  s_add_u32 s45, s43, 131072
  buffer_load_dwordx4 v1, s[8:11], s45 offen lds
  s_add_u32 m0, s42, 32768
  s_add_u32 s45, s44, 196608
  buffer_load_dwordx4 v2, s[12:15], s45 offen lds
  s_add_u32 m0, s42, 36864
  s_add_u32 s45, s44, 245760
  buffer_load_dwordx4 v12, s[12:15], s45 offen lds
  s_add_u32 m0, s42, 12288
  s_add_u32 s45, s43, 196608
  buffer_load_dwordx4 v1, s[8:11], s45 offen lds
  s_add_u32 m0, s42, 40960
  s_add_u32 s45, s44, 294912
  buffer_load_dwordx4 v2, s[12:15], s45 offen lds
  s_add_u32 m0, s42, 45056
  s_add_u32 s45, s44, 344064
  buffer_load_dwordx4 v12, s[12:15], s45 offen lds
  s_add_u32 s41, s41, 1
  s_and_b32 s41, s41, 15
  s_add_u32 s42, s42, 53248
  s_cmp_ge_u32 s42, 159744
  s_cselect_b32 s42, s40, s42
  s_add_u32 s7, s64, 4
  s_mul_i32 s7, s7, s48
  buffer_load_dword v20, v6, s[52:55], s7 offen
  s_lshl_b32 s43, s41, 7
  s_mul_i32 s44, s41, 393216
  s_add_u32 m0, s42, 0
  s_add_u32 s45, s43, 0
  buffer_load_dwordx4 v1, s[8:11], s45 offen lds
  s_add_u32 m0, s42, 16384
  s_add_u32 s45, s44, 0
  buffer_load_dwordx4 v2, s[12:15], s45 offen lds
  s_add_u32 m0, s42, 20480
  s_add_u32 s45, s44, 49152
  buffer_load_dwordx4 v12, s[12:15], s45 offen lds
  s_add_u32 m0, s42, 4096
  s_add_u32 s45, s43, 65536
  buffer_load_dwordx4 v1, s[8:11], s45 offen lds
  s_add_u32 m0, s42, 24576
  s_add_u32 s45, s44, 98304
  buffer_load_dwordx4 v2, s[12:15], s45 offen lds
  s_add_u32 m0, s42, 28672
  s_add_u32 s45, s44, 147456
  buffer_load_dwordx4 v12, s[12:15], s45 offen lds
  s_add_u32 m0, s42, 8192
  s_add_u32 s45, s43, 131072
  buffer_load_dwordx4 v1, s[8:11], s45 offen lds
  s_add_u32 m0, s42, 32768
  s_add_u32 s45, s44, 196608
  buffer_load_dwordx4 v2, s[12:15], s45 offen lds
  s_add_u32 m0, s42, 36864
  s_add_u32 s45, s44, 245760
  buffer_load_dwordx4 v12, s[12:15], s45 offen lds
  s_add_u32 m0, s42, 12288
  s_add_u32 s45, s43, 196608
  buffer_load_dwordx4 v1, s[8:11], s45 offen lds
  s_add_u32 m0, s42, 40960
  s_add_u32 s45, s44, 294912
  buffer_load_dwordx4 v2, s[12:15], s45 offen lds
  s_add_u32 m0, s42, 45056
  s_add_u32 s45, s44, 344064
  buffer_load_dwordx4 v12, s[12:15], s45 offen lds
  s_add_u32 s41, s41, 1
  s_and_b32 s41, s41, 15
  s_add_u32 s42, s42, 53248
  s_cmp_ge_u32 s42, 159744
  s_cselect_b32 s42, s40, s42
  s_add_u32 s49, s64, 5
  s_min_u32 s7, s49, 15
  s_mul_i32 s7, s7, s48
  s_add_u32 s49, s49, 1
  buffer_load_dword v21, v6, s[52:55], s7 offen
  s_mov_b32 s47, 13
p1_ld_4:
  s_waitcnt vmcnt(14)
  s_barrier
  s_lshl_b32 s43, s41, 7
  s_mul_i32 s44, s41, 393216
  s_add_u32 m0, s42, 0
  s_add_u32 s45, s43, 0
  buffer_load_dwordx4 v1, s[8:11], s45 offen lds
  s_add_u32 m0, s42, 16384
  s_add_u32 s45, s44, 0
  buffer_load_dwordx4 v2, s[12:15], s45 offen lds
  s_add_u32 m0, s42, 20480
  s_add_u32 s45, s44, 49152
  buffer_load_dwordx4 v12, s[12:15], s45 offen lds
  s_add_u32 m0, s42, 4096
  s_add_u32 s45, s43, 65536
  buffer_load_dwordx4 v1, s[8:11], s45 offen lds
  s_add_u32 m0, s42, 24576
  s_add_u32 s45, s44, 98304
  buffer_load_dwordx4 v2, s[12:15], s45 offen lds
  s_add_u32 m0, s42, 28672
  s_add_u32 s45, s44, 147456
  buffer_load_dwordx4 v12, s[12:15], s45 offen lds
  s_add_u32 m0, s42, 8192
  s_add_u32 s45, s43, 131072
  buffer_load_dwordx4 v1, s[8:11], s45 offen lds
  s_add_u32 m0, s42, 32768
  s_add_u32 s45, s44, 196608
  buffer_load_dwordx4 v2, s[12:15], s45 offen lds
  s_add_u32 m0, s42, 36864
  s_add_u32 s45, s44, 245760
  buffer_load_dwordx4 v12, s[12:15], s45 offen lds
  s_add_u32 m0, s42, 12288
  s_add_u32 s45, s43, 196608
  buffer_load_dwordx4 v1, s[8:11], s45 offen lds
  s_add_u32 m0, s42, 40960
  s_add_u32 s45, s44, 294912
  buffer_load_dwordx4 v2, s[12:15], s45 offen lds
  s_add_u32 m0, s42, 45056
  s_add_u32 s45, s44, 344064
  buffer_load_dwordx4 v12, s[12:15], s45 offen lds
  s_add_u32 s41, s41, 1
  s_and_b32 s41, s41, 15
  s_add_u32 s42, s42, 53248
  s_cmp_ge_u32 s42, 159744
  s_cselect_b32 s42, s40, s42
  s_min_u32 s7, s49, 15
  s_mul_i32 s7, s7, s48
  s_add_u32 s49, s49, 1
  buffer_load_dword v22, v6, s[52:55], s7 offen
  s_sub_u32 s47, s47, 1
  s_cmp_lg_u32 s47, 0
  s_cbranch_scc1 p1_ld_4
  s_getpc_b64 s[56:57]
ct_5:
  s_add_u32 s56, s56, p2_kernel-ct_5
  s_addc_u32 s57, s57, 0
  s_mov_b32 s58, p2_exit-p2_kernel
  s_mov_b32 s59, 0x20000
  s_lshl_b32 s7, s24, 13
  v_lshlrev_b32 v13, 7, v0
  v_add_u32 v13, s7, v13
  buffer_load_dword v14, v13, s[56:59], 0 offen
  s_waitcnt vmcnt(15)
  s_barrier
  s_waitcnt vmcnt(2)
  s_barrier
  s_endpgm
p1_compute:
  s_lshr_b32 s24, s3, 1
  s_and_b32 s25, s3, 1
  s_getpc_b64 s[56:57]
vp_1:
  s_mov_b32 s7, p1_c_QK-vp_1
  s_cmp_eq_u32 s4, 2
  s_cselect_b32 s7, p1_c_V-vp_1, s7
  s_lshl_b32 s26, s6, 1
  s_add_u32 s26, s26, s25
  s_cmp_eq_u32 s4, 3
  s_cselect_b32 s26, s26, -1
  s_cmp_eq_u32 s26, 0
  s_cselect_b32 s7, p1_c_B0-vp_1, s7
  s_cmp_eq_u32 s26, 1
  s_cselect_b32 s7, p1_c_B1-vp_1, s7
  s_cmp_eq_u32 s26, 2
  s_cselect_b32 s7, p1_c_B2-vp_1, s7
  s_cmp_eq_u32 s26, 3
  s_cselect_b32 s7, p1_c_B3-vp_1, s7
  s_cmp_eq_u32 s26, 4
  s_cselect_b32 s7, p1_c_B4-vp_1, s7
  s_cmp_eq_u32 s26, 5
  s_cselect_b32 s7, p1_c_B5-vp_1, s7
  s_cmp_eq_u32 s26, 6
  s_cselect_b32 s7, p1_c_B6-vp_1, s7
  s_cmp_eq_u32 s26, 7
  s_cselect_b32 s7, p1_c_B7-vp_1, s7
  s_add_u32 s56, s56, s7
  s_addc_u32 s57, s57, 0
  s_mov_b32 s58, p1_c_B1-p1_c_B0
  s_mov_b32 s59, 0x20000
  v_lshlrev_b32 v226, 7, v0
  buffer_load_dword v246, v226, s[56:59], 0 offen
  v_and_b32 v226, 15, v0
  v_lshrrev_b32 v227, 4, v0
  v_lshrrev_b32 v228, 1, v226
  v_xor_b32 v228, v228, v227
  v_lshlrev_b32 v228, 4, v228
  v_lshl_add_u32 v228, v226, 7, v228
  s_lshl_b32 s7, s24, 13
  v_add_u32 v216, s7, v228
  v_xor_b32 v217, 64, v216
  v_lshrrev_b32 v228, 2, v0
  v_and_b32 v228, 3, v228
  v_and_b32 v229, 3, v0
  v_lshlrev_b32 v229, 3, v229
  v_lshl_add_u32 v230, v227, 3, v228
  v_lshl_add_u32 v222, v230, 6, v229
  s_lshl_b32 s7, s25, 11
  s_add_u32 s7, s7, 49152
  v_add_u32 v222, s7, v222
  v_lshl_add_u32 v230, v227, 12, v229
  v_lshl_add_u32 v230, v228, 7, v230
  s_add_u32 s7, s7, -32768
  v_add_u32 v230, s7, v230
  v_and_b32 v231, 1, v227
  v_lshlrev_b32 v231, 1, v231
  v_lshrrev_b32 v232, 1, v228
  v_or_b32 v231, v231, v232
  v_xor_b32 v232, 0, v231
  v_lshl_add_u32 v218, v232, 5, v230
  v_xor_b32 v232, 1, v231
  v_lshl_add_u32 v219, v232, 5, v230
  v_xor_b32 v232, 2, v231
  v_lshl_add_u32 v220, v232, 5, v230
  v_xor_b32 v232, 3, v231
  v_lshl_add_u32 v221, v232, 5, v230
  v_lshlrev_b32 v223, 4, v0
  v_lshrrev_b32 v231, 1, v227
  v_and_b32 v232, 1, v227
  v_lshlrev_b32 v231, 10, v231
  v_lshl_add_u32 v231, v232, 9, v231
  v_lshl_add_u32 v224, v226, 4, v231
  v_lshrrev_b32 v232, 3, v226
  v_lshl_add_u32 v231, v232, 8, v231
  v_and_b32 v232, 7, v226
  v_lshl_add_u32 v225, v232, 4, v231
  v_mov_b32 v128, 0
  v_mov_b32 v129, 0
  v_mov_b32 v130, 0
  v_mov_b32 v131, 0
  s_nop 1
  v_mfma_f32_32x32x16_bf16 v[0:15], v[128:131], v[128:131], 0
  v_mfma_f32_32x32x16_bf16 v[16:31], v[128:131], v[128:131], 0
  v_mfma_f32_32x32x16_bf16 v[32:47], v[128:131], v[128:131], 0
  v_mfma_f32_32x32x16_bf16 v[48:63], v[128:131], v[128:131], 0
  v_mfma_f32_32x32x16_bf16 v[64:79], v[128:131], v[128:131], 0
  v_mfma_f32_32x32x16_bf16 v[80:95], v[128:131], v[128:131], 0
  v_mfma_f32_32x32x16_bf16 v[96:111], v[128:131], v[128:131], 0
  v_mfma_f32_32x32x16_bf16 v[112:127], v[128:131], v[128:131], 0
  v_mfma_f32_32x32x16_bf16 v[200:215], v[128:131], v[128:131], 0
  s_mov_b32 s26, 0
  s_mov_b32 s50, -106496
  s_mov_b32 s51, 53248
  s_cmp_eq_u32 s4, 2
  s_cbranch_scc1 p1_c_V
  s_cmp_eq_u32 s4, 3
  s_cbranch_scc0 p1_c_QK
  s_lshl_b32 s7, s6, 1
  s_add_u32 s7, s7, s25
  s_cmp_eq_u32 s7, 0
  s_cbranch_scc1 p1_c_B0
  s_cmp_eq_u32 s7, 1
  s_cbranch_scc1 p1_c_B1
  s_cmp_eq_u32 s7, 2
  s_cbranch_scc1 p1_c_B2
  s_cmp_eq_u32 s7, 3
  s_cbranch_scc1 p1_c_B3
  s_cmp_eq_u32 s7, 4
  s_cbranch_scc1 p1_c_B4
  s_cmp_eq_u32 s7, 5
  s_cbranch_scc1 p1_c_B5
  s_cmp_eq_u32 s7, 6
  s_cbranch_scc1 p1_c_B6
  s_cmp_eq_u32 s7, 7
  s_cbranch_scc1 p1_c_B7
  s_endpgm
p1_c_QK:
  s_lshl_b32 s7, s6, 3
  s_lshl_b32 s33, s25, 2
  s_add_u32 s7, s7, s33
  s_lshl_b32 s33, s5, 2
  s_lshl_b32 s36, s24, 1
  s_add_u32 s33, s33, s36
  s_mov_b32 s31, 262144
  s_mov_b32 s32, 4096
  s_mov_b32 s36, 4194304
  s_cmp_eq_u32 s4, 0
  s_cselect_b32 s31, 131072, s31
  s_cselect_b32 s32, 2048, s32
  s_cselect_b32 s36, 0, s36
  s_cselect_b32 s34, 0x3e8293ee, 1.0
  s_mov_b32 s35, s34
  s_mul_i32 s7, s7, s31
  s_mul_i32 s33, s33, s32
  s_add_u32 s30, s7, s33
  s_add_u32 s30, s30, s36
  s_mov_b32 s28, 14
  s_waitcnt lgkmcnt(0)
  s_mov_b32 s37, 128
  s_cmp_eq_u32 s4, 0
  s_cselect_b64 vcc, -1, 0
  s_cselect_b32 s37, 256, s37
  s_nop 1
  v_cndmask_b32 v225, v225, v224, vcc
  s_barrier
  ds_read_b128 v[128:131], v216 offset:0
  ds_read_b64_tr_b16 v[160:161], v218 offset:0
  ds_read_b64_tr_b16 v[162:163], v218 offset:512
  ds_read_b128 v[132:135], v216 offset:2048
  ds_read_b64_tr_b16 v[164:165], v219 offset:0
  ds_read_b64_tr_b16 v[166:167], v219 offset:512
  ds_read_b128 v[136:139], v216 offset:4096
  ds_read_b64_tr_b16 v[168:169], v220 offset:0
  ds_read_b64_tr_b16 v[170:171], v220 offset:512
  ds_read_b128 v[140:143], v216 offset:6144
  ds_read_b64_tr_b16 v[172:173], v221 offset:0
  ds_read_b64_tr_b16 v[174:175], v221 offset:512
  .p2align 6
p1_c_QK_loop:
  s_waitcnt lgkmcnt(0)
  v_mfma_f32_16x16x32_bf16 v[0:3], v[160:163], v[128:131], v[0:3]
  ds_read_b64_tr_b16 v[176:177], v218 offset:1024
  v_mfma_f32_16x16x32_bf16 v[4:7], v[164:167], v[128:131], v[4:7]
  ds_read_b64_tr_b16 v[178:179], v218 offset:1536
  v_mfma_f32_16x16x32_bf16 v[8:11], v[168:171], v[128:131], v[8:11]
  ds_read_b64_tr_b16 v[180:181], v219 offset:1024
  v_mfma_f32_16x16x32_bf16 v[12:15], v[172:175], v[128:131], v[12:15]
  ds_read_b64_tr_b16 v[182:183], v219 offset:1536
  v_mfma_f32_16x16x32_bf16 v[32:35], v[160:163], v[132:135], v[32:35]
  ds_read_b128 v[144:147], v217 offset:0
  v_mfma_f32_16x16x32_bf16 v[36:39], v[164:167], v[132:135], v[36:39]
  ds_read_b64_tr_b16 v[184:185], v220 offset:1024
  v_mfma_f32_16x16x32_bf16 v[40:43], v[168:171], v[132:135], v[40:43]
  ds_read_b64_tr_b16 v[186:187], v220 offset:1536
  v_mfma_f32_16x16x32_bf16 v[44:47], v[172:175], v[132:135], v[44:47]
  ds_read_b64_tr_b16 v[188:189], v221 offset:1024
  v_mfma_f32_16x16x32_bf16 v[64:67], v[160:163], v[136:139], v[64:67]
  ds_read_b64_tr_b16 v[190:191], v221 offset:1536
  v_mfma_f32_16x16x32_bf16 v[68:71], v[164:167], v[136:139], v[68:71]
  ds_read_b128 v[148:151], v217 offset:2048
  v_mfma_f32_16x16x32_bf16 v[72:75], v[168:171], v[136:139], v[72:75]
  v_mfma_f32_16x16x32_bf16 v[76:79], v[172:175], v[136:139], v[76:79]
  v_mfma_f32_16x16x32_bf16 v[96:99], v[160:163], v[140:143], v[96:99]
  v_mfma_f32_16x16x32_bf16 v[100:103], v[164:167], v[140:143], v[100:103]
  v_mfma_f32_16x16x32_bf16 v[104:107], v[168:171], v[140:143], v[104:107]
  s_add_u32 s26, s26, 1
  s_cmp_eq_u32 s26, 3
  v_mfma_f32_16x16x32_bf16 v[108:111], v[172:175], v[140:143], v[108:111]
  s_cselect_b32 s27, s50, s51
  s_cselect_b32 s26, 0, s26
  s_waitcnt lgkmcnt(0)
  v_mfma_f32_16x16x32_bf16 v[16:19], v[176:179], v[128:131], v[16:19]
  ds_read_b64_tr_b16 v[160:161], v218 offset:16384
  v_mfma_f32_16x16x32_bf16 v[20:23], v[180:183], v[128:131], v[20:23]
  ds_read_b64_tr_b16 v[162:163], v218 offset:16896
  v_mfma_f32_16x16x32_bf16 v[24:27], v[184:187], v[128:131], v[24:27]
  ds_read_b64_tr_b16 v[164:165], v219 offset:16384
  v_mfma_f32_16x16x32_bf16 v[28:31], v[188:191], v[128:131], v[28:31]
  ds_read_b64_tr_b16 v[166:167], v219 offset:16896
  v_mfma_f32_16x16x32_bf16 v[48:51], v[176:179], v[132:135], v[48:51]
  ds_read_b128 v[152:155], v217 offset:4096
  v_mfma_f32_16x16x32_bf16 v[52:55], v[180:183], v[132:135], v[52:55]
  ds_read_b64_tr_b16 v[168:169], v220 offset:16384
  v_mfma_f32_16x16x32_bf16 v[56:59], v[184:187], v[132:135], v[56:59]
  ds_read_b64_tr_b16 v[170:171], v220 offset:16896
  v_mfma_f32_16x16x32_bf16 v[60:63], v[188:191], v[132:135], v[60:63]
  ds_read_b64_tr_b16 v[172:173], v221 offset:16384
  v_mfma_f32_16x16x32_bf16 v[80:83], v[176:179], v[136:139], v[80:83]
  ds_read_b64_tr_b16 v[174:175], v221 offset:16896
  v_mfma_f32_16x16x32_bf16 v[84:87], v[180:183], v[136:139], v[84:87]
  ds_read_b128 v[156:159], v217 offset:6144
  v_mfma_f32_16x16x32_bf16 v[88:91], v[184:187], v[136:139], v[88:91]
  v_mfma_f32_16x16x32_bf16 v[92:95], v[188:191], v[136:139], v[92:95]
  v_mfma_f32_16x16x32_bf16 v[112:115], v[176:179], v[140:143], v[112:115]
  v_mfma_f32_16x16x32_bf16 v[116:119], v[180:183], v[140:143], v[116:119]
  v_mfma_f32_16x16x32_bf16 v[120:123], v[184:187], v[140:143], v[120:123]
  v_mfma_f32_16x16x32_bf16 v[124:127], v[188:191], v[140:143], v[124:127]
  s_waitcnt lgkmcnt(0)
  v_mfma_f32_16x16x32_bf16 v[0:3], v[160:163], v[144:147], v[0:3]
  ds_read_b64_tr_b16 v[176:177], v218 offset:17408
  v_mfma_f32_16x16x32_bf16 v[4:7], v[164:167], v[144:147], v[4:7]
  ds_read_b64_tr_b16 v[178:179], v218 offset:17920
  v_mfma_f32_16x16x32_bf16 v[8:11], v[168:171], v[144:147], v[8:11]
  ds_read_b64_tr_b16 v[180:181], v219 offset:17408
  v_mfma_f32_16x16x32_bf16 v[12:15], v[172:175], v[144:147], v[12:15]
  ds_read_b64_tr_b16 v[182:183], v219 offset:17920
  v_mfma_f32_16x16x32_bf16 v[32:35], v[160:163], v[148:151], v[32:35]
  ds_read_b64_tr_b16 v[184:185], v220 offset:17408
  v_mfma_f32_16x16x32_bf16 v[36:39], v[164:167], v[148:151], v[36:39]
  ds_read_b64_tr_b16 v[186:187], v220 offset:17920
  v_mfma_f32_16x16x32_bf16 v[40:43], v[168:171], v[148:151], v[40:43]
  ds_read_b64_tr_b16 v[188:189], v221 offset:17408
  v_mfma_f32_16x16x32_bf16 v[44:47], v[172:175], v[148:151], v[44:47]
  ds_read_b64_tr_b16 v[190:191], v221 offset:17920
  v_mfma_f32_16x16x32_bf16 v[64:67], v[160:163], v[152:155], v[64:67]
  v_mfma_f32_16x16x32_bf16 v[68:71], v[164:167], v[152:155], v[68:71]
  v_mfma_f32_16x16x32_bf16 v[72:75], v[168:171], v[152:155], v[72:75]
  v_mfma_f32_16x16x32_bf16 v[76:79], v[172:175], v[152:155], v[76:79]
  v_mfma_f32_16x16x32_bf16 v[96:99], v[160:163], v[156:159], v[96:99]
  v_mfma_f32_16x16x32_bf16 v[100:103], v[164:167], v[156:159], v[100:103]
  v_mfma_f32_16x16x32_bf16 v[104:107], v[168:171], v[156:159], v[104:107]
  v_mfma_f32_16x16x32_bf16 v[108:111], v[172:175], v[156:159], v[108:111]
  s_waitcnt lgkmcnt(0)
  s_barrier
  v_mfma_f32_16x16x32_bf16 v[16:19], v[176:179], v[144:147], v[16:19]
  v_add_u32 v216, s27, v216
  v_add_u32 v218, s27, v218
  v_mfma_f32_16x16x32_bf16 v[20:23], v[180:183], v[144:147], v[20:23]
  ds_read_b128 v[128:131], v216 offset:0
  ds_read_b64_tr_b16 v[160:161], v218 offset:0
  v_mfma_f32_16x16x32_bf16 v[24:27], v[184:187], v[144:147], v[24:27]
  ds_read_b64_tr_b16 v[162:163], v218 offset:512
  v_add_u32 v219, s27, v219
  v_mfma_f32_16x16x32_bf16 v[28:31], v[188:191], v[144:147], v[28:31]
  ds_read_b128 v[132:135], v216 offset:2048
  ds_read_b64_tr_b16 v[164:165], v219 offset:0
  v_mfma_f32_16x16x32_bf16 v[48:51], v[176:179], v[148:151], v[48:51]
  ds_read_b64_tr_b16 v[166:167], v219 offset:512
  v_add_u32 v220, s27, v220
  v_mfma_f32_16x16x32_bf16 v[52:55], v[180:183], v[148:151], v[52:55]
  ds_read_b128 v[136:139], v216 offset:4096
  ds_read_b64_tr_b16 v[168:169], v220 offset:0
  v_mfma_f32_16x16x32_bf16 v[56:59], v[184:187], v[148:151], v[56:59]
  ds_read_b64_tr_b16 v[170:171], v220 offset:512
  v_add_u32 v221, s27, v221
  v_mfma_f32_16x16x32_bf16 v[60:63], v[188:191], v[148:151], v[60:63]
  ds_read_b128 v[140:143], v216 offset:6144
  ds_read_b64_tr_b16 v[172:173], v221 offset:0
  v_mfma_f32_16x16x32_bf16 v[80:83], v[176:179], v[152:155], v[80:83]
  ds_read_b64_tr_b16 v[174:175], v221 offset:512
  v_mfma_f32_16x16x32_bf16 v[84:87], v[180:183], v[152:155], v[84:87]
  v_add_u32 v217, s27, v217
  v_mfma_f32_16x16x32_bf16 v[88:91], v[184:187], v[152:155], v[88:91]
  s_sub_u32 s28, s28, 1
  v_mfma_f32_16x16x32_bf16 v[92:95], v[188:191], v[152:155], v[92:95]
  s_cmp_lg_u32 s28, 0
  v_mfma_f32_16x16x32_bf16 v[112:115], v[176:179], v[156:159], v[112:115]
  v_mfma_f32_16x16x32_bf16 v[116:119], v[180:183], v[156:159], v[116:119]
  v_mfma_f32_16x16x32_bf16 v[120:123], v[184:187], v[156:159], v[120:123]
  v_mfma_f32_16x16x32_bf16 v[124:127], v[188:191], v[156:159], v[124:127]
  s_cbranch_scc1 p1_c_QK_loop
  s_waitcnt lgkmcnt(0)
  v_mfma_f32_16x16x32_bf16 v[0:3], v[160:163], v[128:131], v[0:3]
  ds_read_b128 v[144:147], v217 offset:0
  v_mfma_f32_16x16x32_bf16 v[4:7], v[164:167], v[128:131], v[4:7]
  ds_read_b64_tr_b16 v[176:177], v218 offset:16384
  v_mfma_f32_16x16x32_bf16 v[8:11], v[168:171], v[128:131], v[8:11]
  ds_read_b64_tr_b16 v[178:179], v218 offset:16896
  v_mfma_f32_16x16x32_bf16 v[12:15], v[172:175], v[128:131], v[12:15]
  ds_read_b128 v[148:151], v217 offset:2048
  v_mfma_f32_16x16x32_bf16 v[32:35], v[160:163], v[132:135], v[32:35]
  ds_read_b64_tr_b16 v[180:181], v219 offset:16384
  v_mfma_f32_16x16x32_bf16 v[36:39], v[164:167], v[132:135], v[36:39]
  ds_read_b64_tr_b16 v[182:183], v219 offset:16896
  v_mfma_f32_16x16x32_bf16 v[40:43], v[168:171], v[132:135], v[40:43]
  ds_read_b128 v[152:155], v217 offset:4096
  v_mfma_f32_16x16x32_bf16 v[44:47], v[172:175], v[132:135], v[44:47]
  ds_read_b64_tr_b16 v[184:185], v220 offset:16384
  v_mfma_f32_16x16x32_bf16 v[64:67], v[160:163], v[136:139], v[64:67]
  ds_read_b64_tr_b16 v[186:187], v220 offset:16896
  v_mfma_f32_16x16x32_bf16 v[68:71], v[164:167], v[136:139], v[68:71]
  ds_read_b128 v[156:159], v217 offset:6144
  v_mfma_f32_16x16x32_bf16 v[72:75], v[168:171], v[136:139], v[72:75]
  ds_read_b64_tr_b16 v[188:189], v221 offset:16384
  v_add_u32 v235, 0xfffe6000, v221
  v_mfma_f32_16x16x32_bf16 v[76:79], v[172:175], v[136:139], v[76:79]
  ds_read_b64_tr_b16 v[190:191], v221 offset:16896
  v_add_u32 v234, 0xfffe6000, v220
  v_mfma_f32_16x16x32_bf16 v[96:99], v[160:163], v[140:143], v[96:99]
  v_add_u32 v233, 0xfffe6000, v219
  v_mfma_f32_16x16x32_bf16 v[100:103], v[164:167], v[140:143], v[100:103]
  v_add_u32 v232, 0xfffe6000, v218
  v_mfma_f32_16x16x32_bf16 v[104:107], v[168:171], v[140:143], v[104:107]
  v_add_u32 v231, 0xfffe6000, v217
  v_mfma_f32_16x16x32_bf16 v[108:111], v[172:175], v[140:143], v[108:111]
  v_add_u32 v230, 0xfffe6000, v216
  s_waitcnt lgkmcnt(0)
  s_barrier
  v_mfma_f32_16x16x32_bf16 v[0:3], v[176:179], v[144:147], v[0:3]
  ds_read_b128 v[128:131], v230 offset:0
  v_mfma_f32_16x16x32_bf16 v[4:7], v[180:183], v[144:147], v[4:7]
  ds_read_b64_tr_b16 v[160:161], v232 offset:0
  v_mfma_f32_16x16x32_bf16 v[8:11], v[184:187], v[144:147], v[8:11]
  ds_read_b64_tr_b16 v[162:163], v232 offset:512
  v_mfma_f32_16x16x32_bf16 v[12:15], v[188:191], v[144:147], v[12:15]
  ds_read_b128 v[132:135], v230 offset:2048
  v_mfma_f32_16x16x32_bf16 v[32:35], v[176:179], v[148:151], v[32:35]
  ds_read_b64_tr_b16 v[164:165], v233 offset:0
  v_mfma_f32_16x16x32_bf16 v[36:39], v[180:183], v[148:151], v[36:39]
  ds_read_b64_tr_b16 v[166:167], v233 offset:512
  v_mfma_f32_16x16x32_bf16 v[40:43], v[184:187], v[148:151], v[40:43]
  ds_read_b128 v[136:139], v230 offset:4096
  v_mfma_f32_16x16x32_bf16 v[44:47], v[188:191], v[148:151], v[44:47]
  ds_read_b64_tr_b16 v[168:169], v234 offset:0
  v_mfma_f32_16x16x32_bf16 v[64:67], v[176:179], v[152:155], v[64:67]
  ds_read_b64_tr_b16 v[170:171], v234 offset:512
  v_mfma_f32_16x16x32_bf16 v[68:71], v[180:183], v[152:155], v[68:71]
  ds_read_b128 v[140:143], v230 offset:6144
  v_mfma_f32_16x16x32_bf16 v[72:75], v[184:187], v[152:155], v[72:75]
  ds_read_b64_tr_b16 v[172:173], v235 offset:0
  v_mfma_f32_16x16x32_bf16 v[76:79], v[188:191], v[152:155], v[76:79]
  ds_read_b64_tr_b16 v[174:175], v235 offset:512
  v_mfma_f32_16x16x32_bf16 v[96:99], v[176:179], v[156:159], v[96:99]
  v_mfma_f32_16x16x32_bf16 v[100:103], v[180:183], v[156:159], v[100:103]
  v_mfma_f32_16x16x32_bf16 v[104:107], v[184:187], v[156:159], v[104:107]
  v_mfma_f32_16x16x32_bf16 v[108:111], v[188:191], v[156:159], v[108:111]
  s_waitcnt lgkmcnt(0)
  v_mfma_f32_16x16x32_bf16 v[0:3], v[160:163], v[128:131], v[0:3]
  ds_read_b128 v[144:147], v231 offset:0
  v_mfma_f32_16x16x32_bf16 v[4:7], v[164:167], v[128:131], v[4:7]
  ds_read_b64_tr_b16 v[176:177], v232 offset:16384
  v_mfma_f32_16x16x32_bf16 v[8:11], v[168:171], v[128:131], v[8:11]
  ds_read_b64_tr_b16 v[178:179], v232 offset:16896
  v_mfma_f32_16x16x32_bf16 v[12:15], v[172:175], v[128:131], v[12:15]
  ds_read_b128 v[148:151], v231 offset:2048
  v_mfma_f32_16x16x32_bf16 v[32:35], v[160:163], v[132:135], v[32:35]
  ds_read_b64_tr_b16 v[180:181], v233 offset:16384
  v_mfma_f32_16x16x32_bf16 v[36:39], v[164:167], v[132:135], v[36:39]
  ds_read_b64_tr_b16 v[182:183], v233 offset:16896
  v_mfma_f32_16x16x32_bf16 v[40:43], v[168:171], v[132:135], v[40:43]
  ds_read_b128 v[152:155], v231 offset:4096
  v_mfma_f32_16x16x32_bf16 v[44:47], v[172:175], v[132:135], v[44:47]
  ds_read_b64_tr_b16 v[184:185], v234 offset:16384
  v_mfma_f32_16x16x32_bf16 v[64:67], v[160:163], v[136:139], v[64:67]
  ds_read_b64_tr_b16 v[186:187], v234 offset:16896
  v_mfma_f32_16x16x32_bf16 v[68:71], v[164:167], v[136:139], v[68:71]
  ds_read_b128 v[156:159], v231 offset:6144
  v_mfma_f32_16x16x32_bf16 v[72:75], v[168:171], v[136:139], v[72:75]
  ds_read_b64_tr_b16 v[188:189], v235 offset:16384
  v_mfma_f32_16x16x32_bf16 v[76:79], v[172:175], v[136:139], v[76:79]
  ds_read_b64_tr_b16 v[190:191], v235 offset:16896
  v_mfma_f32_16x16x32_bf16 v[96:99], v[160:163], v[140:143], v[96:99]
  v_mfma_f32_16x16x32_bf16 v[100:103], v[164:167], v[140:143], v[100:103]
  v_mfma_f32_16x16x32_bf16 v[104:107], v[168:171], v[140:143], v[104:107]
  v_mfma_f32_16x16x32_bf16 v[108:111], v[172:175], v[140:143], v[108:111]
  s_waitcnt lgkmcnt(0)
  v_mfma_f32_16x16x32_bf16 v[0:3], v[176:179], v[144:147], v[0:3]
  ds_read_b64_tr_b16 v[160:161], v232 offset:1024
  v_mfma_f32_16x16x32_bf16 v[4:7], v[180:183], v[144:147], v[4:7]
  ds_read_b64_tr_b16 v[162:163], v232 offset:1536
  v_mfma_f32_16x16x32_bf16 v[8:11], v[184:187], v[144:147], v[8:11]
  ds_read_b64_tr_b16 v[164:165], v233 offset:1024
  v_mfma_f32_16x16x32_bf16 v[12:15], v[188:191], v[144:147], v[12:15]
  ds_read_b64_tr_b16 v[166:167], v233 offset:1536
  v_mfma_f32_16x16x32_bf16 v[32:35], v[176:179], v[148:151], v[32:35]
  ds_read_b64_tr_b16 v[168:169], v234 offset:1024
  v_mfma_f32_16x16x32_bf16 v[36:39], v[180:183], v[148:151], v[36:39]
  ds_read_b64_tr_b16 v[170:171], v234 offset:1536
  v_mfma_f32_16x16x32_bf16 v[40:43], v[184:187], v[148:151], v[40:43]
  ds_read_b64_tr_b16 v[172:173], v235 offset:1024
  v_mfma_f32_16x16x32_bf16 v[44:47], v[188:191], v[148:151], v[44:47]
  ds_read_b64_tr_b16 v[174:175], v235 offset:1536
  v_mfma_f32_16x16x32_bf16 v[64:67], v[176:179], v[152:155], v[64:67]
  v_mfma_f32_16x16x32_bf16 v[68:71], v[180:183], v[152:155], v[68:71]
  v_mfma_f32_16x16x32_bf16 v[72:75], v[184:187], v[152:155], v[72:75]
  v_mfma_f32_16x16x32_bf16 v[76:79], v[188:191], v[152:155], v[76:79]
  v_mfma_f32_16x16x32_bf16 v[96:99], v[176:179], v[156:159], v[96:99]
  v_mfma_f32_16x16x32_bf16 v[100:103], v[180:183], v[156:159], v[100:103]
  v_mfma_f32_16x16x32_bf16 v[104:107], v[184:187], v[156:159], v[104:107]
  v_mfma_f32_16x16x32_bf16 v[108:111], v[188:191], v[156:159], v[108:111]
  s_waitcnt lgkmcnt(0)
  v_mfma_f32_16x16x32_bf16 v[16:19], v[160:163], v[128:131], v[16:19]
  ds_read_b64_tr_b16 v[176:177], v232 offset:17408
  v_mfma_f32_16x16x32_bf16 v[20:23], v[164:167], v[128:131], v[20:23]
  ds_read_b64_tr_b16 v[178:179], v232 offset:17920
  v_mfma_f32_16x16x32_bf16 v[24:27], v[168:171], v[128:131], v[24:27]
  ds_read_b64_tr_b16 v[180:181], v233 offset:17408
  v_mfma_f32_16x16x32_bf16 v[28:31], v[172:175], v[128:131], v[28:31]
  ds_read_b64_tr_b16 v[182:183], v233 offset:17920
  v_mfma_f32_16x16x32_bf16 v[48:51], v[160:163], v[132:135], v[48:51]
  ds_read_b64_tr_b16 v[184:185], v234 offset:17408
  v_pk_mul_f32 v[0:1], v[0:1], s[34:35]
  v_pk_mul_f32 v[2:3], v[2:3], s[34:35]
  v_mfma_f32_16x16x32_bf16 v[52:55], v[164:167], v[132:135], v[52:55]
  ds_read_b64_tr_b16 v[186:187], v234 offset:17920
  v_pk_mul_f32 v[4:5], v[4:5], s[34:35]
  v_pk_mul_f32 v[6:7], v[6:7], s[34:35]
  v_mfma_f32_16x16x32_bf16 v[56:59], v[168:171], v[132:135], v[56:59]
  ds_read_b64_tr_b16 v[188:189], v235 offset:17408
  v_cvt_pk_bf16_f32 v0, v0, v1
  v_cvt_pk_bf16_f32 v1, v2, v3
  v_mfma_f32_16x16x32_bf16 v[60:63], v[172:175], v[132:135], v[60:63]
  ds_read_b64_tr_b16 v[190:191], v235 offset:17920
  v_cvt_pk_bf16_f32 v2, v4, v5
  v_cvt_pk_bf16_f32 v3, v6, v7
  v_mfma_f32_16x16x32_bf16 v[80:83], v[160:163], v[136:139], v[80:83]
  s_mul_i32 s7, s31, 0
  s_add_u32 s7, s7, s30
  v_mfma_f32_16x16x32_bf16 v[84:87], v[164:167], v[136:139], v[84:87]
  buffer_store_dwordx4 v[0:3], v225, s[20:23], s7 offen sc1
  v_pk_mul_f32 v[32:33], v[32:33], s[34:35]
  v_mfma_f32_16x16x32_bf16 v[88:91], v[168:171], v[136:139], v[88:91]
  v_pk_mul_f32 v[34:35], v[34:35], s[34:35]
  v_pk_mul_f32 v[36:37], v[36:37], s[34:35]
  v_mfma_f32_16x16x32_bf16 v[92:95], v[172:175], v[136:139], v[92:95]
  v_pk_mul_f32 v[38:39], v[38:39], s[34:35]
  v_cvt_pk_bf16_f32 v32, v32, v33
  v_mfma_f32_16x16x32_bf16 v[112:115], v[160:163], v[140:143], v[112:115]
  v_cvt_pk_bf16_f32 v33, v34, v35
  v_cvt_pk_bf16_f32 v34, v36, v37
  v_mfma_f32_16x16x32_bf16 v[116:119], v[164:167], v[140:143], v[116:119]
  v_cvt_pk_bf16_f32 v35, v38, v39
  s_add_u32 s33, s7, s37
  v_mfma_f32_16x16x32_bf16 v[120:123], v[168:171], v[140:143], v[120:123]
  buffer_store_dwordx4 v[32:35], v225, s[20:23], s33 offen sc1
  v_pk_mul_f32 v[8:9], v[8:9], s[34:35]
  v_mfma_f32_16x16x32_bf16 v[124:127], v[172:175], v[140:143], v[124:127]
  v_pk_mul_f32 v[10:11], v[10:11], s[34:35]
  v_pk_mul_f32 v[12:13], v[12:13], s[34:35]
  s_waitcnt lgkmcnt(0)
  v_mfma_f32_16x16x32_bf16 v[16:19], v[176:179], v[144:147], v[16:19]
  ds_read_b128 v[128:131], v216 offset:0
  v_pk_mul_f32 v[14:15], v[14:15], s[34:35]
  v_cvt_pk_bf16_f32 v8, v8, v9
  v_mfma_f32_16x16x32_bf16 v[20:23], v[180:183], v[144:147], v[20:23]
  ds_read_b64_tr_b16 v[160:161], v218 offset:1024
  v_cvt_pk_bf16_f32 v9, v10, v11
  v_cvt_pk_bf16_f32 v10, v12, v13
  v_mfma_f32_16x16x32_bf16 v[24:27], v[184:187], v[144:147], v[24:27]
  ds_read_b64_tr_b16 v[162:163], v218 offset:1536
  v_cvt_pk_bf16_f32 v11, v14, v15
  s_mul_i32 s7, s31, 1
  v_mfma_f32_16x16x32_bf16 v[28:31], v[188:191], v[144:147], v[28:31]
  ds_read_b128 v[132:135], v216 offset:2048
  s_add_u32 s7, s7, s30
  buffer_store_dwordx4 v[8:11], v225, s[20:23], s7 offen sc1
  v_mfma_f32_16x16x32_bf16 v[48:51], v[176:179], v[148:151], v[48:51]
  ds_read_b64_tr_b16 v[164:165], v219 offset:1024
  v_pk_mul_f32 v[40:41], v[40:41], s[34:35]
  v_pk_mul_f32 v[42:43], v[42:43], s[34:35]
  v_mfma_f32_16x16x32_bf16 v[52:55], v[180:183], v[148:151], v[52:55]
  ds_read_b64_tr_b16 v[166:167], v219 offset:1536
  v_pk_mul_f32 v[44:45], v[44:45], s[34:35]
  v_pk_mul_f32 v[46:47], v[46:47], s[34:35]
  v_mfma_f32_16x16x32_bf16 v[56:59], v[184:187], v[148:151], v[56:59]
  ds_read_b128 v[136:139], v216 offset:4096
  v_cvt_pk_bf16_f32 v40, v40, v41
  v_cvt_pk_bf16_f32 v41, v42, v43
  v_mfma_f32_16x16x32_bf16 v[60:63], v[188:191], v[148:151], v[60:63]
  ds_read_b64_tr_b16 v[168:169], v220 offset:1024
  v_cvt_pk_bf16_f32 v42, v44, v45
  v_cvt_pk_bf16_f32 v43, v46, v47
  v_mfma_f32_16x16x32_bf16 v[80:83], v[176:179], v[152:155], v[80:83]
  ds_read_b64_tr_b16 v[170:171], v220 offset:1536
  s_add_u32 s33, s7, s37
  buffer_store_dwordx4 v[40:43], v225, s[20:23], s33 offen sc1
  v_mfma_f32_16x16x32_bf16 v[84:87], v[180:183], v[152:155], v[84:87]
  ds_read_b128 v[140:143], v216 offset:6144
  v_pk_mul_f32 v[64:65], v[64:65], s[34:35]
  v_pk_mul_f32 v[66:67], v[66:67], s[34:35]
  v_mfma_f32_16x16x32_bf16 v[88:91], v[184:187], v[152:155], v[88:91]
  ds_read_b64_tr_b16 v[172:173], v221 offset:1024
  v_pk_mul_f32 v[68:69], v[68:69], s[34:35]
  v_pk_mul_f32 v[70:71], v[70:71], s[34:35]
  v_mfma_f32_16x16x32_bf16 v[92:95], v[188:191], v[152:155], v[92:95]
  ds_read_b64_tr_b16 v[174:175], v221 offset:1536
  v_cvt_pk_bf16_f32 v64, v64, v65
  v_cvt_pk_bf16_f32 v65, v66, v67
  v_mfma_f32_16x16x32_bf16 v[112:115], v[176:179], v[156:159], v[112:115]
  v_cvt_pk_bf16_f32 v66, v68, v69
  v_cvt_pk_bf16_f32 v67, v70, v71
  v_mfma_f32_16x16x32_bf16 v[116:119], v[180:183], v[156:159], v[116:119]
  s_mul_i32 s7, s31, 0
  s_add_u32 s7, s7, s30
  v_mfma_f32_16x16x32_bf16 v[120:123], v[184:187], v[156:159], v[120:123]
  s_add_u32 s7, s7, s32
  buffer_store_dwordx4 v[64:67], v225, s[20:23], s7 offen sc1
  v_mfma_f32_16x16x32_bf16 v[124:127], v[188:191], v[156:159], v[124:127]
  v_pk_mul_f32 v[96:97], v[96:97], s[34:35]
  v_pk_mul_f32 v[98:99], v[98:99], s[34:35]
  s_waitcnt lgkmcnt(0)
  v_mfma_f32_16x16x32_bf16 v[16:19], v[160:163], v[128:131], v[16:19]
  ds_read_b128 v[144:147], v217 offset:0
  v_pk_mul_f32 v[100:101], v[100:101], s[34:35]
  v_mfma_f32_16x16x32_bf16 v[20:23], v[164:167], v[128:131], v[20:23]
  ds_read_b64_tr_b16 v[176:177], v218 offset:17408
  v_pk_mul_f32 v[102:103], v[102:103], s[34:35]
  v_mfma_f32_16x16x32_bf16 v[24:27], v[168:171], v[128:131], v[24:27]
  ds_read_b64_tr_b16 v[178:179], v218 offset:17920
  v_cvt_pk_bf16_f32 v96, v96, v97
  v_mfma_f32_16x16x32_bf16 v[28:31], v[172:175], v[128:131], v[28:31]
  ds_read_b128 v[148:151], v217 offset:2048
  v_cvt_pk_bf16_f32 v97, v98, v99
  v_mfma_f32_16x16x32_bf16 v[48:51], v[160:163], v[132:135], v[48:51]
  ds_read_b64_tr_b16 v[180:181], v219 offset:17408
  v_cvt_pk_bf16_f32 v98, v100, v101
  v_mfma_f32_16x16x32_bf16 v[52:55], v[164:167], v[132:135], v[52:55]
  ds_read_b64_tr_b16 v[182:183], v219 offset:17920
  v_cvt_pk_bf16_f32 v99, v102, v103
  v_mfma_f32_16x16x32_bf16 v[56:59], v[168:171], v[132:135], v[56:59]
  ds_read_b128 v[152:155], v217 offset:4096
  s_add_u32 s33, s7, s37
  v_mfma_f32_16x16x32_bf16 v[60:63], v[172:175], v[132:135], v[60:63]
  ds_read_b64_tr_b16 v[184:185], v220 offset:17408
  buffer_store_dwordx4 v[96:99], v225, s[20:23], s33 offen sc1
  v_mfma_f32_16x16x32_bf16 v[80:83], v[160:163], v[136:139], v[80:83]
  ds_read_b64_tr_b16 v[186:187], v220 offset:17920
  v_pk_mul_f32 v[72:73], v[72:73], s[34:35]
  v_mfma_f32_16x16x32_bf16 v[84:87], v[164:167], v[136:139], v[84:87]
  ds_read_b128 v[156:159], v217 offset:6144
  v_pk_mul_f32 v[74:75], v[74:75], s[34:35]
  v_mfma_f32_16x16x32_bf16 v[88:91], v[168:171], v[136:139], v[88:91]
  ds_read_b64_tr_b16 v[188:189], v221 offset:17408
  v_pk_mul_f32 v[76:77], v[76:77], s[34:35]
  v_mfma_f32_16x16x32_bf16 v[92:95], v[172:175], v[136:139], v[92:95]
  ds_read_b64_tr_b16 v[190:191], v221 offset:17920
  v_pk_mul_f32 v[78:79], v[78:79], s[34:35]
  v_mfma_f32_16x16x32_bf16 v[112:115], v[160:163], v[140:143], v[112:115]
  v_cvt_pk_bf16_f32 v72, v72, v73
  v_mfma_f32_16x16x32_bf16 v[116:119], v[164:167], v[140:143], v[116:119]
  v_cvt_pk_bf16_f32 v73, v74, v75
  v_mfma_f32_16x16x32_bf16 v[120:123], v[168:171], v[140:143], v[120:123]
  v_cvt_pk_bf16_f32 v74, v76, v77
  v_mfma_f32_16x16x32_bf16 v[124:127], v[172:175], v[140:143], v[124:127]
  v_cvt_pk_bf16_f32 v75, v78, v79
  s_waitcnt lgkmcnt(0)
  v_mfma_f32_16x16x32_bf16 v[16:19], v[176:179], v[144:147], v[16:19]
  s_mul_i32 s7, s31, 1
  v_mfma_f32_16x16x32_bf16 v[20:23], v[180:183], v[144:147], v[20:23]
  s_add_u32 s7, s7, s30
  v_mfma_f32_16x16x32_bf16 v[24:27], v[184:187], v[144:147], v[24:27]
  s_add_u32 s7, s7, s32
  v_mfma_f32_16x16x32_bf16 v[28:31], v[188:191], v[144:147], v[28:31]
  buffer_store_dwordx4 v[72:75], v225, s[20:23], s7 offen sc1
  v_mfma_f32_16x16x32_bf16 v[48:51], v[176:179], v[148:151], v[48:51]
  v_pk_mul_f32 v[104:105], v[104:105], s[34:35]
  v_mfma_f32_16x16x32_bf16 v[52:55], v[180:183], v[148:151], v[52:55]
  v_pk_mul_f32 v[106:107], v[106:107], s[34:35]
  v_mfma_f32_16x16x32_bf16 v[56:59], v[184:187], v[148:151], v[56:59]
  v_pk_mul_f32 v[108:109], v[108:109], s[34:35]
  v_mfma_f32_16x16x32_bf16 v[60:63], v[188:191], v[148:151], v[60:63]
  v_pk_mul_f32 v[110:111], v[110:111], s[34:35]
  v_mfma_f32_16x16x32_bf16 v[80:83], v[176:179], v[152:155], v[80:83]
  v_cvt_pk_bf16_f32 v104, v104, v105
  v_mfma_f32_16x16x32_bf16 v[84:87], v[180:183], v[152:155], v[84:87]
  v_cvt_pk_bf16_f32 v105, v106, v107
  v_mfma_f32_16x16x32_bf16 v[88:91], v[184:187], v[152:155], v[88:91]
  v_cvt_pk_bf16_f32 v106, v108, v109
  v_mfma_f32_16x16x32_bf16 v[92:95], v[188:191], v[152:155], v[92:95]
  v_cvt_pk_bf16_f32 v107, v110, v111
  v_mfma_f32_16x16x32_bf16 v[112:115], v[176:179], v[156:159], v[112:115]
  s_add_u32 s33, s7, s37
  v_mfma_f32_16x16x32_bf16 v[116:119], v[180:183], v[156:159], v[116:119]
  buffer_store_dwordx4 v[104:107], v225, s[20:23], s33 offen sc1
  v_mfma_f32_16x16x32_bf16 v[120:123], v[184:187], v[156:159], v[120:123]
  v_mfma_f32_16x16x32_bf16 v[124:127], v[188:191], v[156:159], v[124:127]
  s_nop 7
  v_pk_mul_f32 v[16:17], v[16:17], s[34:35]
  v_pk_mul_f32 v[18:19], v[18:19], s[34:35]
  v_pk_mul_f32 v[20:21], v[20:21], s[34:35]
  v_pk_mul_f32 v[22:23], v[22:23], s[34:35]
  v_cvt_pk_bf16_f32 v16, v16, v17
  v_cvt_pk_bf16_f32 v17, v18, v19
  v_cvt_pk_bf16_f32 v18, v20, v21
  v_cvt_pk_bf16_f32 v19, v22, v23
  s_mul_i32 s7, s31, 2
  s_add_u32 s7, s7, s30
  buffer_store_dwordx4 v[16:19], v225, s[20:23], s7 offen sc1
  v_pk_mul_f32 v[48:49], v[48:49], s[34:35]
  v_pk_mul_f32 v[50:51], v[50:51], s[34:35]
  v_pk_mul_f32 v[52:53], v[52:53], s[34:35]
  v_pk_mul_f32 v[54:55], v[54:55], s[34:35]
  v_cvt_pk_bf16_f32 v48, v48, v49
  v_cvt_pk_bf16_f32 v49, v50, v51
  v_cvt_pk_bf16_f32 v50, v52, v53
  v_cvt_pk_bf16_f32 v51, v54, v55
  s_add_u32 s33, s7, s37
  buffer_store_dwordx4 v[48:51], v225, s[20:23], s33 offen sc1
  v_pk_mul_f32 v[24:25], v[24:25], s[34:35]
  v_pk_mul_f32 v[26:27], v[26:27], s[34:35]
  v_pk_mul_f32 v[28:29], v[28:29], s[34:35]
  v_pk_mul_f32 v[30:31], v[30:31], s[34:35]
  v_cvt_pk_bf16_f32 v24, v24, v25
  v_cvt_pk_bf16_f32 v25, v26, v27
  v_cvt_pk_bf16_f32 v26, v28, v29
  v_cvt_pk_bf16_f32 v27, v30, v31
  s_mul_i32 s7, s31, 3
  s_add_u32 s7, s7, s30
  buffer_store_dwordx4 v[24:27], v225, s[20:23], s7 offen sc1
  v_pk_mul_f32 v[56:57], v[56:57], s[34:35]
  v_pk_mul_f32 v[58:59], v[58:59], s[34:35]
  v_pk_mul_f32 v[60:61], v[60:61], s[34:35]
  v_pk_mul_f32 v[62:63], v[62:63], s[34:35]
  v_cvt_pk_bf16_f32 v56, v56, v57
  v_cvt_pk_bf16_f32 v57, v58, v59
  v_cvt_pk_bf16_f32 v58, v60, v61
  v_cvt_pk_bf16_f32 v59, v62, v63
  s_add_u32 s33, s7, s37
  buffer_store_dwordx4 v[56:59], v225, s[20:23], s33 offen sc1
  v_pk_mul_f32 v[80:81], v[80:81], s[34:35]
  v_pk_mul_f32 v[82:83], v[82:83], s[34:35]
  v_pk_mul_f32 v[84:85], v[84:85], s[34:35]
  v_pk_mul_f32 v[86:87], v[86:87], s[34:35]
  v_cvt_pk_bf16_f32 v80, v80, v81
  v_cvt_pk_bf16_f32 v81, v82, v83
  v_cvt_pk_bf16_f32 v82, v84, v85
  v_cvt_pk_bf16_f32 v83, v86, v87
  s_mul_i32 s7, s31, 2
  s_add_u32 s7, s7, s30
  s_add_u32 s7, s7, s32
  buffer_store_dwordx4 v[80:83], v225, s[20:23], s7 offen sc1
  v_pk_mul_f32 v[112:113], v[112:113], s[34:35]
  v_pk_mul_f32 v[114:115], v[114:115], s[34:35]
  v_pk_mul_f32 v[116:117], v[116:117], s[34:35]
  v_pk_mul_f32 v[118:119], v[118:119], s[34:35]
  v_cvt_pk_bf16_f32 v112, v112, v113
  v_cvt_pk_bf16_f32 v113, v114, v115
  v_cvt_pk_bf16_f32 v114, v116, v117
  v_cvt_pk_bf16_f32 v115, v118, v119
  s_add_u32 s33, s7, s37
  buffer_store_dwordx4 v[112:115], v225, s[20:23], s33 offen sc1
  v_pk_mul_f32 v[88:89], v[88:89], s[34:35]
  v_pk_mul_f32 v[90:91], v[90:91], s[34:35]
  v_pk_mul_f32 v[92:93], v[92:93], s[34:35]
  v_pk_mul_f32 v[94:95], v[94:95], s[34:35]
  v_cvt_pk_bf16_f32 v88, v88, v89
  v_cvt_pk_bf16_f32 v89, v90, v91
  v_cvt_pk_bf16_f32 v90, v92, v93
  v_cvt_pk_bf16_f32 v91, v94, v95
  s_mul_i32 s7, s31, 3
  s_add_u32 s7, s7, s30
  s_add_u32 s7, s7, s32
  buffer_store_dwordx4 v[88:91], v225, s[20:23], s7 offen sc1
  v_pk_mul_f32 v[120:121], v[120:121], s[34:35]
  v_pk_mul_f32 v[122:123], v[122:123], s[34:35]
  v_pk_mul_f32 v[124:125], v[124:125], s[34:35]
  v_pk_mul_f32 v[126:127], v[126:127], s[34:35]
  v_cvt_pk_bf16_f32 v120, v120, v121
  v_cvt_pk_bf16_f32 v121, v122, v123
  v_cvt_pk_bf16_f32 v122, v124, v125
  v_cvt_pk_bf16_f32 v123, v126, v127
  s_add_u32 s33, s7, s37
  buffer_store_dwordx4 v[120:123], v225, s[20:23], s33 offen sc1
  s_endpgm
p1_c_V:
  s_lshl_b32 s7, s6, 3
  s_lshl_b32 s33, s25, 2
  s_add_u32 s7, s7, s33
  s_lshl_b32 s33, s5, 2
  s_lshl_b32 s36, s24, 1
  s_add_u32 s33, s33, s36
  s_mov_b32 s31, 262144
  s_mov_b32 s32, 4096
  s_mov_b32 s36, 4196352
  s_mov_b32 s34, 0x3e8293ee
  s_mov_b32 s35, s34
  s_mul_i32 s7, s7, s31
  s_mul_i32 s33, s33, s32
  s_add_u32 s30, s7, s33
  s_add_u32 s30, s30, s36
  s_mov_b32 s28, 14
  s_waitcnt lgkmcnt(0)
  s_barrier
  ds_read_b128 v[128:131], v216 offset:0
  ds_read_b64_tr_b16 v[160:161], v218 offset:0
  ds_read_b64_tr_b16 v[162:163], v218 offset:512
  ds_read_b128 v[132:135], v216 offset:2048
  ds_read_b64_tr_b16 v[164:165], v219 offset:0
  ds_read_b64_tr_b16 v[166:167], v219 offset:512
  ds_read_b128 v[136:139], v216 offset:4096
  ds_read_b64_tr_b16 v[168:169], v220 offset:0
  ds_read_b64_tr_b16 v[170:171], v220 offset:512
  ds_read_b128 v[140:143], v216 offset:6144
  ds_read_b64_tr_b16 v[172:173], v221 offset:0
  ds_read_b64_tr_b16 v[174:175], v221 offset:512
  .p2align 6
p1_c_V_loop:
  s_waitcnt lgkmcnt(0)
  v_mfma_f32_16x16x32_bf16 v[0:3], v[128:131], v[160:163], v[0:3]
  ds_read_b64_tr_b16 v[176:177], v218 offset:1024
  v_mfma_f32_16x16x32_bf16 v[4:7], v[128:131], v[164:167], v[4:7]
  ds_read_b64_tr_b16 v[178:179], v218 offset:1536
  v_mfma_f32_16x16x32_bf16 v[8:11], v[128:131], v[168:171], v[8:11]
  ds_read_b64_tr_b16 v[180:181], v219 offset:1024
  v_mfma_f32_16x16x32_bf16 v[12:15], v[128:131], v[172:175], v[12:15]
  ds_read_b64_tr_b16 v[182:183], v219 offset:1536
  v_mfma_f32_16x16x32_bf16 v[32:35], v[132:135], v[160:163], v[32:35]
  ds_read_b128 v[144:147], v217 offset:0
  v_mfma_f32_16x16x32_bf16 v[36:39], v[132:135], v[164:167], v[36:39]
  ds_read_b64_tr_b16 v[184:185], v220 offset:1024
  v_mfma_f32_16x16x32_bf16 v[40:43], v[132:135], v[168:171], v[40:43]
  ds_read_b64_tr_b16 v[186:187], v220 offset:1536
  v_mfma_f32_16x16x32_bf16 v[44:47], v[132:135], v[172:175], v[44:47]
  ds_read_b64_tr_b16 v[188:189], v221 offset:1024
  v_mfma_f32_16x16x32_bf16 v[64:67], v[136:139], v[160:163], v[64:67]
  ds_read_b64_tr_b16 v[190:191], v221 offset:1536
  v_mfma_f32_16x16x32_bf16 v[68:71], v[136:139], v[164:167], v[68:71]
  ds_read_b128 v[148:151], v217 offset:2048
  v_mfma_f32_16x16x32_bf16 v[72:75], v[136:139], v[168:171], v[72:75]
  v_mfma_f32_16x16x32_bf16 v[76:79], v[136:139], v[172:175], v[76:79]
  v_mfma_f32_16x16x32_bf16 v[96:99], v[140:143], v[160:163], v[96:99]
  v_mfma_f32_16x16x32_bf16 v[100:103], v[140:143], v[164:167], v[100:103]
  v_mfma_f32_16x16x32_bf16 v[104:107], v[140:143], v[168:171], v[104:107]
  s_add_u32 s26, s26, 1
  s_cmp_eq_u32 s26, 3
  v_mfma_f32_16x16x32_bf16 v[108:111], v[140:143], v[172:175], v[108:111]
  s_cselect_b32 s27, s50, s51
  s_cselect_b32 s26, 0, s26
  s_waitcnt lgkmcnt(0)
  v_mfma_f32_16x16x32_bf16 v[16:19], v[128:131], v[176:179], v[16:19]
  ds_read_b64_tr_b16 v[160:161], v218 offset:16384
  v_mfma_f32_16x16x32_bf16 v[20:23], v[128:131], v[180:183], v[20:23]
  ds_read_b64_tr_b16 v[162:163], v218 offset:16896
  v_mfma_f32_16x16x32_bf16 v[24:27], v[128:131], v[184:187], v[24:27]
  ds_read_b64_tr_b16 v[164:165], v219 offset:16384
  v_mfma_f32_16x16x32_bf16 v[28:31], v[128:131], v[188:191], v[28:31]
  ds_read_b64_tr_b16 v[166:167], v219 offset:16896
  v_mfma_f32_16x16x32_bf16 v[48:51], v[132:135], v[176:179], v[48:51]
  ds_read_b128 v[152:155], v217 offset:4096
  v_mfma_f32_16x16x32_bf16 v[52:55], v[132:135], v[180:183], v[52:55]
  ds_read_b64_tr_b16 v[168:169], v220 offset:16384
  v_mfma_f32_16x16x32_bf16 v[56:59], v[132:135], v[184:187], v[56:59]
  ds_read_b64_tr_b16 v[170:171], v220 offset:16896
  v_mfma_f32_16x16x32_bf16 v[60:63], v[132:135], v[188:191], v[60:63]
  ds_read_b64_tr_b16 v[172:173], v221 offset:16384
  v_mfma_f32_16x16x32_bf16 v[80:83], v[136:139], v[176:179], v[80:83]
  ds_read_b64_tr_b16 v[174:175], v221 offset:16896
  v_mfma_f32_16x16x32_bf16 v[84:87], v[136:139], v[180:183], v[84:87]
  ds_read_b128 v[156:159], v217 offset:6144
  v_mfma_f32_16x16x32_bf16 v[88:91], v[136:139], v[184:187], v[88:91]
  v_mfma_f32_16x16x32_bf16 v[92:95], v[136:139], v[188:191], v[92:95]
  v_mfma_f32_16x16x32_bf16 v[112:115], v[140:143], v[176:179], v[112:115]
  v_mfma_f32_16x16x32_bf16 v[116:119], v[140:143], v[180:183], v[116:119]
  v_mfma_f32_16x16x32_bf16 v[120:123], v[140:143], v[184:187], v[120:123]
  v_mfma_f32_16x16x32_bf16 v[124:127], v[140:143], v[188:191], v[124:127]
  s_waitcnt lgkmcnt(0)
  v_mfma_f32_16x16x32_bf16 v[0:3], v[144:147], v[160:163], v[0:3]
  ds_read_b64_tr_b16 v[176:177], v218 offset:17408
  v_mfma_f32_16x16x32_bf16 v[4:7], v[144:147], v[164:167], v[4:7]
  ds_read_b64_tr_b16 v[178:179], v218 offset:17920
  v_mfma_f32_16x16x32_bf16 v[8:11], v[144:147], v[168:171], v[8:11]
  ds_read_b64_tr_b16 v[180:181], v219 offset:17408
  v_mfma_f32_16x16x32_bf16 v[12:15], v[144:147], v[172:175], v[12:15]
  ds_read_b64_tr_b16 v[182:183], v219 offset:17920
  v_mfma_f32_16x16x32_bf16 v[32:35], v[148:151], v[160:163], v[32:35]
  ds_read_b64_tr_b16 v[184:185], v220 offset:17408
  v_mfma_f32_16x16x32_bf16 v[36:39], v[148:151], v[164:167], v[36:39]
  ds_read_b64_tr_b16 v[186:187], v220 offset:17920
  v_mfma_f32_16x16x32_bf16 v[40:43], v[148:151], v[168:171], v[40:43]
  ds_read_b64_tr_b16 v[188:189], v221 offset:17408
  v_mfma_f32_16x16x32_bf16 v[44:47], v[148:151], v[172:175], v[44:47]
  ds_read_b64_tr_b16 v[190:191], v221 offset:17920
  v_mfma_f32_16x16x32_bf16 v[64:67], v[152:155], v[160:163], v[64:67]
  v_mfma_f32_16x16x32_bf16 v[68:71], v[152:155], v[164:167], v[68:71]
  v_mfma_f32_16x16x32_bf16 v[72:75], v[152:155], v[168:171], v[72:75]
  v_mfma_f32_16x16x32_bf16 v[76:79], v[152:155], v[172:175], v[76:79]
  v_mfma_f32_16x16x32_bf16 v[96:99], v[156:159], v[160:163], v[96:99]
  v_mfma_f32_16x16x32_bf16 v[100:103], v[156:159], v[164:167], v[100:103]
  v_mfma_f32_16x16x32_bf16 v[104:107], v[156:159], v[168:171], v[104:107]
  v_mfma_f32_16x16x32_bf16 v[108:111], v[156:159], v[172:175], v[108:111]
  s_waitcnt lgkmcnt(0)
  s_barrier
  v_mfma_f32_16x16x32_bf16 v[16:19], v[144:147], v[176:179], v[16:19]
  v_add_u32 v216, s27, v216
  v_add_u32 v218, s27, v218
  v_mfma_f32_16x16x32_bf16 v[20:23], v[144:147], v[180:183], v[20:23]
  ds_read_b128 v[128:131], v216 offset:0
  ds_read_b64_tr_b16 v[160:161], v218 offset:0
  v_mfma_f32_16x16x32_bf16 v[24:27], v[144:147], v[184:187], v[24:27]
  ds_read_b64_tr_b16 v[162:163], v218 offset:512
  v_add_u32 v219, s27, v219
  v_mfma_f32_16x16x32_bf16 v[28:31], v[144:147], v[188:191], v[28:31]
  ds_read_b128 v[132:135], v216 offset:2048
  ds_read_b64_tr_b16 v[164:165], v219 offset:0
  v_mfma_f32_16x16x32_bf16 v[48:51], v[148:151], v[176:179], v[48:51]
  ds_read_b64_tr_b16 v[166:167], v219 offset:512
  v_add_u32 v220, s27, v220
  v_mfma_f32_16x16x32_bf16 v[52:55], v[148:151], v[180:183], v[52:55]
  ds_read_b128 v[136:139], v216 offset:4096
  ds_read_b64_tr_b16 v[168:169], v220 offset:0
  v_mfma_f32_16x16x32_bf16 v[56:59], v[148:151], v[184:187], v[56:59]
  ds_read_b64_tr_b16 v[170:171], v220 offset:512
  v_add_u32 v221, s27, v221
  v_mfma_f32_16x16x32_bf16 v[60:63], v[148:151], v[188:191], v[60:63]
  ds_read_b128 v[140:143], v216 offset:6144
  ds_read_b64_tr_b16 v[172:173], v221 offset:0
  v_mfma_f32_16x16x32_bf16 v[80:83], v[152:155], v[176:179], v[80:83]
  ds_read_b64_tr_b16 v[174:175], v221 offset:512
  v_mfma_f32_16x16x32_bf16 v[84:87], v[152:155], v[180:183], v[84:87]
  v_add_u32 v217, s27, v217
  v_mfma_f32_16x16x32_bf16 v[88:91], v[152:155], v[184:187], v[88:91]
  s_sub_u32 s28, s28, 1
  v_mfma_f32_16x16x32_bf16 v[92:95], v[152:155], v[188:191], v[92:95]
  s_cmp_lg_u32 s28, 0
  v_mfma_f32_16x16x32_bf16 v[112:115], v[156:159], v[176:179], v[112:115]
  v_mfma_f32_16x16x32_bf16 v[116:119], v[156:159], v[180:183], v[116:119]
  v_mfma_f32_16x16x32_bf16 v[120:123], v[156:159], v[184:187], v[120:123]
  v_mfma_f32_16x16x32_bf16 v[124:127], v[156:159], v[188:191], v[124:127]
  s_cbranch_scc1 p1_c_V_loop
  s_waitcnt lgkmcnt(0)
  v_mfma_f32_16x16x32_bf16 v[0:3], v[128:131], v[160:163], v[0:3]
  ds_read_b128 v[144:147], v217 offset:0
  v_mfma_f32_16x16x32_bf16 v[4:7], v[128:131], v[164:167], v[4:7]
  ds_read_b64_tr_b16 v[176:177], v218 offset:16384
  v_mfma_f32_16x16x32_bf16 v[8:11], v[128:131], v[168:171], v[8:11]
  ds_read_b64_tr_b16 v[178:179], v218 offset:16896
  v_mfma_f32_16x16x32_bf16 v[12:15], v[128:131], v[172:175], v[12:15]
  ds_read_b128 v[148:151], v217 offset:2048
  v_mfma_f32_16x16x32_bf16 v[32:35], v[132:135], v[160:163], v[32:35]
  ds_read_b64_tr_b16 v[180:181], v219 offset:16384
  v_mfma_f32_16x16x32_bf16 v[36:39], v[132:135], v[164:167], v[36:39]
  ds_read_b64_tr_b16 v[182:183], v219 offset:16896
  v_mfma_f32_16x16x32_bf16 v[40:43], v[132:135], v[168:171], v[40:43]
  ds_read_b128 v[152:155], v217 offset:4096
  v_mfma_f32_16x16x32_bf16 v[44:47], v[132:135], v[172:175], v[44:47]
  ds_read_b64_tr_b16 v[184:185], v220 offset:16384
  v_mfma_f32_16x16x32_bf16 v[64:67], v[136:139], v[160:163], v[64:67]
  ds_read_b64_tr_b16 v[186:187], v220 offset:16896
  v_mfma_f32_16x16x32_bf16 v[68:71], v[136:139], v[164:167], v[68:71]
  ds_read_b128 v[156:159], v217 offset:6144
  v_mfma_f32_16x16x32_bf16 v[72:75], v[136:139], v[168:171], v[72:75]
  ds_read_b64_tr_b16 v[188:189], v221 offset:16384
  v_add_u32 v235, 0xfffe6000, v221
  v_mfma_f32_16x16x32_bf16 v[76:79], v[136:139], v[172:175], v[76:79]
  ds_read_b64_tr_b16 v[190:191], v221 offset:16896
  v_add_u32 v234, 0xfffe6000, v220
  v_mfma_f32_16x16x32_bf16 v[96:99], v[140:143], v[160:163], v[96:99]
  v_add_u32 v233, 0xfffe6000, v219
  v_mfma_f32_16x16x32_bf16 v[100:103], v[140:143], v[164:167], v[100:103]
  v_add_u32 v232, 0xfffe6000, v218
  v_mfma_f32_16x16x32_bf16 v[104:107], v[140:143], v[168:171], v[104:107]
  v_add_u32 v231, 0xfffe6000, v217
  v_mfma_f32_16x16x32_bf16 v[108:111], v[140:143], v[172:175], v[108:111]
  v_add_u32 v230, 0xfffe6000, v216
  s_waitcnt lgkmcnt(0)
  s_barrier
  v_mfma_f32_16x16x32_bf16 v[0:3], v[144:147], v[176:179], v[0:3]
  ds_read_b128 v[128:131], v230 offset:0
  v_mfma_f32_16x16x32_bf16 v[4:7], v[144:147], v[180:183], v[4:7]
  ds_read_b64_tr_b16 v[160:161], v232 offset:0
  v_mfma_f32_16x16x32_bf16 v[8:11], v[144:147], v[184:187], v[8:11]
  ds_read_b64_tr_b16 v[162:163], v232 offset:512
  v_mfma_f32_16x16x32_bf16 v[12:15], v[144:147], v[188:191], v[12:15]
  ds_read_b128 v[132:135], v230 offset:2048
  v_mfma_f32_16x16x32_bf16 v[32:35], v[148:151], v[176:179], v[32:35]
  ds_read_b64_tr_b16 v[164:165], v233 offset:0
  v_mfma_f32_16x16x32_bf16 v[36:39], v[148:151], v[180:183], v[36:39]
  ds_read_b64_tr_b16 v[166:167], v233 offset:512
  v_mfma_f32_16x16x32_bf16 v[40:43], v[148:151], v[184:187], v[40:43]
  ds_read_b128 v[136:139], v230 offset:4096
  v_mfma_f32_16x16x32_bf16 v[44:47], v[148:151], v[188:191], v[44:47]
  ds_read_b64_tr_b16 v[168:169], v234 offset:0
  v_mfma_f32_16x16x32_bf16 v[64:67], v[152:155], v[176:179], v[64:67]
  ds_read_b64_tr_b16 v[170:171], v234 offset:512
  v_mfma_f32_16x16x32_bf16 v[68:71], v[152:155], v[180:183], v[68:71]
  ds_read_b128 v[140:143], v230 offset:6144
  v_mfma_f32_16x16x32_bf16 v[72:75], v[152:155], v[184:187], v[72:75]
  ds_read_b64_tr_b16 v[172:173], v235 offset:0
  v_mfma_f32_16x16x32_bf16 v[76:79], v[152:155], v[188:191], v[76:79]
  ds_read_b64_tr_b16 v[174:175], v235 offset:512
  v_mfma_f32_16x16x32_bf16 v[96:99], v[156:159], v[176:179], v[96:99]
  v_mfma_f32_16x16x32_bf16 v[100:103], v[156:159], v[180:183], v[100:103]
  v_mfma_f32_16x16x32_bf16 v[104:107], v[156:159], v[184:187], v[104:107]
  v_mfma_f32_16x16x32_bf16 v[108:111], v[156:159], v[188:191], v[108:111]
  s_waitcnt lgkmcnt(0)
  v_mfma_f32_16x16x32_bf16 v[0:3], v[128:131], v[160:163], v[0:3]
  ds_read_b128 v[144:147], v231 offset:0
  v_mfma_f32_16x16x32_bf16 v[4:7], v[128:131], v[164:167], v[4:7]
  ds_read_b64_tr_b16 v[176:177], v232 offset:16384
  v_mfma_f32_16x16x32_bf16 v[8:11], v[128:131], v[168:171], v[8:11]
  ds_read_b64_tr_b16 v[178:179], v232 offset:16896
  v_mfma_f32_16x16x32_bf16 v[12:15], v[128:131], v[172:175], v[12:15]
  ds_read_b128 v[148:151], v231 offset:2048
  v_mfma_f32_16x16x32_bf16 v[32:35], v[132:135], v[160:163], v[32:35]
  ds_read_b64_tr_b16 v[180:181], v233 offset:16384
  v_mfma_f32_16x16x32_bf16 v[36:39], v[132:135], v[164:167], v[36:39]
  ds_read_b64_tr_b16 v[182:183], v233 offset:16896
  v_mfma_f32_16x16x32_bf16 v[40:43], v[132:135], v[168:171], v[40:43]
  ds_read_b128 v[152:155], v231 offset:4096
  v_mfma_f32_16x16x32_bf16 v[44:47], v[132:135], v[172:175], v[44:47]
  ds_read_b64_tr_b16 v[184:185], v234 offset:16384
  v_mfma_f32_16x16x32_bf16 v[64:67], v[136:139], v[160:163], v[64:67]
  ds_read_b64_tr_b16 v[186:187], v234 offset:16896
  v_mfma_f32_16x16x32_bf16 v[68:71], v[136:139], v[164:167], v[68:71]
  ds_read_b128 v[156:159], v231 offset:6144
  v_mfma_f32_16x16x32_bf16 v[72:75], v[136:139], v[168:171], v[72:75]
  ds_read_b64_tr_b16 v[188:189], v235 offset:16384
  v_mfma_f32_16x16x32_bf16 v[76:79], v[136:139], v[172:175], v[76:79]
  ds_read_b64_tr_b16 v[190:191], v235 offset:16896
  v_mfma_f32_16x16x32_bf16 v[96:99], v[140:143], v[160:163], v[96:99]
  v_mfma_f32_16x16x32_bf16 v[100:103], v[140:143], v[164:167], v[100:103]
  v_mfma_f32_16x16x32_bf16 v[104:107], v[140:143], v[168:171], v[104:107]
  v_mfma_f32_16x16x32_bf16 v[108:111], v[140:143], v[172:175], v[108:111]
  s_waitcnt lgkmcnt(0)
  v_mfma_f32_16x16x32_bf16 v[0:3], v[144:147], v[176:179], v[0:3]
  ds_read_b64_tr_b16 v[160:161], v232 offset:1024
  v_mfma_f32_16x16x32_bf16 v[4:7], v[144:147], v[180:183], v[4:7]
  ds_read_b64_tr_b16 v[162:163], v232 offset:1536
  v_mfma_f32_16x16x32_bf16 v[8:11], v[144:147], v[184:187], v[8:11]
  ds_read_b64_tr_b16 v[164:165], v233 offset:1024
  v_mfma_f32_16x16x32_bf16 v[12:15], v[144:147], v[188:191], v[12:15]
  ds_read_b64_tr_b16 v[166:167], v233 offset:1536
  v_mfma_f32_16x16x32_bf16 v[32:35], v[148:151], v[176:179], v[32:35]
  ds_read_b64_tr_b16 v[168:169], v234 offset:1024
  v_mfma_f32_16x16x32_bf16 v[36:39], v[148:151], v[180:183], v[36:39]
  ds_read_b64_tr_b16 v[170:171], v234 offset:1536
  v_mfma_f32_16x16x32_bf16 v[40:43], v[148:151], v[184:187], v[40:43]
  ds_read_b64_tr_b16 v[172:173], v235 offset:1024
  v_mfma_f32_16x16x32_bf16 v[44:47], v[148:151], v[188:191], v[44:47]
  ds_read_b64_tr_b16 v[174:175], v235 offset:1536
  v_mfma_f32_16x16x32_bf16 v[64:67], v[152:155], v[176:179], v[64:67]
  v_mfma_f32_16x16x32_bf16 v[68:71], v[152:155], v[180:183], v[68:71]
  v_mfma_f32_16x16x32_bf16 v[72:75], v[152:155], v[184:187], v[72:75]
  v_mfma_f32_16x16x32_bf16 v[76:79], v[152:155], v[188:191], v[76:79]
  v_mfma_f32_16x16x32_bf16 v[96:99], v[156:159], v[176:179], v[96:99]
  v_mfma_f32_16x16x32_bf16 v[100:103], v[156:159], v[180:183], v[100:103]
  v_mfma_f32_16x16x32_bf16 v[104:107], v[156:159], v[184:187], v[104:107]
  v_mfma_f32_16x16x32_bf16 v[108:111], v[156:159], v[188:191], v[108:111]
  s_waitcnt lgkmcnt(0)
  v_mfma_f32_16x16x32_bf16 v[16:19], v[128:131], v[160:163], v[16:19]
  ds_read_b64_tr_b16 v[176:177], v232 offset:17408
  v_mfma_f32_16x16x32_bf16 v[20:23], v[128:131], v[164:167], v[20:23]
  ds_read_b64_tr_b16 v[178:179], v232 offset:17920
  v_mfma_f32_16x16x32_bf16 v[24:27], v[128:131], v[168:171], v[24:27]
  ds_read_b64_tr_b16 v[180:181], v233 offset:17408
  v_mfma_f32_16x16x32_bf16 v[28:31], v[128:131], v[172:175], v[28:31]
  ds_read_b64_tr_b16 v[182:183], v233 offset:17920
  v_mfma_f32_16x16x32_bf16 v[48:51], v[132:135], v[160:163], v[48:51]
  ds_read_b64_tr_b16 v[184:185], v234 offset:17408
  v_cvt_pk_bf16_f32 v0, v0, v1
  v_mfma_f32_16x16x32_bf16 v[52:55], v[132:135], v[164:167], v[52:55]
  ds_read_b64_tr_b16 v[186:187], v234 offset:17920
  v_cvt_pk_bf16_f32 v1, v2, v3
  v_mfma_f32_16x16x32_bf16 v[56:59], v[132:135], v[168:171], v[56:59]
  ds_read_b64_tr_b16 v[188:189], v235 offset:17408
  v_cvt_pk_bf16_f32 v2, v32, v33
  v_mfma_f32_16x16x32_bf16 v[60:63], v[132:135], v[172:175], v[60:63]
  ds_read_b64_tr_b16 v[190:191], v235 offset:17920
  v_cvt_pk_bf16_f32 v3, v34, v35
  v_mfma_f32_16x16x32_bf16 v[80:83], v[136:139], v[160:163], v[80:83]
  s_mul_i32 s7, s31, 0
  v_mfma_f32_16x16x32_bf16 v[84:87], v[136:139], v[164:167], v[84:87]
  s_add_u32 s7, s7, s30
  v_mfma_f32_16x16x32_bf16 v[88:91], v[136:139], v[168:171], v[88:91]
  buffer_store_dwordx4 v[0:3], v224, s[20:23], s7 offen offset:0 sc1
  v_mfma_f32_16x16x32_bf16 v[92:95], v[136:139], v[172:175], v[92:95]
  v_cvt_pk_bf16_f32 v4, v4, v5
  v_mfma_f32_16x16x32_bf16 v[112:115], v[140:143], v[160:163], v[112:115]
  v_cvt_pk_bf16_f32 v5, v6, v7
  v_mfma_f32_16x16x32_bf16 v[116:119], v[140:143], v[164:167], v[116:119]
  v_cvt_pk_bf16_f32 v6, v36, v37
  v_mfma_f32_16x16x32_bf16 v[120:123], v[140:143], v[168:171], v[120:123]
  v_cvt_pk_bf16_f32 v7, v38, v39
  v_mfma_f32_16x16x32_bf16 v[124:127], v[140:143], v[172:175], v[124:127]
  buffer_store_dwordx4 v[4:7], v224, s[20:23], s7 offen offset:256 sc1
  s_waitcnt lgkmcnt(0)
  v_mfma_f32_16x16x32_bf16 v[16:19], v[144:147], v[176:179], v[16:19]
  ds_read_b128 v[128:131], v216 offset:0
  v_cvt_pk_bf16_f32 v8, v8, v9
  v_mfma_f32_16x16x32_bf16 v[20:23], v[144:147], v[180:183], v[20:23]
  ds_read_b64_tr_b16 v[160:161], v218 offset:1024
  v_cvt_pk_bf16_f32 v9, v10, v11
  v_mfma_f32_16x16x32_bf16 v[24:27], v[144:147], v[184:187], v[24:27]
  ds_read_b64_tr_b16 v[162:163], v218 offset:1536
  v_cvt_pk_bf16_f32 v10, v40, v41
  v_mfma_f32_16x16x32_bf16 v[28:31], v[144:147], v[188:191], v[28:31]
  ds_read_b128 v[132:135], v216 offset:2048
  v_cvt_pk_bf16_f32 v11, v42, v43
  v_mfma_f32_16x16x32_bf16 v[48:51], v[148:151], v[176:179], v[48:51]
  ds_read_b64_tr_b16 v[164:165], v219 offset:1024
  s_mul_i32 s7, s31, 1
  v_mfma_f32_16x16x32_bf16 v[52:55], v[148:151], v[180:183], v[52:55]
  ds_read_b64_tr_b16 v[166:167], v219 offset:1536
  s_add_u32 s7, s7, s30
  v_mfma_f32_16x16x32_bf16 v[56:59], v[148:151], v[184:187], v[56:59]
  ds_read_b128 v[136:139], v216 offset:4096
  buffer_store_dwordx4 v[8:11], v224, s[20:23], s7 offen offset:0 sc1
  v_mfma_f32_16x16x32_bf16 v[60:63], v[148:151], v[188:191], v[60:63]
  ds_read_b64_tr_b16 v[168:169], v220 offset:1024
  v_cvt_pk_bf16_f32 v12, v12, v13
  v_mfma_f32_16x16x32_bf16 v[80:83], v[152:155], v[176:179], v[80:83]
  ds_read_b64_tr_b16 v[170:171], v220 offset:1536
  v_cvt_pk_bf16_f32 v13, v14, v15
  v_mfma_f32_16x16x32_bf16 v[84:87], v[152:155], v[180:183], v[84:87]
  ds_read_b128 v[140:143], v216 offset:6144
  v_cvt_pk_bf16_f32 v14, v44, v45
  v_mfma_f32_16x16x32_bf16 v[88:91], v[152:155], v[184:187], v[88:91]
  ds_read_b64_tr_b16 v[172:173], v221 offset:1024
  v_cvt_pk_bf16_f32 v15, v46, v47
  v_mfma_f32_16x16x32_bf16 v[92:95], v[152:155], v[188:191], v[92:95]
  ds_read_b64_tr_b16 v[174:175], v221 offset:1536
  buffer_store_dwordx4 v[12:15], v224, s[20:23], s7 offen offset:256 sc1
  v_mfma_f32_16x16x32_bf16 v[112:115], v[156:159], v[176:179], v[112:115]
  v_cvt_pk_bf16_f32 v64, v64, v65
  v_mfma_f32_16x16x32_bf16 v[116:119], v[156:159], v[180:183], v[116:119]
  v_cvt_pk_bf16_f32 v65, v66, v67
  v_mfma_f32_16x16x32_bf16 v[120:123], v[156:159], v[184:187], v[120:123]
  v_cvt_pk_bf16_f32 v66, v96, v97
  v_mfma_f32_16x16x32_bf16 v[124:127], v[156:159], v[188:191], v[124:127]
  v_cvt_pk_bf16_f32 v67, v98, v99
  s_waitcnt lgkmcnt(0)
  v_mfma_f32_16x16x32_bf16 v[16:19], v[128:131], v[160:163], v[16:19]
  ds_read_b128 v[144:147], v217 offset:0
  s_mul_i32 s7, s31, 0
  v_mfma_f32_16x16x32_bf16 v[20:23], v[128:131], v[164:167], v[20:23]
  ds_read_b64_tr_b16 v[176:177], v218 offset:17408
  s_add_u32 s7, s7, s30
  v_mfma_f32_16x16x32_bf16 v[24:27], v[128:131], v[168:171], v[24:27]
  ds_read_b64_tr_b16 v[178:179], v218 offset:17920
  s_add_u32 s7, s7, s32
  v_mfma_f32_16x16x32_bf16 v[28:31], v[128:131], v[172:175], v[28:31]
  ds_read_b128 v[148:151], v217 offset:2048
  buffer_store_dwordx4 v[64:67], v224, s[20:23], s7 offen offset:0 sc1
  v_mfma_f32_16x16x32_bf16 v[48:51], v[132:135], v[160:163], v[48:51]
  ds_read_b64_tr_b16 v[180:181], v219 offset:17408
  v_cvt_pk_bf16_f32 v68, v68, v69
  v_mfma_f32_16x16x32_bf16 v[52:55], v[132:135], v[164:167], v[52:55]
  ds_read_b64_tr_b16 v[182:183], v219 offset:17920
  v_cvt_pk_bf16_f32 v69, v70, v71
  v_mfma_f32_16x16x32_bf16 v[56:59], v[132:135], v[168:171], v[56:59]
  ds_read_b128 v[152:155], v217 offset:4096
  v_cvt_pk_bf16_f32 v70, v100, v101
  v_mfma_f32_16x16x32_bf16 v[60:63], v[132:135], v[172:175], v[60:63]
  ds_read_b64_tr_b16 v[184:185], v220 offset:17408
  v_cvt_pk_bf16_f32 v71, v102, v103
  v_mfma_f32_16x16x32_bf16 v[80:83], v[136:139], v[160:163], v[80:83]
  ds_read_b64_tr_b16 v[186:187], v220 offset:17920
  buffer_store_dwordx4 v[68:71], v224, s[20:23], s7 offen offset:256 sc1
  v_mfma_f32_16x16x32_bf16 v[84:87], v[136:139], v[164:167], v[84:87]
  ds_read_b128 v[156:159], v217 offset:6144
  v_cvt_pk_bf16_f32 v72, v72, v73
  v_mfma_f32_16x16x32_bf16 v[88:91], v[136:139], v[168:171], v[88:91]
  ds_read_b64_tr_b16 v[188:189], v221 offset:17408
  v_cvt_pk_bf16_f32 v73, v74, v75
  v_mfma_f32_16x16x32_bf16 v[92:95], v[136:139], v[172:175], v[92:95]
  ds_read_b64_tr_b16 v[190:191], v221 offset:17920
  v_cvt_pk_bf16_f32 v74, v104, v105
  v_mfma_f32_16x16x32_bf16 v[112:115], v[140:143], v[160:163], v[112:115]
  v_cvt_pk_bf16_f32 v75, v106, v107
  v_mfma_f32_16x16x32_bf16 v[116:119], v[140:143], v[164:167], v[116:119]
  s_mul_i32 s7, s31, 1
  v_mfma_f32_16x16x32_bf16 v[120:123], v[140:143], v[168:171], v[120:123]
  s_add_u32 s7, s7, s30
  v_mfma_f32_16x16x32_bf16 v[124:127], v[140:143], v[172:175], v[124:127]
  s_add_u32 s7, s7, s32
  s_waitcnt lgkmcnt(0)
  v_mfma_f32_16x16x32_bf16 v[16:19], v[144:147], v[176:179], v[16:19]
  buffer_store_dwordx4 v[72:75], v224, s[20:23], s7 offen offset:0 sc1
  v_mfma_f32_16x16x32_bf16 v[20:23], v[144:147], v[180:183], v[20:23]
  v_cvt_pk_bf16_f32 v76, v76, v77
  v_mfma_f32_16x16x32_bf16 v[24:27], v[144:147], v[184:187], v[24:27]
  v_cvt_pk_bf16_f32 v77, v78, v79
  v_mfma_f32_16x16x32_bf16 v[28:31], v[144:147], v[188:191], v[28:31]
  v_cvt_pk_bf16_f32 v78, v108, v109
  v_mfma_f32_16x16x32_bf16 v[48:51], v[148:151], v[176:179], v[48:51]
  v_cvt_pk_bf16_f32 v79, v110, v111
  v_mfma_f32_16x16x32_bf16 v[52:55], v[148:151], v[180:183], v[52:55]
  buffer_store_dwordx4 v[76:79], v224, s[20:23], s7 offen offset:256 sc1
  v_mfma_f32_16x16x32_bf16 v[56:59], v[148:151], v[184:187], v[56:59]
  v_mfma_f32_16x16x32_bf16 v[60:63], v[148:151], v[188:191], v[60:63]
  v_mfma_f32_16x16x32_bf16 v[80:83], v[152:155], v[176:179], v[80:83]
  v_mfma_f32_16x16x32_bf16 v[84:87], v[152:155], v[180:183], v[84:87]
  v_mfma_f32_16x16x32_bf16 v[88:91], v[152:155], v[184:187], v[88:91]
  v_mfma_f32_16x16x32_bf16 v[92:95], v[152:155], v[188:191], v[92:95]
  v_mfma_f32_16x16x32_bf16 v[112:115], v[156:159], v[176:179], v[112:115]
  v_mfma_f32_16x16x32_bf16 v[116:119], v[156:159], v[180:183], v[116:119]
  v_mfma_f32_16x16x32_bf16 v[120:123], v[156:159], v[184:187], v[120:123]
  v_mfma_f32_16x16x32_bf16 v[124:127], v[156:159], v[188:191], v[124:127]
  s_nop 7
  v_cvt_pk_bf16_f32 v16, v16, v17
  v_cvt_pk_bf16_f32 v17, v18, v19
  v_cvt_pk_bf16_f32 v18, v48, v49
  v_cvt_pk_bf16_f32 v19, v50, v51
  s_mul_i32 s7, s31, 2
  s_add_u32 s7, s7, s30
  buffer_store_dwordx4 v[16:19], v224, s[20:23], s7 offen offset:0 sc1
  v_cvt_pk_bf16_f32 v20, v20, v21
  v_cvt_pk_bf16_f32 v21, v22, v23
  v_cvt_pk_bf16_f32 v22, v52, v53
  v_cvt_pk_bf16_f32 v23, v54, v55
  buffer_store_dwordx4 v[20:23], v224, s[20:23], s7 offen offset:256 sc1
  v_cvt_pk_bf16_f32 v24, v24, v25
  v_cvt_pk_bf16_f32 v25, v26, v27
  v_cvt_pk_bf16_f32 v26, v56, v57
  v_cvt_pk_bf16_f32 v27, v58, v59
  s_mul_i32 s7, s31, 3
  s_add_u32 s7, s7, s30
  buffer_store_dwordx4 v[24:27], v224, s[20:23], s7 offen offset:0 sc1
  v_cvt_pk_bf16_f32 v28, v28, v29
  v_cvt_pk_bf16_f32 v29, v30, v31
  v_cvt_pk_bf16_f32 v30, v60, v61
  v_cvt_pk_bf16_f32 v31, v62, v63
  buffer_store_dwordx4 v[28:31], v224, s[20:23], s7 offen offset:256 sc1
  v_cvt_pk_bf16_f32 v80, v80, v81
  v_cvt_pk_bf16_f32 v81, v82, v83
  v_cvt_pk_bf16_f32 v82, v112, v113
  v_cvt_pk_bf16_f32 v83, v114, v115
  s_mul_i32 s7, s31, 2
  s_add_u32 s7, s7, s30
  s_add_u32 s7, s7, s32
  buffer_store_dwordx4 v[80:83], v224, s[20:23], s7 offen offset:0 sc1
  v_cvt_pk_bf16_f32 v84, v84, v85
  v_cvt_pk_bf16_f32 v85, v86, v87
  v_cvt_pk_bf16_f32 v86, v116, v117
  v_cvt_pk_bf16_f32 v87, v118, v119
  buffer_store_dwordx4 v[84:87], v224, s[20:23], s7 offen offset:256 sc1
  v_cvt_pk_bf16_f32 v88, v88, v89
  v_cvt_pk_bf16_f32 v89, v90, v91
  v_cvt_pk_bf16_f32 v90, v120, v121
  v_cvt_pk_bf16_f32 v91, v122, v123
  s_mul_i32 s7, s31, 3
  s_add_u32 s7, s7, s30
  s_add_u32 s7, s7, s32
  buffer_store_dwordx4 v[88:91], v224, s[20:23], s7 offen offset:0 sc1
  v_cvt_pk_bf16_f32 v92, v92, v93
  v_cvt_pk_bf16_f32 v93, v94, v95
  v_cvt_pk_bf16_f32 v94, v124, v125
  v_cvt_pk_bf16_f32 v95, v126, v127
  buffer_store_dwordx4 v[92:95], v224, s[20:23], s7 offen offset:256 sc1
  s_endpgm
p1_c_B0:
  s_lshl_b32 s7, s6, 3
  s_lshl_b32 s33, s25, 2
  s_add_u32 s7, s7, s33
  s_lshl_b32 s33, s5, 2
  s_lshl_b32 s36, s24, 1
  s_add_u32 s33, s33, s36
  s_mov_b32 s31, 131072
  s_mov_b32 s32, 2048
  s_mov_b32 s36, 12582912
  s_mov_b32 s34, 0x3e8293ee
  s_mov_b32 s35, s34
  s_mul_i32 s7, s7, s31
  s_mul_i32 s33, s33, s32
  s_add_u32 s30, s7, s33
  s_add_u32 s30, s30, s36
  s_mov_b32 s28, 14
  s_waitcnt lgkmcnt(0)
  s_barrier
  ds_read_b128 v[128:131], v216 offset:0
  ds_read_b64_tr_b16 v[160:161], v218 offset:0
  ds_read_b64_tr_b16 v[162:163], v218 offset:512
  ds_read_b128 v[132:135], v216 offset:2048
  ds_read_b64_tr_b16 v[164:165], v219 offset:0
  ds_read_b64_tr_b16 v[166:167], v219 offset:512
  ds_read_b128 v[136:139], v216 offset:4096
  ds_read_b64_tr_b16 v[168:169], v220 offset:0
  ds_read_b64_tr_b16 v[170:171], v220 offset:512
  ds_read_b128 v[140:143], v216 offset:6144
  ds_read_b64_tr_b16 v[172:173], v221 offset:0
  ds_read_b64_tr_b16 v[174:175], v221 offset:512
  .p2align 6
p1_c_B0_loop:
  s_waitcnt lgkmcnt(0)
  v_mfma_f32_16x16x32_bf16 v[0:3], v[160:163], v[128:131], v[0:3]
  ds_read_b64_tr_b16 v[176:177], v218 offset:1024
  v_mfma_f32_16x16x32_bf16 v[4:7], v[164:167], v[128:131], v[4:7]
  ds_read_b64_tr_b16 v[178:179], v218 offset:1536
  v_mfma_f32_16x16x32_bf16 v[8:11], v[168:171], v[128:131], v[8:11]
  ds_read_b64_tr_b16 v[180:181], v219 offset:1024
  v_mfma_f32_16x16x32_bf16 v[12:15], v[172:175], v[128:131], v[12:15]
  ds_read_b64_tr_b16 v[182:183], v219 offset:1536
  v_mfma_f32_16x16x32_bf16 v[32:35], v[160:163], v[132:135], v[32:35]
  ds_read_b128 v[144:147], v217 offset:0
  v_mfma_f32_16x16x32_bf16 v[36:39], v[164:167], v[132:135], v[36:39]
  ds_read_b64_tr_b16 v[184:185], v220 offset:1024
  v_mfma_f32_16x16x32_bf16 v[40:43], v[168:171], v[132:135], v[40:43]
  ds_read_b64_tr_b16 v[186:187], v220 offset:1536
  v_mfma_f32_16x16x32_bf16 v[44:47], v[172:175], v[132:135], v[44:47]
  ds_read_b64_tr_b16 v[188:189], v221 offset:1024
  v_mfma_f32_16x16x32_bf16 v[64:67], v[160:163], v[136:139], v[64:67]
  ds_read_b64_tr_b16 v[190:191], v221 offset:1536
  v_mfma_f32_16x16x32_bf16 v[68:71], v[164:167], v[136:139], v[68:71]
  ds_read_b128 v[148:151], v217 offset:2048
  v_mfma_f32_16x16x32_bf16 v[72:75], v[168:171], v[136:139], v[72:75]
  ds_read_b64_tr_b16 v[192:193], v222 offset:0
  v_mfma_f32_16x16x32_bf16 v[76:79], v[172:175], v[136:139], v[76:79]
  ds_read_b64_tr_b16 v[194:195], v222 offset:256
  v_mfma_f32_16x16x32_bf16 v[96:99], v[160:163], v[140:143], v[96:99]
  ds_read_b64_tr_b16 v[196:197], v222 offset:32
  v_mfma_f32_16x16x32_bf16 v[100:103], v[164:167], v[140:143], v[100:103]
  ds_read_b64_tr_b16 v[198:199], v222 offset:288
  v_mfma_f32_16x16x32_bf16 v[104:107], v[168:171], v[140:143], v[104:107]
  s_add_u32 s26, s26, 1
  s_cmp_eq_u32 s26, 3
  v_mfma_f32_16x16x32_bf16 v[108:111], v[172:175], v[140:143], v[108:111]
  s_cselect_b32 s27, s50, s51
  s_cselect_b32 s26, 0, s26
  s_waitcnt lgkmcnt(0)
  v_mfma_f32_16x16x32_bf16 v[16:19], v[176:179], v[128:131], v[16:19]
  ds_read_b64_tr_b16 v[160:161], v218 offset:16384
  v_mfma_f32_16x16x32_bf16 v[20:23], v[180:183], v[128:131], v[20:23]
  ds_read_b64_tr_b16 v[162:163], v218 offset:16896
  v_mfma_f32_16x16x32_bf16 v[24:27], v[184:187], v[128:131], v[24:27]
  ds_read_b64_tr_b16 v[164:165], v219 offset:16384
  v_mfma_f32_16x16x32_bf16 v[28:31], v[188:191], v[128:131], v[28:31]
  ds_read_b64_tr_b16 v[166:167], v219 offset:16896
  v_mfma_f32_16x16x32_bf16 v[48:51], v[176:179], v[132:135], v[48:51]
  ds_read_b128 v[152:155], v217 offset:4096
  v_mfma_f32_16x16x32_bf16 v[52:55], v[180:183], v[132:135], v[52:55]
  ds_read_b64_tr_b16 v[168:169], v220 offset:16384
  v_mfma_f32_16x16x32_bf16 v[56:59], v[184:187], v[132:135], v[56:59]
  ds_read_b64_tr_b16 v[170:171], v220 offset:16896
  v_mfma_f32_16x16x32_bf16 v[60:63], v[188:191], v[132:135], v[60:63]
  ds_read_b64_tr_b16 v[172:173], v221 offset:16384
  v_mfma_f32_16x16x32_bf16 v[80:83], v[176:179], v[136:139], v[80:83]
  ds_read_b64_tr_b16 v[174:175], v221 offset:16896
  v_mfma_f32_16x16x32_bf16 v[84:87], v[180:183], v[136:139], v[84:87]
  ds_read_b128 v[156:159], v217 offset:6144
  v_mfma_f32_16x16x32_bf16 v[200:203], v[192:195], v[128:131], v[200:203]
  v_mfma_f32_16x16x32_bf16 v[88:91], v[184:187], v[136:139], v[88:91]
  v_mfma_f32_16x16x32_bf16 v[204:207], v[196:199], v[128:131], v[204:207]
  v_mfma_f32_16x16x32_bf16 v[92:95], v[188:191], v[136:139], v[92:95]
  v_mfma_f32_16x16x32_bf16 v[208:211], v[192:195], v[132:135], v[208:211]
  v_mfma_f32_16x16x32_bf16 v[112:115], v[176:179], v[140:143], v[112:115]
  v_mfma_f32_16x16x32_bf16 v[212:215], v[196:199], v[132:135], v[212:215]
  v_mfma_f32_16x16x32_bf16 v[116:119], v[180:183], v[140:143], v[116:119]
  v_mfma_f32_16x16x32_bf16 v[120:123], v[184:187], v[140:143], v[120:123]
  v_mfma_f32_16x16x32_bf16 v[124:127], v[188:191], v[140:143], v[124:127]
  s_waitcnt lgkmcnt(0)
  v_mfma_f32_16x16x32_bf16 v[0:3], v[160:163], v[144:147], v[0:3]
  ds_read_b64_tr_b16 v[176:177], v218 offset:17408
  v_mfma_f32_16x16x32_bf16 v[4:7], v[164:167], v[144:147], v[4:7]
  ds_read_b64_tr_b16 v[178:179], v218 offset:17920
  v_mfma_f32_16x16x32_bf16 v[8:11], v[168:171], v[144:147], v[8:11]
  ds_read_b64_tr_b16 v[180:181], v219 offset:17408
  v_mfma_f32_16x16x32_bf16 v[12:15], v[172:175], v[144:147], v[12:15]
  ds_read_b64_tr_b16 v[182:183], v219 offset:17920
  v_mfma_f32_16x16x32_bf16 v[32:35], v[160:163], v[148:151], v[32:35]
  ds_read_b64_tr_b16 v[184:185], v220 offset:17408
  v_mfma_f32_16x16x32_bf16 v[36:39], v[164:167], v[148:151], v[36:39]
  ds_read_b64_tr_b16 v[186:187], v220 offset:17920
  v_mfma_f32_16x16x32_bf16 v[40:43], v[168:171], v[148:151], v[40:43]
  ds_read_b64_tr_b16 v[188:189], v221 offset:17408
  v_mfma_f32_16x16x32_bf16 v[44:47], v[172:175], v[148:151], v[44:47]
  ds_read_b64_tr_b16 v[190:191], v221 offset:17920
  v_mfma_f32_16x16x32_bf16 v[64:67], v[160:163], v[152:155], v[64:67]
  v_mfma_f32_16x16x32_bf16 v[68:71], v[164:167], v[152:155], v[68:71]
  v_mfma_f32_16x16x32_bf16 v[72:75], v[168:171], v[152:155], v[72:75]
  v_mfma_f32_16x16x32_bf16 v[76:79], v[172:175], v[152:155], v[76:79]
  v_mfma_f32_16x16x32_bf16 v[96:99], v[160:163], v[156:159], v[96:99]
  v_mfma_f32_16x16x32_bf16 v[100:103], v[164:167], v[156:159], v[100:103]
  v_mfma_f32_16x16x32_bf16 v[104:107], v[168:171], v[156:159], v[104:107]
  v_mfma_f32_16x16x32_bf16 v[108:111], v[172:175], v[156:159], v[108:111]
  s_waitcnt lgkmcnt(0)
  s_barrier
  v_mfma_f32_16x16x32_bf16 v[16:19], v[176:179], v[144:147], v[16:19]
  v_add_u32 v216, s27, v216
  v_add_u32 v218, s27, v218
  v_mfma_f32_16x16x32_bf16 v[20:23], v[180:183], v[144:147], v[20:23]
  ds_read_b128 v[128:131], v216 offset:0
  ds_read_b64_tr_b16 v[160:161], v218 offset:0
  v_mfma_f32_16x16x32_bf16 v[24:27], v[184:187], v[144:147], v[24:27]
  ds_read_b64_tr_b16 v[162:163], v218 offset:512
  v_add_u32 v219, s27, v219
  v_mfma_f32_16x16x32_bf16 v[28:31], v[188:191], v[144:147], v[28:31]
  ds_read_b128 v[132:135], v216 offset:2048
  ds_read_b64_tr_b16 v[164:165], v219 offset:0
  v_mfma_f32_16x16x32_bf16 v[48:51], v[176:179], v[148:151], v[48:51]
  ds_read_b64_tr_b16 v[166:167], v219 offset:512
  v_add_u32 v220, s27, v220
  v_mfma_f32_16x16x32_bf16 v[52:55], v[180:183], v[148:151], v[52:55]
  ds_read_b128 v[136:139], v216 offset:4096
  ds_read_b64_tr_b16 v[168:169], v220 offset:0
  v_mfma_f32_16x16x32_bf16 v[56:59], v[184:187], v[148:151], v[56:59]
  ds_read_b64_tr_b16 v[170:171], v220 offset:512
  v_add_u32 v221, s27, v221
  v_mfma_f32_16x16x32_bf16 v[60:63], v[188:191], v[148:151], v[60:63]
  ds_read_b128 v[140:143], v216 offset:6144
  ds_read_b64_tr_b16 v[172:173], v221 offset:0
  v_mfma_f32_16x16x32_bf16 v[80:83], v[176:179], v[152:155], v[80:83]
  ds_read_b64_tr_b16 v[174:175], v221 offset:512
  v_mfma_f32_16x16x32_bf16 v[84:87], v[180:183], v[152:155], v[84:87]
  v_add_u32 v217, s27, v217
  v_mfma_f32_16x16x32_bf16 v[88:91], v[184:187], v[152:155], v[88:91]
  v_add_u32 v222, s27, v222
  v_mfma_f32_16x16x32_bf16 v[92:95], v[188:191], v[152:155], v[92:95]
  s_sub_u32 s28, s28, 1
  v_mfma_f32_16x16x32_bf16 v[112:115], v[176:179], v[156:159], v[112:115]
  s_cmp_lg_u32 s28, 0
  v_mfma_f32_16x16x32_bf16 v[116:119], v[180:183], v[156:159], v[116:119]
  v_mfma_f32_16x16x32_bf16 v[120:123], v[184:187], v[156:159], v[120:123]
  v_mfma_f32_16x16x32_bf16 v[124:127], v[188:191], v[156:159], v[124:127]
  s_cbranch_scc1 p1_c_B0_loop
  s_waitcnt lgkmcnt(0)
  v_mfma_f32_16x16x32_bf16 v[0:3], v[160:163], v[128:131], v[0:3]
  ds_read_b128 v[144:147], v217 offset:0
  v_mfma_f32_16x16x32_bf16 v[4:7], v[164:167], v[128:131], v[4:7]
  ds_read_b64_tr_b16 v[176:177], v218 offset:16384
  v_mfma_f32_16x16x32_bf16 v[8:11], v[168:171], v[128:131], v[8:11]
  ds_read_b64_tr_b16 v[178:179], v218 offset:16896
  v_mfma_f32_16x16x32_bf16 v[12:15], v[172:175], v[128:131], v[12:15]
  ds_read_b128 v[148:151], v217 offset:2048
  v_mfma_f32_16x16x32_bf16 v[32:35], v[160:163], v[132:135], v[32:35]
  ds_read_b64_tr_b16 v[180:181], v219 offset:16384
  v_mfma_f32_16x16x32_bf16 v[36:39], v[164:167], v[132:135], v[36:39]
  ds_read_b64_tr_b16 v[182:183], v219 offset:16896
  v_mfma_f32_16x16x32_bf16 v[40:43], v[168:171], v[132:135], v[40:43]
  ds_read_b128 v[152:155], v217 offset:4096
  v_mfma_f32_16x16x32_bf16 v[44:47], v[172:175], v[132:135], v[44:47]
  ds_read_b64_tr_b16 v[184:185], v220 offset:16384
  v_mfma_f32_16x16x32_bf16 v[64:67], v[160:163], v[136:139], v[64:67]
  ds_read_b64_tr_b16 v[186:187], v220 offset:16896
  v_mfma_f32_16x16x32_bf16 v[68:71], v[164:167], v[136:139], v[68:71]
  ds_read_b128 v[156:159], v217 offset:6144
  v_add_u32 v236, 0xfffe6000, v222
  v_mfma_f32_16x16x32_bf16 v[72:75], v[168:171], v[136:139], v[72:75]
  ds_read_b64_tr_b16 v[188:189], v221 offset:16384
  v_add_u32 v235, 0xfffe6000, v221
  v_mfma_f32_16x16x32_bf16 v[76:79], v[172:175], v[136:139], v[76:79]
  ds_read_b64_tr_b16 v[190:191], v221 offset:16896
  v_add_u32 v234, 0xfffe6000, v220
  v_mfma_f32_16x16x32_bf16 v[96:99], v[160:163], v[140:143], v[96:99]
  v_add_u32 v233, 0xfffe6000, v219
  v_mfma_f32_16x16x32_bf16 v[100:103], v[164:167], v[140:143], v[100:103]
  v_add_u32 v232, 0xfffe6000, v218
  v_mfma_f32_16x16x32_bf16 v[104:107], v[168:171], v[140:143], v[104:107]
  v_add_u32 v231, 0xfffe6000, v217
  v_mfma_f32_16x16x32_bf16 v[108:111], v[172:175], v[140:143], v[108:111]
  v_add_u32 v230, 0xfffe6000, v216
  s_waitcnt lgkmcnt(0)
  s_barrier
  v_mfma_f32_16x16x32_bf16 v[0:3], v[176:179], v[144:147], v[0:3]
  ds_read_b128 v[128:131], v230 offset:0
  v_mfma_f32_16x16x32_bf16 v[4:7], v[180:183], v[144:147], v[4:7]
  ds_read_b64_tr_b16 v[160:161], v232 offset:0
  v_mfma_f32_16x16x32_bf16 v[8:11], v[184:187], v[144:147], v[8:11]
  ds_read_b64_tr_b16 v[162:163], v232 offset:512
  v_mfma_f32_16x16x32_bf16 v[12:15], v[188:191], v[144:147], v[12:15]
  ds_read_b128 v[132:135], v230 offset:2048
  v_mfma_f32_16x16x32_bf16 v[32:35], v[176:179], v[148:151], v[32:35]
  ds_read_b64_tr_b16 v[164:165], v233 offset:0
  v_mfma_f32_16x16x32_bf16 v[36:39], v[180:183], v[148:151], v[36:39]
  ds_read_b64_tr_b16 v[166:167], v233 offset:512
  v_mfma_f32_16x16x32_bf16 v[40:43], v[184:187], v[148:151], v[40:43]
  ds_read_b128 v[136:139], v230 offset:4096
  v_mfma_f32_16x16x32_bf16 v[44:47], v[188:191], v[148:151], v[44:47]
  ds_read_b64_tr_b16 v[168:169], v234 offset:0
  v_mfma_f32_16x16x32_bf16 v[64:67], v[176:179], v[152:155], v[64:67]
  ds_read_b64_tr_b16 v[170:171], v234 offset:512
  v_mfma_f32_16x16x32_bf16 v[68:71], v[180:183], v[152:155], v[68:71]
  ds_read_b128 v[140:143], v230 offset:6144
  v_mfma_f32_16x16x32_bf16 v[72:75], v[184:187], v[152:155], v[72:75]
  ds_read_b64_tr_b16 v[172:173], v235 offset:0
  v_mfma_f32_16x16x32_bf16 v[76:79], v[188:191], v[152:155], v[76:79]
  ds_read_b64_tr_b16 v[174:175], v235 offset:512
  v_mfma_f32_16x16x32_bf16 v[96:99], v[176:179], v[156:159], v[96:99]
  v_mfma_f32_16x16x32_bf16 v[100:103], v[180:183], v[156:159], v[100:103]
  v_mfma_f32_16x16x32_bf16 v[104:107], v[184:187], v[156:159], v[104:107]
  v_mfma_f32_16x16x32_bf16 v[108:111], v[188:191], v[156:159], v[108:111]
  s_waitcnt lgkmcnt(0)
  v_mfma_f32_16x16x32_bf16 v[0:3], v[160:163], v[128:131], v[0:3]
  ds_read_b128 v[144:147], v231 offset:0
  v_mfma_f32_16x16x32_bf16 v[4:7], v[164:167], v[128:131], v[4:7]
  ds_read_b64_tr_b16 v[176:177], v232 offset:16384
  v_mfma_f32_16x16x32_bf16 v[8:11], v[168:171], v[128:131], v[8:11]
  ds_read_b64_tr_b16 v[178:179], v232 offset:16896
  v_mfma_f32_16x16x32_bf16 v[12:15], v[172:175], v[128:131], v[12:15]
  ds_read_b128 v[148:151], v231 offset:2048
  v_mfma_f32_16x16x32_bf16 v[32:35], v[160:163], v[132:135], v[32:35]
  ds_read_b64_tr_b16 v[180:181], v233 offset:16384
  v_mfma_f32_16x16x32_bf16 v[36:39], v[164:167], v[132:135], v[36:39]
  ds_read_b64_tr_b16 v[182:183], v233 offset:16896
  v_mfma_f32_16x16x32_bf16 v[40:43], v[168:171], v[132:135], v[40:43]
  ds_read_b128 v[152:155], v231 offset:4096
  v_mfma_f32_16x16x32_bf16 v[44:47], v[172:175], v[132:135], v[44:47]
  ds_read_b64_tr_b16 v[184:185], v234 offset:16384
  v_mfma_f32_16x16x32_bf16 v[64:67], v[160:163], v[136:139], v[64:67]
  ds_read_b64_tr_b16 v[186:187], v234 offset:16896
  v_mfma_f32_16x16x32_bf16 v[68:71], v[164:167], v[136:139], v[68:71]
  ds_read_b128 v[156:159], v231 offset:6144
  v_mfma_f32_16x16x32_bf16 v[72:75], v[168:171], v[136:139], v[72:75]
  ds_read_b64_tr_b16 v[188:189], v235 offset:16384
  v_mfma_f32_16x16x32_bf16 v[76:79], v[172:175], v[136:139], v[76:79]
  ds_read_b64_tr_b16 v[190:191], v235 offset:16896
  v_mfma_f32_16x16x32_bf16 v[96:99], v[160:163], v[140:143], v[96:99]
  v_mfma_f32_16x16x32_bf16 v[100:103], v[164:167], v[140:143], v[100:103]
  v_mfma_f32_16x16x32_bf16 v[104:107], v[168:171], v[140:143], v[104:107]
  v_mfma_f32_16x16x32_bf16 v[108:111], v[172:175], v[140:143], v[108:111]
  s_waitcnt lgkmcnt(0)
  v_mfma_f32_16x16x32_bf16 v[0:3], v[176:179], v[144:147], v[0:3]
  ds_read_b64_tr_b16 v[160:161], v232 offset:1024
  v_mfma_f32_16x16x32_bf16 v[4:7], v[180:183], v[144:147], v[4:7]
  ds_read_b64_tr_b16 v[162:163], v232 offset:1536
  v_mfma_f32_16x16x32_bf16 v[8:11], v[184:187], v[144:147], v[8:11]
  ds_read_b64_tr_b16 v[164:165], v233 offset:1024
  v_mfma_f32_16x16x32_bf16 v[12:15], v[188:191], v[144:147], v[12:15]
  ds_read_b64_tr_b16 v[166:167], v233 offset:1536
  v_mfma_f32_16x16x32_bf16 v[32:35], v[176:179], v[148:151], v[32:35]
  ds_read_b64_tr_b16 v[168:169], v234 offset:1024
  v_mfma_f32_16x16x32_bf16 v[36:39], v[180:183], v[148:151], v[36:39]
  ds_read_b64_tr_b16 v[170:171], v234 offset:1536
  v_mfma_f32_16x16x32_bf16 v[40:43], v[184:187], v[148:151], v[40:43]
  ds_read_b64_tr_b16 v[172:173], v235 offset:1024
  v_mfma_f32_16x16x32_bf16 v[44:47], v[188:191], v[148:151], v[44:47]
  ds_read_b64_tr_b16 v[174:175], v235 offset:1536
  v_mfma_f32_16x16x32_bf16 v[64:67], v[176:179], v[152:155], v[64:67]
  ds_read_b64_tr_b16 v[192:193], v236 offset:0
  v_mfma_f32_16x16x32_bf16 v[68:71], v[180:183], v[152:155], v[68:71]
  ds_read_b64_tr_b16 v[194:195], v236 offset:256
  v_mfma_f32_16x16x32_bf16 v[72:75], v[184:187], v[152:155], v[72:75]
  ds_read_b64_tr_b16 v[196:197], v236 offset:32
  v_mfma_f32_16x16x32_bf16 v[76:79], v[188:191], v[152:155], v[76:79]
  ds_read_b64_tr_b16 v[198:199], v236 offset:288
  v_mfma_f32_16x16x32_bf16 v[96:99], v[176:179], v[156:159], v[96:99]
  v_mfma_f32_16x16x32_bf16 v[100:103], v[180:183], v[156:159], v[100:103]
  v_mfma_f32_16x16x32_bf16 v[104:107], v[184:187], v[156:159], v[104:107]
  v_mfma_f32_16x16x32_bf16 v[108:111], v[188:191], v[156:159], v[108:111]
  s_waitcnt lgkmcnt(0)
  v_mfma_f32_16x16x32_bf16 v[16:19], v[160:163], v[128:131], v[16:19]
  ds_read_b64_tr_b16 v[176:177], v232 offset:17408
  v_mfma_f32_16x16x32_bf16 v[20:23], v[164:167], v[128:131], v[20:23]
  ds_read_b64_tr_b16 v[178:179], v232 offset:17920
  v_mfma_f32_16x16x32_bf16 v[24:27], v[168:171], v[128:131], v[24:27]
  ds_read_b64_tr_b16 v[180:181], v233 offset:17408
  v_mfma_f32_16x16x32_bf16 v[28:31], v[172:175], v[128:131], v[28:31]
  ds_read_b64_tr_b16 v[182:183], v233 offset:17920
  v_mfma_f32_16x16x32_bf16 v[48:51], v[160:163], v[132:135], v[48:51]
  ds_read_b64_tr_b16 v[184:185], v234 offset:17408
  v_cvt_pk_bf16_f32 v0, v0, v1
  v_mfma_f32_16x16x32_bf16 v[52:55], v[164:167], v[132:135], v[52:55]
  ds_read_b64_tr_b16 v[186:187], v234 offset:17920
  v_cvt_pk_bf16_f32 v1, v2, v3
  v_mfma_f32_16x16x32_bf16 v[56:59], v[168:171], v[132:135], v[56:59]
  ds_read_b64_tr_b16 v[188:189], v235 offset:17408
  v_cvt_pk_bf16_f32 v2, v4, v5
  v_mfma_f32_16x16x32_bf16 v[60:63], v[172:175], v[132:135], v[60:63]
  ds_read_b64_tr_b16 v[190:191], v235 offset:17920
  v_cvt_pk_bf16_f32 v3, v6, v7
  v_mfma_f32_16x16x32_bf16 v[80:83], v[160:163], v[136:139], v[80:83]
  s_mul_i32 s7, s31, 0
  v_mfma_f32_16x16x32_bf16 v[84:87], v[164:167], v[136:139], v[84:87]
  s_add_u32 s7, s7, s30
  v_mfma_f32_16x16x32_bf16 v[200:203], v[192:195], v[128:131], v[200:203]
  buffer_store_dwordx4 v[0:3], v224, s[20:23], s7 offen sc1
  v_mfma_f32_16x16x32_bf16 v[88:91], v[168:171], v[136:139], v[88:91]
  v_cvt_pk_bf16_f32 v32, v32, v33
  v_mfma_f32_16x16x32_bf16 v[204:207], v[196:199], v[128:131], v[204:207]
  v_cvt_pk_bf16_f32 v33, v34, v35
  v_mfma_f32_16x16x32_bf16 v[92:95], v[172:175], v[136:139], v[92:95]
  v_cvt_pk_bf16_f32 v34, v36, v37
  v_mfma_f32_16x16x32_bf16 v[208:211], v[192:195], v[132:135], v[208:211]
  v_cvt_pk_bf16_f32 v35, v38, v39
  v_mfma_f32_16x16x32_bf16 v[112:115], v[160:163], v[140:143], v[112:115]
  buffer_store_dwordx4 v[32:35], v224, s[20:23], s7 offen offset:256 sc1
  v_mfma_f32_16x16x32_bf16 v[212:215], v[196:199], v[132:135], v[212:215]
  v_cvt_pk_bf16_f32 v8, v8, v9
  v_mfma_f32_16x16x32_bf16 v[116:119], v[164:167], v[140:143], v[116:119]
  v_cvt_pk_bf16_f32 v9, v10, v11
  v_mfma_f32_16x16x32_bf16 v[120:123], v[168:171], v[140:143], v[120:123]
  v_cvt_pk_bf16_f32 v10, v12, v13
  v_mfma_f32_16x16x32_bf16 v[124:127], v[172:175], v[140:143], v[124:127]
  v_cvt_pk_bf16_f32 v11, v14, v15
  s_waitcnt lgkmcnt(0)
  v_mfma_f32_16x16x32_bf16 v[16:19], v[176:179], v[144:147], v[16:19]
  ds_read_b128 v[128:131], v216 offset:0
  s_mul_i32 s7, s31, 1
  v_mfma_f32_16x16x32_bf16 v[20:23], v[180:183], v[144:147], v[20:23]
  ds_read_b64_tr_b16 v[160:161], v218 offset:1024
  s_add_u32 s7, s7, s30
  v_mfma_f32_16x16x32_bf16 v[24:27], v[184:187], v[144:147], v[24:27]
  ds_read_b64_tr_b16 v[162:163], v218 offset:1536
  buffer_store_dwordx4 v[8:11], v224, s[20:23], s7 offen sc1
  v_mfma_f32_16x16x32_bf16 v[28:31], v[188:191], v[144:147], v[28:31]
  ds_read_b128 v[132:135], v216 offset:2048
  v_cvt_pk_bf16_f32 v40, v40, v41
  v_mfma_f32_16x16x32_bf16 v[48:51], v[176:179], v[148:151], v[48:51]
  ds_read_b64_tr_b16 v[164:165], v219 offset:1024
  v_cvt_pk_bf16_f32 v41, v42, v43
  v_mfma_f32_16x16x32_bf16 v[52:55], v[180:183], v[148:151], v[52:55]
  ds_read_b64_tr_b16 v[166:167], v219 offset:1536
  v_cvt_pk_bf16_f32 v42, v44, v45
  v_mfma_f32_16x16x32_bf16 v[56:59], v[184:187], v[148:151], v[56:59]
  ds_read_b128 v[136:139], v216 offset:4096
  v_cvt_pk_bf16_f32 v43, v46, v47
  v_mfma_f32_16x16x32_bf16 v[60:63], v[188:191], v[148:151], v[60:63]
  ds_read_b64_tr_b16 v[168:169], v220 offset:1024
  buffer_store_dwordx4 v[40:43], v224, s[20:23], s7 offen offset:256 sc1
  v_mfma_f32_16x16x32_bf16 v[80:83], v[176:179], v[152:155], v[80:83]
  ds_read_b64_tr_b16 v[170:171], v220 offset:1536
  v_cvt_pk_bf16_f32 v64, v64, v65
  v_mfma_f32_16x16x32_bf16 v[84:87], v[180:183], v[152:155], v[84:87]
  ds_read_b128 v[140:143], v216 offset:6144
  v_cvt_pk_bf16_f32 v65, v66, v67
  v_mfma_f32_16x16x32_bf16 v[88:91], v[184:187], v[152:155], v[88:91]
  ds_read_b64_tr_b16 v[172:173], v221 offset:1024
  v_cvt_pk_bf16_f32 v66, v68, v69
  v_mfma_f32_16x16x32_bf16 v[92:95], v[188:191], v[152:155], v[92:95]
  ds_read_b64_tr_b16 v[174:175], v221 offset:1536
  v_cvt_pk_bf16_f32 v67, v70, v71
  v_mfma_f32_16x16x32_bf16 v[112:115], v[176:179], v[156:159], v[112:115]
  ds_read_b64_tr_b16 v[192:193], v222 offset:0
  s_mul_i32 s7, s31, 0
  v_mfma_f32_16x16x32_bf16 v[116:119], v[180:183], v[156:159], v[116:119]
  ds_read_b64_tr_b16 v[194:195], v222 offset:256
  s_add_u32 s7, s7, s30
  v_mfma_f32_16x16x32_bf16 v[120:123], v[184:187], v[156:159], v[120:123]
  ds_read_b64_tr_b16 v[196:197], v222 offset:32
  s_add_u32 s7, s7, s32
  v_mfma_f32_16x16x32_bf16 v[124:127], v[188:191], v[156:159], v[124:127]
  ds_read_b64_tr_b16 v[198:199], v222 offset:288
  buffer_store_dwordx4 v[64:67], v224, s[20:23], s7 offen sc1
  s_waitcnt lgkmcnt(0)
  v_mfma_f32_16x16x32_bf16 v[16:19], v[160:163], v[128:131], v[16:19]
  ds_read_b128 v[144:147], v217 offset:0
  v_cvt_pk_bf16_f32 v96, v96, v97
  v_mfma_f32_16x16x32_bf16 v[20:23], v[164:167], v[128:131], v[20:23]
  ds_read_b64_tr_b16 v[176:177], v218 offset:17408
  v_cvt_pk_bf16_f32 v97, v98, v99
  v_mfma_f32_16x16x32_bf16 v[24:27], v[168:171], v[128:131], v[24:27]
  ds_read_b64_tr_b16 v[178:179], v218 offset:17920
  v_cvt_pk_bf16_f32 v98, v100, v101
  v_mfma_f32_16x16x32_bf16 v[28:31], v[172:175], v[128:131], v[28:31]
  ds_read_b128 v[148:151], v217 offset:2048
  v_cvt_pk_bf16_f32 v99, v102, v103
  v_mfma_f32_16x16x32_bf16 v[48:51], v[160:163], v[132:135], v[48:51]
  ds_read_b64_tr_b16 v[180:181], v219 offset:17408
  buffer_store_dwordx4 v[96:99], v224, s[20:23], s7 offen offset:256 sc1
  v_mfma_f32_16x16x32_bf16 v[52:55], v[164:167], v[132:135], v[52:55]
  ds_read_b64_tr_b16 v[182:183], v219 offset:17920
  v_cvt_pk_bf16_f32 v72, v72, v73
  v_mfma_f32_16x16x32_bf16 v[56:59], v[168:171], v[132:135], v[56:59]
  ds_read_b128 v[152:155], v217 offset:4096
  v_cvt_pk_bf16_f32 v73, v74, v75
  v_mfma_f32_16x16x32_bf16 v[60:63], v[172:175], v[132:135], v[60:63]
  ds_read_b64_tr_b16 v[184:185], v220 offset:17408
  v_cvt_pk_bf16_f32 v74, v76, v77
  v_mfma_f32_16x16x32_bf16 v[80:83], v[160:163], v[136:139], v[80:83]
  ds_read_b64_tr_b16 v[186:187], v220 offset:17920
  v_cvt_pk_bf16_f32 v75, v78, v79
  v_mfma_f32_16x16x32_bf16 v[84:87], v[164:167], v[136:139], v[84:87]
  ds_read_b128 v[156:159], v217 offset:6144
  s_mul_i32 s7, s31, 1
  v_mfma_f32_16x16x32_bf16 v[200:203], v[192:195], v[128:131], v[200:203]
  ds_read_b64_tr_b16 v[188:189], v221 offset:17408
  s_add_u32 s7, s7, s30
  v_mfma_f32_16x16x32_bf16 v[88:91], v[168:171], v[136:139], v[88:91]
  ds_read_b64_tr_b16 v[190:191], v221 offset:17920
  s_add_u32 s7, s7, s32
  v_mfma_f32_16x16x32_bf16 v[204:207], v[196:199], v[128:131], v[204:207]
  buffer_store_dwordx4 v[72:75], v224, s[20:23], s7 offen sc1
  v_mfma_f32_16x16x32_bf16 v[92:95], v[172:175], v[136:139], v[92:95]
  v_cvt_pk_bf16_f32 v104, v104, v105
  v_mfma_f32_16x16x32_bf16 v[208:211], v[192:195], v[132:135], v[208:211]
  v_cvt_pk_bf16_f32 v105, v106, v107
  v_mfma_f32_16x16x32_bf16 v[112:115], v[160:163], v[140:143], v[112:115]
  v_cvt_pk_bf16_f32 v106, v108, v109
  v_mfma_f32_16x16x32_bf16 v[212:215], v[196:199], v[132:135], v[212:215]
  v_cvt_pk_bf16_f32 v107, v110, v111
  v_mfma_f32_16x16x32_bf16 v[116:119], v[164:167], v[140:143], v[116:119]
  buffer_store_dwordx4 v[104:107], v224, s[20:23], s7 offen offset:256 sc1
  v_mfma_f32_16x16x32_bf16 v[120:123], v[168:171], v[140:143], v[120:123]
  v_mfma_f32_16x16x32_bf16 v[124:127], v[172:175], v[140:143], v[124:127]
  s_waitcnt lgkmcnt(0)
  v_mfma_f32_16x16x32_bf16 v[16:19], v[176:179], v[144:147], v[16:19]
  v_mfma_f32_16x16x32_bf16 v[20:23], v[180:183], v[144:147], v[20:23]
  v_mfma_f32_16x16x32_bf16 v[24:27], v[184:187], v[144:147], v[24:27]
  v_mfma_f32_16x16x32_bf16 v[28:31], v[188:191], v[144:147], v[28:31]
  v_mfma_f32_16x16x32_bf16 v[48:51], v[176:179], v[148:151], v[48:51]
  v_mfma_f32_16x16x32_bf16 v[52:55], v[180:183], v[148:151], v[52:55]
  v_mfma_f32_16x16x32_bf16 v[56:59], v[184:187], v[148:151], v[56:59]
  v_mfma_f32_16x16x32_bf16 v[60:63], v[188:191], v[148:151], v[60:63]
  v_mfma_f32_16x16x32_bf16 v[80:83], v[176:179], v[152:155], v[80:83]
  v_mfma_f32_16x16x32_bf16 v[84:87], v[180:183], v[152:155], v[84:87]
  v_mfma_f32_16x16x32_bf16 v[88:91], v[184:187], v[152:155], v[88:91]
  v_mfma_f32_16x16x32_bf16 v[92:95], v[188:191], v[152:155], v[92:95]
  v_mfma_f32_16x16x32_bf16 v[112:115], v[176:179], v[156:159], v[112:115]
  v_mfma_f32_16x16x32_bf16 v[116:119], v[180:183], v[156:159], v[116:119]
  v_mfma_f32_16x16x32_bf16 v[120:123], v[184:187], v[156:159], v[120:123]
  v_mfma_f32_16x16x32_bf16 v[124:127], v[188:191], v[156:159], v[124:127]
  s_nop 7
  v_cvt_pk_bf16_f32 v16, v16, v17
  v_cvt_pk_bf16_f32 v17, v18, v19
  v_cvt_pk_bf16_f32 v18, v20, v21
  v_cvt_pk_bf16_f32 v19, v22, v23
  s_mul_i32 s7, s31, 2
  s_add_u32 s7, s7, s30
  buffer_store_dwordx4 v[16:19], v224, s[20:23], s7 offen sc1
  v_cvt_pk_bf16_f32 v48, v48, v49
  v_cvt_pk_bf16_f32 v49, v50, v51
  v_cvt_pk_bf16_f32 v50, v52, v53
  v_cvt_pk_bf16_f32 v51, v54, v55
  buffer_store_dwordx4 v[48:51], v224, s[20:23], s7 offen offset:256 sc1
  v_cvt_pk_bf16_f32 v24, v24, v25
  v_cvt_pk_bf16_f32 v25, v26, v27
  v_cvt_pk_bf16_f32 v26, v28, v29
  v_cvt_pk_bf16_f32 v27, v30, v31
  s_mul_i32 s7, s31, 3
  s_add_u32 s7, s7, s30
  buffer_store_dwordx4 v[24:27], v224, s[20:23], s7 offen sc1
  v_cvt_pk_bf16_f32 v56, v56, v57
  v_cvt_pk_bf16_f32 v57, v58, v59
  v_cvt_pk_bf16_f32 v58, v60, v61
  v_cvt_pk_bf16_f32 v59, v62, v63
  buffer_store_dwordx4 v[56:59], v224, s[20:23], s7 offen offset:256 sc1
  v_cvt_pk_bf16_f32 v80, v80, v81
  v_cvt_pk_bf16_f32 v81, v82, v83
  v_cvt_pk_bf16_f32 v82, v84, v85
  v_cvt_pk_bf16_f32 v83, v86, v87
  s_mul_i32 s7, s31, 2
  s_add_u32 s7, s7, s30
  s_add_u32 s7, s7, s32
  buffer_store_dwordx4 v[80:83], v224, s[20:23], s7 offen sc1
  v_cvt_pk_bf16_f32 v112, v112, v113
  v_cvt_pk_bf16_f32 v113, v114, v115
  v_cvt_pk_bf16_f32 v114, v116, v117
  v_cvt_pk_bf16_f32 v115, v118, v119
  buffer_store_dwordx4 v[112:115], v224, s[20:23], s7 offen offset:256 sc1
  v_cvt_pk_bf16_f32 v88, v88, v89
  v_cvt_pk_bf16_f32 v89, v90, v91
  v_cvt_pk_bf16_f32 v90, v92, v93
  v_cvt_pk_bf16_f32 v91, v94, v95
  s_mul_i32 s7, s31, 3
  s_add_u32 s7, s7, s30
  s_add_u32 s7, s7, s32
  buffer_store_dwordx4 v[88:91], v224, s[20:23], s7 offen sc1
  v_cvt_pk_bf16_f32 v120, v120, v121
  v_cvt_pk_bf16_f32 v121, v122, v123
  v_cvt_pk_bf16_f32 v122, v124, v125
  v_cvt_pk_bf16_f32 v123, v126, v127
  buffer_store_dwordx4 v[120:123], v224, s[20:23], s7 offen offset:256 sc1
  s_waitcnt lgkmcnt(0)
  s_barrier
  s_lshl_b32 s7, s24, 12
  s_add_u32 s7, s7, 53248
  v_add_u32 v226, s7, v223
  ds_read_b128 v[128:131], v226 offset:0
  ds_read_b128 v[132:135], v226 offset:1024
  ds_read_b128 v[136:139], v226 offset:2048
  ds_read_b128 v[140:143], v226 offset:3072
  s_waitcnt lgkmcnt(0)
  v_add_f32 v200, v200, v128
  v_add_f32 v201, v201, v129
  v_add_f32 v202, v202, v130
  v_add_f32 v203, v203, v131
  v_add_f32 v204, v204, v132
  v_add_f32 v205, v205, v133
  v_add_f32 v206, v206, v134
  v_add_f32 v207, v207, v135
  v_add_f32 v208, v208, v136
  v_add_f32 v209, v209, v137
  v_add_f32 v210, v210, v138
  v_add_f32 v211, v211, v139
  v_add_f32 v212, v212, v140
  v_add_f32 v213, v213, v141
  v_add_f32 v214, v214, v142
  v_add_f32 v215, v215, v143
  v_pk_mul_f32 v[200:201], v[200:201], s[34:35]
  v_pk_mul_f32 v[202:203], v[202:203], s[34:35]
  v_pk_mul_f32 v[204:205], v[204:205], s[34:35]
  v_pk_mul_f32 v[206:207], v[206:207], s[34:35]
  v_pk_mul_f32 v[208:209], v[208:209], s[34:35]
  v_pk_mul_f32 v[210:211], v[210:211], s[34:35]
  v_pk_mul_f32 v[212:213], v[212:213], s[34:35]
  v_pk_mul_f32 v[214:215], v[214:215], s[34:35]
  v_cvt_pk_bf16_f32 v200, v200, v201
  v_cvt_pk_bf16_f32 v201, v202, v203
  v_cvt_pk_bf16_f32 v202, v204, v205
  v_cvt_pk_bf16_f32 v203, v206, v207
  v_cvt_pk_bf16_f32 v204, v208, v209
  v_cvt_pk_bf16_f32 v205, v210, v211
  v_cvt_pk_bf16_f32 v206, v212, v213
  v_cvt_pk_bf16_f32 v207, v214, v215
  s_lshl_b32 s7, s5, 2
  s_lshl_b32 s33, s24, 1
  s_add_u32 s7, s7, s33
  s_add_u32 s7, s7, 0
  s_lshl_b32 s7, s7, 12
  s_add_u32 s7, s7, 16777216
  buffer_store_dwordx4 v[200:203], v225, s[20:23], s7 offen sc1
  buffer_store_dwordx4 v[204:207], v225, s[20:23], s7 offen offset:128 sc1
  s_endpgm
p1_c_B1:
  s_lshl_b32 s7, s6, 3
  s_lshl_b32 s33, s25, 2
  s_add_u32 s7, s7, s33
  s_lshl_b32 s33, s5, 2
  s_lshl_b32 s36, s24, 1
  s_add_u32 s33, s33, s36
  s_mov_b32 s31, 131072
  s_mov_b32 s32, 2048
  s_mov_b32 s36, 12582912
  s_mov_b32 s34, 0x3e8293ee
  s_mov_b32 s35, s34
  s_mul_i32 s7, s7, s31
  s_mul_i32 s33, s33, s32
  s_add_u32 s30, s7, s33
  s_add_u32 s30, s30, s36
  s_mov_b32 s28, 14
  s_waitcnt lgkmcnt(0)
  s_barrier
  ds_read_b128 v[128:131], v216 offset:0
  ds_read_b64_tr_b16 v[160:161], v218 offset:0
  ds_read_b64_tr_b16 v[162:163], v218 offset:512
  ds_read_b128 v[132:135], v216 offset:2048
  ds_read_b64_tr_b16 v[164:165], v219 offset:0
  ds_read_b64_tr_b16 v[166:167], v219 offset:512
  ds_read_b128 v[136:139], v216 offset:4096
  ds_read_b64_tr_b16 v[168:169], v220 offset:0
  ds_read_b64_tr_b16 v[170:171], v220 offset:512
  ds_read_b128 v[140:143], v216 offset:6144
  ds_read_b64_tr_b16 v[172:173], v221 offset:0
  ds_read_b64_tr_b16 v[174:175], v221 offset:512
  .p2align 6
p1_c_B1_loop:
  s_waitcnt lgkmcnt(0)
  v_mfma_f32_16x16x32_bf16 v[0:3], v[160:163], v[128:131], v[0:3]
  ds_read_b64_tr_b16 v[176:177], v218 offset:1024
  v_mfma_f32_16x16x32_bf16 v[4:7], v[164:167], v[128:131], v[4:7]
  ds_read_b64_tr_b16 v[178:179], v218 offset:1536
  v_mfma_f32_16x16x32_bf16 v[8:11], v[168:171], v[128:131], v[8:11]
  ds_read_b64_tr_b16 v[180:181], v219 offset:1024
  v_mfma_f32_16x16x32_bf16 v[12:15], v[172:175], v[128:131], v[12:15]
  ds_read_b64_tr_b16 v[182:183], v219 offset:1536
  v_mfma_f32_16x16x32_bf16 v[32:35], v[160:163], v[132:135], v[32:35]
  ds_read_b128 v[144:147], v217 offset:0
  v_mfma_f32_16x16x32_bf16 v[36:39], v[164:167], v[132:135], v[36:39]
  ds_read_b64_tr_b16 v[184:185], v220 offset:1024
  v_mfma_f32_16x16x32_bf16 v[40:43], v[168:171], v[132:135], v[40:43]
  ds_read_b64_tr_b16 v[186:187], v220 offset:1536
  v_mfma_f32_16x16x32_bf16 v[44:47], v[172:175], v[132:135], v[44:47]
  ds_read_b64_tr_b16 v[188:189], v221 offset:1024
  v_mfma_f32_16x16x32_bf16 v[64:67], v[160:163], v[136:139], v[64:67]
  ds_read_b64_tr_b16 v[190:191], v221 offset:1536
  v_mfma_f32_16x16x32_bf16 v[68:71], v[164:167], v[136:139], v[68:71]
  ds_read_b128 v[148:151], v217 offset:2048
  v_mfma_f32_16x16x32_bf16 v[72:75], v[168:171], v[136:139], v[72:75]
  v_mfma_f32_16x16x32_bf16 v[76:79], v[172:175], v[136:139], v[76:79]
  v_mfma_f32_16x16x32_bf16 v[96:99], v[160:163], v[140:143], v[96:99]
  v_mfma_f32_16x16x32_bf16 v[100:103], v[164:167], v[140:143], v[100:103]
  v_mfma_f32_16x16x32_bf16 v[104:107], v[168:171], v[140:143], v[104:107]
  s_add_u32 s26, s26, 1
  s_cmp_eq_u32 s26, 3
  v_mfma_f32_16x16x32_bf16 v[108:111], v[172:175], v[140:143], v[108:111]
  s_cselect_b32 s27, s50, s51
  s_cselect_b32 s26, 0, s26
  s_waitcnt lgkmcnt(0)
  v_mfma_f32_16x16x32_bf16 v[16:19], v[176:179], v[128:131], v[16:19]
  ds_read_b64_tr_b16 v[160:161], v218 offset:16384
  v_mfma_f32_16x16x32_bf16 v[20:23], v[180:183], v[128:131], v[20:23]
  ds_read_b64_tr_b16 v[162:163], v218 offset:16896
  v_mfma_f32_16x16x32_bf16 v[24:27], v[184:187], v[128:131], v[24:27]
  ds_read_b64_tr_b16 v[164:165], v219 offset:16384
  v_mfma_f32_16x16x32_bf16 v[28:31], v[188:191], v[128:131], v[28:31]
  ds_read_b64_tr_b16 v[166:167], v219 offset:16896
  v_mfma_f32_16x16x32_bf16 v[48:51], v[176:179], v[132:135], v[48:51]
  ds_read_b128 v[152:155], v217 offset:4096
  v_mfma_f32_16x16x32_bf16 v[52:55], v[180:183], v[132:135], v[52:55]
  ds_read_b64_tr_b16 v[168:169], v220 offset:16384
  v_mfma_f32_16x16x32_bf16 v[56:59], v[184:187], v[132:135], v[56:59]
  ds_read_b64_tr_b16 v[170:171], v220 offset:16896
  v_mfma_f32_16x16x32_bf16 v[60:63], v[188:191], v[132:135], v[60:63]
  ds_read_b64_tr_b16 v[172:173], v221 offset:16384
  v_mfma_f32_16x16x32_bf16 v[80:83], v[176:179], v[136:139], v[80:83]
  ds_read_b64_tr_b16 v[174:175], v221 offset:16896
  v_mfma_f32_16x16x32_bf16 v[84:87], v[180:183], v[136:139], v[84:87]
  ds_read_b128 v[156:159], v217 offset:6144
  v_mfma_f32_16x16x32_bf16 v[88:91], v[184:187], v[136:139], v[88:91]
  v_mfma_f32_16x16x32_bf16 v[92:95], v[188:191], v[136:139], v[92:95]
  v_mfma_f32_16x16x32_bf16 v[112:115], v[176:179], v[140:143], v[112:115]
  v_mfma_f32_16x16x32_bf16 v[116:119], v[180:183], v[140:143], v[116:119]
  v_mfma_f32_16x16x32_bf16 v[120:123], v[184:187], v[140:143], v[120:123]
  v_mfma_f32_16x16x32_bf16 v[124:127], v[188:191], v[140:143], v[124:127]
  s_waitcnt lgkmcnt(0)
  v_mfma_f32_16x16x32_bf16 v[0:3], v[160:163], v[144:147], v[0:3]
  ds_read_b64_tr_b16 v[176:177], v218 offset:17408
  v_mfma_f32_16x16x32_bf16 v[4:7], v[164:167], v[144:147], v[4:7]
  ds_read_b64_tr_b16 v[178:179], v218 offset:17920
  v_mfma_f32_16x16x32_bf16 v[8:11], v[168:171], v[144:147], v[8:11]
  ds_read_b64_tr_b16 v[180:181], v219 offset:17408
  v_mfma_f32_16x16x32_bf16 v[12:15], v[172:175], v[144:147], v[12:15]
  ds_read_b64_tr_b16 v[182:183], v219 offset:17920
  v_mfma_f32_16x16x32_bf16 v[32:35], v[160:163], v[148:151], v[32:35]
  ds_read_b64_tr_b16 v[184:185], v220 offset:17408
  v_mfma_f32_16x16x32_bf16 v[36:39], v[164:167], v[148:151], v[36:39]
  ds_read_b64_tr_b16 v[186:187], v220 offset:17920
  v_mfma_f32_16x16x32_bf16 v[40:43], v[168:171], v[148:151], v[40:43]
  ds_read_b64_tr_b16 v[188:189], v221 offset:17408
  v_mfma_f32_16x16x32_bf16 v[44:47], v[172:175], v[148:151], v[44:47]
  ds_read_b64_tr_b16 v[190:191], v221 offset:17920
  v_mfma_f32_16x16x32_bf16 v[64:67], v[160:163], v[152:155], v[64:67]
  ds_read_b64_tr_b16 v[192:193], v222 offset:0
  v_mfma_f32_16x16x32_bf16 v[68:71], v[164:167], v[152:155], v[68:71]
  ds_read_b64_tr_b16 v[194:195], v222 offset:256
  v_mfma_f32_16x16x32_bf16 v[72:75], v[168:171], v[152:155], v[72:75]
  ds_read_b64_tr_b16 v[196:197], v222 offset:32
  v_mfma_f32_16x16x32_bf16 v[76:79], v[172:175], v[152:155], v[76:79]
  ds_read_b64_tr_b16 v[198:199], v222 offset:288
  v_mfma_f32_16x16x32_bf16 v[96:99], v[160:163], v[156:159], v[96:99]
  v_mfma_f32_16x16x32_bf16 v[100:103], v[164:167], v[156:159], v[100:103]
  v_mfma_f32_16x16x32_bf16 v[104:107], v[168:171], v[156:159], v[104:107]
  v_mfma_f32_16x16x32_bf16 v[108:111], v[172:175], v[156:159], v[108:111]
  s_waitcnt lgkmcnt(0)
  s_barrier
  v_mfma_f32_16x16x32_bf16 v[16:19], v[176:179], v[144:147], v[16:19]
  v_add_u32 v216, s27, v216
  v_add_u32 v218, s27, v218
  v_mfma_f32_16x16x32_bf16 v[20:23], v[180:183], v[144:147], v[20:23]
  ds_read_b128 v[128:131], v216 offset:0
  ds_read_b64_tr_b16 v[160:161], v218 offset:0
  v_mfma_f32_16x16x32_bf16 v[24:27], v[184:187], v[144:147], v[24:27]
  ds_read_b64_tr_b16 v[162:163], v218 offset:512
  v_add_u32 v219, s27, v219
  v_mfma_f32_16x16x32_bf16 v[28:31], v[188:191], v[144:147], v[28:31]
  ds_read_b128 v[132:135], v216 offset:2048
  ds_read_b64_tr_b16 v[164:165], v219 offset:0
  v_mfma_f32_16x16x32_bf16 v[48:51], v[176:179], v[148:151], v[48:51]
  ds_read_b64_tr_b16 v[166:167], v219 offset:512
  v_add_u32 v220, s27, v220
  v_mfma_f32_16x16x32_bf16 v[52:55], v[180:183], v[148:151], v[52:55]
  ds_read_b128 v[136:139], v216 offset:4096
  ds_read_b64_tr_b16 v[168:169], v220 offset:0
  v_mfma_f32_16x16x32_bf16 v[56:59], v[184:187], v[148:151], v[56:59]
  ds_read_b64_tr_b16 v[170:171], v220 offset:512
  v_add_u32 v221, s27, v221
  v_mfma_f32_16x16x32_bf16 v[60:63], v[188:191], v[148:151], v[60:63]
  ds_read_b128 v[140:143], v216 offset:6144
  ds_read_b64_tr_b16 v[172:173], v221 offset:0
  v_mfma_f32_16x16x32_bf16 v[80:83], v[176:179], v[152:155], v[80:83]
  ds_read_b64_tr_b16 v[174:175], v221 offset:512
  v_mfma_f32_16x16x32_bf16 v[84:87], v[180:183], v[152:155], v[84:87]
  v_add_u32 v217, s27, v217
  v_mfma_f32_16x16x32_bf16 v[200:203], v[192:195], v[144:147], v[200:203]
  v_add_u32 v222, s27, v222
  v_mfma_f32_16x16x32_bf16 v[88:91], v[184:187], v[152:155], v[88:91]
  s_sub_u32 s28, s28, 1
  v_mfma_f32_16x16x32_bf16 v[204:207], v[196:199], v[144:147], v[204:207]
  s_cmp_lg_u32 s28, 0
  v_mfma_f32_16x16x32_bf16 v[92:95], v[188:191], v[152:155], v[92:95]
  v_mfma_f32_16x16x32_bf16 v[208:211], v[192:195], v[148:151], v[208:211]
  v_mfma_f32_16x16x32_bf16 v[112:115], v[176:179], v[156:159], v[112:115]
  v_mfma_f32_16x16x32_bf16 v[212:215], v[196:199], v[148:151], v[212:215]
  v_mfma_f32_16x16x32_bf16 v[116:119], v[180:183], v[156:159], v[116:119]
  v_mfma_f32_16x16x32_bf16 v[120:123], v[184:187], v[156:159], v[120:123]
  v_mfma_f32_16x16x32_bf16 v[124:127], v[188:191], v[156:159], v[124:127]
  s_cbranch_scc1 p1_c_B1_loop
  s_waitcnt lgkmcnt(0)
  v_mfma_f32_16x16x32_bf16 v[0:3], v[160:163], v[128:131], v[0:3]
  ds_read_b128 v[144:147], v217 offset:0
  v_mfma_f32_16x16x32_bf16 v[4:7], v[164:167], v[128:131], v[4:7]
  ds_read_b64_tr_b16 v[176:177], v218 offset:16384
  v_mfma_f32_16x16x32_bf16 v[8:11], v[168:171], v[128:131], v[8:11]
  ds_read_b64_tr_b16 v[178:179], v218 offset:16896
  v_mfma_f32_16x16x32_bf16 v[12:15], v[172:175], v[128:131], v[12:15]
  ds_read_b128 v[148:151], v217 offset:2048
  v_mfma_f32_16x16x32_bf16 v[32:35], v[160:163], v[132:135], v[32:35]
  ds_read_b64_tr_b16 v[180:181], v219 offset:16384
  v_mfma_f32_16x16x32_bf16 v[36:39], v[164:167], v[132:135], v[36:39]
  ds_read_b64_tr_b16 v[182:183], v219 offset:16896
  v_mfma_f32_16x16x32_bf16 v[40:43], v[168:171], v[132:135], v[40:43]
  ds_read_b128 v[152:155], v217 offset:4096
  v_mfma_f32_16x16x32_bf16 v[44:47], v[172:175], v[132:135], v[44:47]
  ds_read_b64_tr_b16 v[184:185], v220 offset:16384
  v_mfma_f32_16x16x32_bf16 v[64:67], v[160:163], v[136:139], v[64:67]
  ds_read_b64_tr_b16 v[186:187], v220 offset:16896
  v_mfma_f32_16x16x32_bf16 v[68:71], v[164:167], v[136:139], v[68:71]
  ds_read_b128 v[156:159], v217 offset:6144
  v_add_u32 v236, 0xfffe6000, v222
  v_mfma_f32_16x16x32_bf16 v[72:75], v[168:171], v[136:139], v[72:75]
  ds_read_b64_tr_b16 v[188:189], v221 offset:16384
  v_add_u32 v235, 0xfffe6000, v221
  v_mfma_f32_16x16x32_bf16 v[76:79], v[172:175], v[136:139], v[76:79]
  ds_read_b64_tr_b16 v[190:191], v221 offset:16896
  v_add_u32 v234, 0xfffe6000, v220
  v_mfma_f32_16x16x32_bf16 v[96:99], v[160:163], v[140:143], v[96:99]
  v_add_u32 v233, 0xfffe6000, v219
  v_mfma_f32_16x16x32_bf16 v[100:103], v[164:167], v[140:143], v[100:103]
  v_add_u32 v232, 0xfffe6000, v218
  v_mfma_f32_16x16x32_bf16 v[104:107], v[168:171], v[140:143], v[104:107]
  v_add_u32 v231, 0xfffe6000, v217
  v_mfma_f32_16x16x32_bf16 v[108:111], v[172:175], v[140:143], v[108:111]
  v_add_u32 v230, 0xfffe6000, v216
  s_waitcnt lgkmcnt(0)
  s_barrier
  v_mfma_f32_16x16x32_bf16 v[0:3], v[176:179], v[144:147], v[0:3]
  ds_read_b128 v[128:131], v230 offset:0
  v_mfma_f32_16x16x32_bf16 v[4:7], v[180:183], v[144:147], v[4:7]
  ds_read_b64_tr_b16 v[160:161], v232 offset:0
  v_mfma_f32_16x16x32_bf16 v[8:11], v[184:187], v[144:147], v[8:11]
  ds_read_b64_tr_b16 v[162:163], v232 offset:512
  v_mfma_f32_16x16x32_bf16 v[12:15], v[188:191], v[144:147], v[12:15]
  ds_read_b128 v[132:135], v230 offset:2048
  v_mfma_f32_16x16x32_bf16 v[32:35], v[176:179], v[148:151], v[32:35]
  ds_read_b64_tr_b16 v[164:165], v233 offset:0
  v_mfma_f32_16x16x32_bf16 v[36:39], v[180:183], v[148:151], v[36:39]
  ds_read_b64_tr_b16 v[166:167], v233 offset:512
  v_mfma_f32_16x16x32_bf16 v[40:43], v[184:187], v[148:151], v[40:43]
  ds_read_b128 v[136:139], v230 offset:4096
  v_mfma_f32_16x16x32_bf16 v[44:47], v[188:191], v[148:151], v[44:47]
  ds_read_b64_tr_b16 v[168:169], v234 offset:0
  v_mfma_f32_16x16x32_bf16 v[64:67], v[176:179], v[152:155], v[64:67]
  ds_read_b64_tr_b16 v[170:171], v234 offset:512
  v_mfma_f32_16x16x32_bf16 v[68:71], v[180:183], v[152:155], v[68:71]
  ds_read_b128 v[140:143], v230 offset:6144
  v_mfma_f32_16x16x32_bf16 v[72:75], v[184:187], v[152:155], v[72:75]
  ds_read_b64_tr_b16 v[172:173], v235 offset:0
  v_mfma_f32_16x16x32_bf16 v[76:79], v[188:191], v[152:155], v[76:79]
  ds_read_b64_tr_b16 v[174:175], v235 offset:512
  v_mfma_f32_16x16x32_bf16 v[96:99], v[176:179], v[156:159], v[96:99]
  v_mfma_f32_16x16x32_bf16 v[100:103], v[180:183], v[156:159], v[100:103]
  v_mfma_f32_16x16x32_bf16 v[104:107], v[184:187], v[156:159], v[104:107]
  v_mfma_f32_16x16x32_bf16 v[108:111], v[188:191], v[156:159], v[108:111]
  s_waitcnt lgkmcnt(0)
  v_mfma_f32_16x16x32_bf16 v[0:3], v[160:163], v[128:131], v[0:3]
  ds_read_b128 v[144:147], v231 offset:0
  v_mfma_f32_16x16x32_bf16 v[4:7], v[164:167], v[128:131], v[4:7]
  ds_read_b64_tr_b16 v[176:177], v232 offset:16384
  v_mfma_f32_16x16x32_bf16 v[8:11], v[168:171], v[128:131], v[8:11]
  ds_read_b64_tr_b16 v[178:179], v232 offset:16896
  v_mfma_f32_16x16x32_bf16 v[12:15], v[172:175], v[128:131], v[12:15]
  ds_read_b128 v[148:151], v231 offset:2048
  v_mfma_f32_16x16x32_bf16 v[32:35], v[160:163], v[132:135], v[32:35]
  ds_read_b64_tr_b16 v[180:181], v233 offset:16384
  v_mfma_f32_16x16x32_bf16 v[36:39], v[164:167], v[132:135], v[36:39]
  ds_read_b64_tr_b16 v[182:183], v233 offset:16896
  v_mfma_f32_16x16x32_bf16 v[40:43], v[168:171], v[132:135], v[40:43]
  ds_read_b128 v[152:155], v231 offset:4096
  v_mfma_f32_16x16x32_bf16 v[44:47], v[172:175], v[132:135], v[44:47]
  ds_read_b64_tr_b16 v[184:185], v234 offset:16384
  v_mfma_f32_16x16x32_bf16 v[64:67], v[160:163], v[136:139], v[64:67]
  ds_read_b64_tr_b16 v[186:187], v234 offset:16896
  v_mfma_f32_16x16x32_bf16 v[68:71], v[164:167], v[136:139], v[68:71]
  ds_read_b128 v[156:159], v231 offset:6144
  v_mfma_f32_16x16x32_bf16 v[72:75], v[168:171], v[136:139], v[72:75]
  ds_read_b64_tr_b16 v[188:189], v235 offset:16384
  v_mfma_f32_16x16x32_bf16 v[76:79], v[172:175], v[136:139], v[76:79]
  ds_read_b64_tr_b16 v[190:191], v235 offset:16896
  v_mfma_f32_16x16x32_bf16 v[96:99], v[160:163], v[140:143], v[96:99]
  v_mfma_f32_16x16x32_bf16 v[100:103], v[164:167], v[140:143], v[100:103]
  v_mfma_f32_16x16x32_bf16 v[104:107], v[168:171], v[140:143], v[104:107]
  v_mfma_f32_16x16x32_bf16 v[108:111], v[172:175], v[140:143], v[108:111]
  s_waitcnt lgkmcnt(0)
  v_mfma_f32_16x16x32_bf16 v[0:3], v[176:179], v[144:147], v[0:3]
  ds_read_b64_tr_b16 v[160:161], v232 offset:1024
  v_mfma_f32_16x16x32_bf16 v[4:7], v[180:183], v[144:147], v[4:7]
  ds_read_b64_tr_b16 v[162:163], v232 offset:1536
  v_mfma_f32_16x16x32_bf16 v[8:11], v[184:187], v[144:147], v[8:11]
  ds_read_b64_tr_b16 v[164:165], v233 offset:1024
  v_mfma_f32_16x16x32_bf16 v[12:15], v[188:191], v[144:147], v[12:15]
  ds_read_b64_tr_b16 v[166:167], v233 offset:1536
  v_mfma_f32_16x16x32_bf16 v[32:35], v[176:179], v[148:151], v[32:35]
  ds_read_b64_tr_b16 v[168:169], v234 offset:1024
  v_mfma_f32_16x16x32_bf16 v[36:39], v[180:183], v[148:151], v[36:39]
  ds_read_b64_tr_b16 v[170:171], v234 offset:1536
  v_mfma_f32_16x16x32_bf16 v[40:43], v[184:187], v[148:151], v[40:43]
  ds_read_b64_tr_b16 v[172:173], v235 offset:1024
  v_mfma_f32_16x16x32_bf16 v[44:47], v[188:191], v[148:151], v[44:47]
  ds_read_b64_tr_b16 v[174:175], v235 offset:1536
  v_mfma_f32_16x16x32_bf16 v[64:67], v[176:179], v[152:155], v[64:67]
  v_mfma_f32_16x16x32_bf16 v[68:71], v[180:183], v[152:155], v[68:71]
  v_mfma_f32_16x16x32_bf16 v[72:75], v[184:187], v[152:155], v[72:75]
  v_mfma_f32_16x16x32_bf16 v[76:79], v[188:191], v[152:155], v[76:79]
  v_mfma_f32_16x16x32_bf16 v[96:99], v[176:179], v[156:159], v[96:99]
  v_mfma_f32_16x16x32_bf16 v[100:103], v[180:183], v[156:159], v[100:103]
  v_mfma_f32_16x16x32_bf16 v[104:107], v[184:187], v[156:159], v[104:107]
  v_mfma_f32_16x16x32_bf16 v[108:111], v[188:191], v[156:159], v[108:111]
  s_waitcnt lgkmcnt(0)
  v_mfma_f32_16x16x32_bf16 v[16:19], v[160:163], v[128:131], v[16:19]
  ds_read_b64_tr_b16 v[176:177], v232 offset:17408
  v_mfma_f32_16x16x32_bf16 v[20:23], v[164:167], v[128:131], v[20:23]
  ds_read_b64_tr_b16 v[178:179], v232 offset:17920
  v_mfma_f32_16x16x32_bf16 v[24:27], v[168:171], v[128:131], v[24:27]
  ds_read_b64_tr_b16 v[180:181], v233 offset:17408
  v_mfma_f32_16x16x32_bf16 v[28:31], v[172:175], v[128:131], v[28:31]
  ds_read_b64_tr_b16 v[182:183], v233 offset:17920
  v_mfma_f32_16x16x32_bf16 v[48:51], v[160:163], v[132:135], v[48:51]
  ds_read_b64_tr_b16 v[184:185], v234 offset:17408
  v_cvt_pk_bf16_f32 v0, v0, v1
  v_mfma_f32_16x16x32_bf16 v[52:55], v[164:167], v[132:135], v[52:55]
  ds_read_b64_tr_b16 v[186:187], v234 offset:17920
  v_cvt_pk_bf16_f32 v1, v2, v3
  v_mfma_f32_16x16x32_bf16 v[56:59], v[168:171], v[132:135], v[56:59]
  ds_read_b64_tr_b16 v[188:189], v235 offset:17408
  v_cvt_pk_bf16_f32 v2, v4, v5
  v_mfma_f32_16x16x32_bf16 v[60:63], v[172:175], v[132:135], v[60:63]
  ds_read_b64_tr_b16 v[190:191], v235 offset:17920
  v_cvt_pk_bf16_f32 v3, v6, v7
  v_mfma_f32_16x16x32_bf16 v[80:83], v[160:163], v[136:139], v[80:83]
  ds_read_b64_tr_b16 v[192:193], v236 offset:0
  s_mul_i32 s7, s31, 0
  v_mfma_f32_16x16x32_bf16 v[84:87], v[164:167], v[136:139], v[84:87]
  ds_read_b64_tr_b16 v[194:195], v236 offset:256
  s_add_u32 s7, s7, s30
  v_mfma_f32_16x16x32_bf16 v[88:91], v[168:171], v[136:139], v[88:91]
  ds_read_b64_tr_b16 v[196:197], v236 offset:32
  buffer_store_dwordx4 v[0:3], v224, s[20:23], s7 offen sc1
  v_mfma_f32_16x16x32_bf16 v[92:95], v[172:175], v[136:139], v[92:95]
  ds_read_b64_tr_b16 v[198:199], v236 offset:288
  v_cvt_pk_bf16_f32 v32, v32, v33
  v_mfma_f32_16x16x32_bf16 v[112:115], v[160:163], v[140:143], v[112:115]
  v_cvt_pk_bf16_f32 v33, v34, v35
  v_mfma_f32_16x16x32_bf16 v[116:119], v[164:167], v[140:143], v[116:119]
  v_cvt_pk_bf16_f32 v34, v36, v37
  v_mfma_f32_16x16x32_bf16 v[120:123], v[168:171], v[140:143], v[120:123]
  v_cvt_pk_bf16_f32 v35, v38, v39
  v_mfma_f32_16x16x32_bf16 v[124:127], v[172:175], v[140:143], v[124:127]
  buffer_store_dwordx4 v[32:35], v224, s[20:23], s7 offen offset:256 sc1
  s_waitcnt lgkmcnt(0)
  v_mfma_f32_16x16x32_bf16 v[16:19], v[176:179], v[144:147], v[16:19]
  ds_read_b128 v[128:131], v216 offset:0
  v_cvt_pk_bf16_f32 v8, v8, v9
  v_mfma_f32_16x16x32_bf16 v[20:23], v[180:183], v[144:147], v[20:23]
  ds_read_b64_tr_b16 v[160:161], v218 offset:1024
  v_cvt_pk_bf16_f32 v9, v10, v11
  v_mfma_f32_16x16x32_bf16 v[24:27], v[184:187], v[144:147], v[24:27]
  ds_read_b64_tr_b16 v[162:163], v218 offset:1536
  v_cvt_pk_bf16_f32 v10, v12, v13
  v_mfma_f32_16x16x32_bf16 v[28:31], v[188:191], v[144:147], v[28:31]
  ds_read_b128 v[132:135], v216 offset:2048
  v_cvt_pk_bf16_f32 v11, v14, v15
  v_mfma_f32_16x16x32_bf16 v[48:51], v[176:179], v[148:151], v[48:51]
  ds_read_b64_tr_b16 v[164:165], v219 offset:1024
  s_mul_i32 s7, s31, 1
  v_mfma_f32_16x16x32_bf16 v[52:55], v[180:183], v[148:151], v[52:55]
  ds_read_b64_tr_b16 v[166:167], v219 offset:1536
  s_add_u32 s7, s7, s30
  v_mfma_f32_16x16x32_bf16 v[56:59], v[184:187], v[148:151], v[56:59]
  ds_read_b128 v[136:139], v216 offset:4096
  buffer_store_dwordx4 v[8:11], v224, s[20:23], s7 offen sc1
  v_mfma_f32_16x16x32_bf16 v[60:63], v[188:191], v[148:151], v[60:63]
  ds_read_b64_tr_b16 v[168:169], v220 offset:1024
  v_cvt_pk_bf16_f32 v40, v40, v41
  v_mfma_f32_16x16x32_bf16 v[80:83], v[176:179], v[152:155], v[80:83]
  ds_read_b64_tr_b16 v[170:171], v220 offset:1536
  v_cvt_pk_bf16_f32 v41, v42, v43
  v_mfma_f32_16x16x32_bf16 v[84:87], v[180:183], v[152:155], v[84:87]
  ds_read_b128 v[140:143], v216 offset:6144
  v_cvt_pk_bf16_f32 v42, v44, v45
  v_mfma_f32_16x16x32_bf16 v[200:203], v[192:195], v[144:147], v[200:203]
  ds_read_b64_tr_b16 v[172:173], v221 offset:1024
  v_cvt_pk_bf16_f32 v43, v46, v47
  v_mfma_f32_16x16x32_bf16 v[88:91], v[184:187], v[152:155], v[88:91]
  ds_read_b64_tr_b16 v[174:175], v221 offset:1536
  buffer_store_dwordx4 v[40:43], v224, s[20:23], s7 offen offset:256 sc1
  v_mfma_f32_16x16x32_bf16 v[204:207], v[196:199], v[144:147], v[204:207]
  v_cvt_pk_bf16_f32 v64, v64, v65
  v_mfma_f32_16x16x32_bf16 v[92:95], v[188:191], v[152:155], v[92:95]
  v_cvt_pk_bf16_f32 v65, v66, v67
  v_mfma_f32_16x16x32_bf16 v[208:211], v[192:195], v[148:151], v[208:211]
  v_cvt_pk_bf16_f32 v66, v68, v69
  v_mfma_f32_16x16x32_bf16 v[112:115], v[176:179], v[156:159], v[112:115]
  v_cvt_pk_bf16_f32 v67, v70, v71
  v_mfma_f32_16x16x32_bf16 v[212:215], v[196:199], v[148:151], v[212:215]
  s_mul_i32 s7, s31, 0
  v_mfma_f32_16x16x32_bf16 v[116:119], v[180:183], v[156:159], v[116:119]
  s_add_u32 s7, s7, s30
  v_mfma_f32_16x16x32_bf16 v[120:123], v[184:187], v[156:159], v[120:123]
  s_add_u32 s7, s7, s32
  v_mfma_f32_16x16x32_bf16 v[124:127], v[188:191], v[156:159], v[124:127]
  buffer_store_dwordx4 v[64:67], v224, s[20:23], s7 offen sc1
  s_waitcnt lgkmcnt(0)
  v_mfma_f32_16x16x32_bf16 v[16:19], v[160:163], v[128:131], v[16:19]
  ds_read_b128 v[144:147], v217 offset:0
  v_cvt_pk_bf16_f32 v96, v96, v97
  v_mfma_f32_16x16x32_bf16 v[20:23], v[164:167], v[128:131], v[20:23]
  ds_read_b64_tr_b16 v[176:177], v218 offset:17408
  v_cvt_pk_bf16_f32 v97, v98, v99
  v_mfma_f32_16x16x32_bf16 v[24:27], v[168:171], v[128:131], v[24:27]
  ds_read_b64_tr_b16 v[178:179], v218 offset:17920
  v_cvt_pk_bf16_f32 v98, v100, v101
  v_mfma_f32_16x16x32_bf16 v[28:31], v[172:175], v[128:131], v[28:31]
  ds_read_b128 v[148:151], v217 offset:2048
  v_cvt_pk_bf16_f32 v99, v102, v103
  v_mfma_f32_16x16x32_bf16 v[48:51], v[160:163], v[132:135], v[48:51]
  ds_read_b64_tr_b16 v[180:181], v219 offset:17408
  buffer_store_dwordx4 v[96:99], v224, s[20:23], s7 offen offset:256 sc1
  v_mfma_f32_16x16x32_bf16 v[52:55], v[164:167], v[132:135], v[52:55]
  ds_read_b64_tr_b16 v[182:183], v219 offset:17920
  v_cvt_pk_bf16_f32 v72, v72, v73
  v_mfma_f32_16x16x32_bf16 v[56:59], v[168:171], v[132:135], v[56:59]
  ds_read_b128 v[152:155], v217 offset:4096
  v_cvt_pk_bf16_f32 v73, v74, v75
  v_mfma_f32_16x16x32_bf16 v[60:63], v[172:175], v[132:135], v[60:63]
  ds_read_b64_tr_b16 v[184:185], v220 offset:17408
  v_cvt_pk_bf16_f32 v74, v76, v77
  v_mfma_f32_16x16x32_bf16 v[80:83], v[160:163], v[136:139], v[80:83]
  ds_read_b64_tr_b16 v[186:187], v220 offset:17920
  v_cvt_pk_bf16_f32 v75, v78, v79
  v_mfma_f32_16x16x32_bf16 v[84:87], v[164:167], v[136:139], v[84:87]
  ds_read_b128 v[156:159], v217 offset:6144
  s_mul_i32 s7, s31, 1
  v_mfma_f32_16x16x32_bf16 v[88:91], v[168:171], v[136:139], v[88:91]
  ds_read_b64_tr_b16 v[188:189], v221 offset:17408
  s_add_u32 s7, s7, s30
  v_mfma_f32_16x16x32_bf16 v[92:95], v[172:175], v[136:139], v[92:95]
  ds_read_b64_tr_b16 v[190:191], v221 offset:17920
  s_add_u32 s7, s7, s32
  v_mfma_f32_16x16x32_bf16 v[112:115], v[160:163], v[140:143], v[112:115]
  ds_read_b64_tr_b16 v[192:193], v222 offset:0
  buffer_store_dwordx4 v[72:75], v224, s[20:23], s7 offen sc1
  v_mfma_f32_16x16x32_bf16 v[116:119], v[164:167], v[140:143], v[116:119]
  ds_read_b64_tr_b16 v[194:195], v222 offset:256
  v_cvt_pk_bf16_f32 v104, v104, v105
  v_mfma_f32_16x16x32_bf16 v[120:123], v[168:171], v[140:143], v[120:123]
  ds_read_b64_tr_b16 v[196:197], v222 offset:32
  v_cvt_pk_bf16_f32 v105, v106, v107
  v_mfma_f32_16x16x32_bf16 v[124:127], v[172:175], v[140:143], v[124:127]
  ds_read_b64_tr_b16 v[198:199], v222 offset:288
  v_cvt_pk_bf16_f32 v106, v108, v109
  s_waitcnt lgkmcnt(0)
  v_mfma_f32_16x16x32_bf16 v[16:19], v[176:179], v[144:147], v[16:19]
  v_cvt_pk_bf16_f32 v107, v110, v111
  v_mfma_f32_16x16x32_bf16 v[20:23], v[180:183], v[144:147], v[20:23]
  buffer_store_dwordx4 v[104:107], v224, s[20:23], s7 offen offset:256 sc1
  v_mfma_f32_16x16x32_bf16 v[24:27], v[184:187], v[144:147], v[24:27]
  v_mfma_f32_16x16x32_bf16 v[28:31], v[188:191], v[144:147], v[28:31]
  v_mfma_f32_16x16x32_bf16 v[48:51], v[176:179], v[148:151], v[48:51]
  v_mfma_f32_16x16x32_bf16 v[52:55], v[180:183], v[148:151], v[52:55]
  v_mfma_f32_16x16x32_bf16 v[56:59], v[184:187], v[148:151], v[56:59]
  v_mfma_f32_16x16x32_bf16 v[60:63], v[188:191], v[148:151], v[60:63]
  v_mfma_f32_16x16x32_bf16 v[80:83], v[176:179], v[152:155], v[80:83]
  v_mfma_f32_16x16x32_bf16 v[84:87], v[180:183], v[152:155], v[84:87]
  v_mfma_f32_16x16x32_bf16 v[200:203], v[192:195], v[144:147], v[200:203]
  v_mfma_f32_16x16x32_bf16 v[88:91], v[184:187], v[152:155], v[88:91]
  v_mfma_f32_16x16x32_bf16 v[204:207], v[196:199], v[144:147], v[204:207]
  v_mfma_f32_16x16x32_bf16 v[92:95], v[188:191], v[152:155], v[92:95]
  v_mfma_f32_16x16x32_bf16 v[208:211], v[192:195], v[148:151], v[208:211]
  v_mfma_f32_16x16x32_bf16 v[112:115], v[176:179], v[156:159], v[112:115]
  v_mfma_f32_16x16x32_bf16 v[212:215], v[196:199], v[148:151], v[212:215]
  v_mfma_f32_16x16x32_bf16 v[116:119], v[180:183], v[156:159], v[116:119]
  v_mfma_f32_16x16x32_bf16 v[120:123], v[184:187], v[156:159], v[120:123]
  v_mfma_f32_16x16x32_bf16 v[124:127], v[188:191], v[156:159], v[124:127]
  s_nop 7
  s_lshl_b32 s7, s24, 12
  s_add_u32 s7, s7, 53248
  v_add_u32 v226, s7, v223
  ds_write_b128 v226, v[200:203] offset:0
  ds_write_b128 v226, v[204:207] offset:1024
  ds_write_b128 v226, v[208:211] offset:2048
  ds_write_b128 v226, v[212:215] offset:3072
  v_cvt_pk_bf16_f32 v16, v16, v17
  v_cvt_pk_bf16_f32 v17, v18, v19
  v_cvt_pk_bf16_f32 v18, v20, v21
  v_cvt_pk_bf16_f32 v19, v22, v23
  s_mul_i32 s7, s31, 2
  s_add_u32 s7, s7, s30
  buffer_store_dwordx4 v[16:19], v224, s[20:23], s7 offen sc1
  v_cvt_pk_bf16_f32 v48, v48, v49
  v_cvt_pk_bf16_f32 v49, v50, v51
  v_cvt_pk_bf16_f32 v50, v52, v53
  v_cvt_pk_bf16_f32 v51, v54, v55
  buffer_store_dwordx4 v[48:51], v224, s[20:23], s7 offen offset:256 sc1
  v_cvt_pk_bf16_f32 v24, v24, v25
  v_cvt_pk_bf16_f32 v25, v26, v27
  v_cvt_pk_bf16_f32 v26, v28, v29
  v_cvt_pk_bf16_f32 v27, v30, v31
  s_mul_i32 s7, s31, 3
  s_add_u32 s7, s7, s30
  buffer_store_dwordx4 v[24:27], v224, s[20:23], s7 offen sc1
  v_cvt_pk_bf16_f32 v56, v56, v57
  v_cvt_pk_bf16_f32 v57, v58, v59
  v_cvt_pk_bf16_f32 v58, v60, v61
  v_cvt_pk_bf16_f32 v59, v62, v63
  buffer_store_dwordx4 v[56:59], v224, s[20:23], s7 offen offset:256 sc1
  v_cvt_pk_bf16_f32 v80, v80, v81
  v_cvt_pk_bf16_f32 v81, v82, v83
  v_cvt_pk_bf16_f32 v82, v84, v85
  v_cvt_pk_bf16_f32 v83, v86, v87
  s_mul_i32 s7, s31, 2
  s_add_u32 s7, s7, s30
  s_add_u32 s7, s7, s32
  buffer_store_dwordx4 v[80:83], v224, s[20:23], s7 offen sc1
  v_cvt_pk_bf16_f32 v112, v112, v113
  v_cvt_pk_bf16_f32 v113, v114, v115
  v_cvt_pk_bf16_f32 v114, v116, v117
  v_cvt_pk_bf16_f32 v115, v118, v119
  buffer_store_dwordx4 v[112:115], v224, s[20:23], s7 offen offset:256 sc1
  v_cvt_pk_bf16_f32 v88, v88, v89
  v_cvt_pk_bf16_f32 v89, v90, v91
  v_cvt_pk_bf16_f32 v90, v92, v93
  v_cvt_pk_bf16_f32 v91, v94, v95
  s_mul_i32 s7, s31, 3
  s_add_u32 s7, s7, s30
  s_add_u32 s7, s7, s32
  buffer_store_dwordx4 v[88:91], v224, s[20:23], s7 offen sc1
  v_cvt_pk_bf16_f32 v120, v120, v121
  v_cvt_pk_bf16_f32 v121, v122, v123
  v_cvt_pk_bf16_f32 v122, v124, v125
  v_cvt_pk_bf16_f32 v123, v126, v127
  buffer_store_dwordx4 v[120:123], v224, s[20:23], s7 offen offset:256 sc1
  s_waitcnt lgkmcnt(0)
  s_barrier
  s_endpgm
p1_c_B2:
  s_lshl_b32 s7, s6, 3
  s_lshl_b32 s33, s25, 2
  s_add_u32 s7, s7, s33
  s_lshl_b32 s33, s5, 2
  s_lshl_b32 s36, s24, 1
  s_add_u32 s33, s33, s36
  s_mov_b32 s31, 131072
  s_mov_b32 s32, 2048
  s_mov_b32 s36, 12582912
  s_mov_b32 s34, 0x3e8293ee
  s_mov_b32 s35, s34
  s_mul_i32 s7, s7, s31
  s_mul_i32 s33, s33, s32
  s_add_u32 s30, s7, s33
  s_add_u32 s30, s30, s36
  s_mov_b32 s28, 14
  s_waitcnt lgkmcnt(0)
  s_barrier
  ds_read_b128 v[128:131], v216 offset:0
  ds_read_b64_tr_b16 v[160:161], v218 offset:0
  ds_read_b64_tr_b16 v[162:163], v218 offset:512
  ds_read_b128 v[132:135], v216 offset:2048
  ds_read_b64_tr_b16 v[164:165], v219 offset:0
  ds_read_b64_tr_b16 v[166:167], v219 offset:512
  ds_read_b128 v[136:139], v216 offset:4096
  ds_read_b64_tr_b16 v[168:169], v220 offset:0
  ds_read_b64_tr_b16 v[170:171], v220 offset:512
  ds_read_b128 v[140:143], v216 offset:6144
  ds_read_b64_tr_b16 v[172:173], v221 offset:0
  ds_read_b64_tr_b16 v[174:175], v221 offset:512
  .p2align 6
p1_c_B2_loop:
  s_waitcnt lgkmcnt(0)
  v_mfma_f32_16x16x32_bf16 v[0:3], v[160:163], v[128:131], v[0:3]
  ds_read_b64_tr_b16 v[176:177], v218 offset:1024
  v_mfma_f32_16x16x32_bf16 v[4:7], v[164:167], v[128:131], v[4:7]
  ds_read_b64_tr_b16 v[178:179], v218 offset:1536
  v_mfma_f32_16x16x32_bf16 v[8:11], v[168:171], v[128:131], v[8:11]
  ds_read_b64_tr_b16 v[180:181], v219 offset:1024
  v_mfma_f32_16x16x32_bf16 v[12:15], v[172:175], v[128:131], v[12:15]
  ds_read_b64_tr_b16 v[182:183], v219 offset:1536
  v_mfma_f32_16x16x32_bf16 v[32:35], v[160:163], v[132:135], v[32:35]
  ds_read_b128 v[144:147], v217 offset:0
  v_mfma_f32_16x16x32_bf16 v[36:39], v[164:167], v[132:135], v[36:39]
  ds_read_b64_tr_b16 v[184:185], v220 offset:1024
  v_mfma_f32_16x16x32_bf16 v[40:43], v[168:171], v[132:135], v[40:43]
  ds_read_b64_tr_b16 v[186:187], v220 offset:1536
  v_mfma_f32_16x16x32_bf16 v[44:47], v[172:175], v[132:135], v[44:47]
  ds_read_b64_tr_b16 v[188:189], v221 offset:1024
  v_mfma_f32_16x16x32_bf16 v[64:67], v[160:163], v[136:139], v[64:67]
  ds_read_b64_tr_b16 v[190:191], v221 offset:1536
  v_mfma_f32_16x16x32_bf16 v[68:71], v[164:167], v[136:139], v[68:71]
  ds_read_b128 v[148:151], v217 offset:2048
  v_mfma_f32_16x16x32_bf16 v[72:75], v[168:171], v[136:139], v[72:75]
  ds_read_b64_tr_b16 v[192:193], v222 offset:0
  v_mfma_f32_16x16x32_bf16 v[76:79], v[172:175], v[136:139], v[76:79]
  ds_read_b64_tr_b16 v[194:195], v222 offset:256
  v_mfma_f32_16x16x32_bf16 v[96:99], v[160:163], v[140:143], v[96:99]
  ds_read_b64_tr_b16 v[196:197], v222 offset:32
  v_mfma_f32_16x16x32_bf16 v[100:103], v[164:167], v[140:143], v[100:103]
  ds_read_b64_tr_b16 v[198:199], v222 offset:288
  v_mfma_f32_16x16x32_bf16 v[104:107], v[168:171], v[140:143], v[104:107]
  s_add_u32 s26, s26, 1
  s_cmp_eq_u32 s26, 3
  v_mfma_f32_16x16x32_bf16 v[108:111], v[172:175], v[140:143], v[108:111]
  s_cselect_b32 s27, s50, s51
  s_cselect_b32 s26, 0, s26
  s_waitcnt lgkmcnt(0)
  v_mfma_f32_16x16x32_bf16 v[16:19], v[176:179], v[128:131], v[16:19]
  ds_read_b64_tr_b16 v[160:161], v218 offset:16384
  v_mfma_f32_16x16x32_bf16 v[20:23], v[180:183], v[128:131], v[20:23]
  ds_read_b64_tr_b16 v[162:163], v218 offset:16896
  v_mfma_f32_16x16x32_bf16 v[24:27], v[184:187], v[128:131], v[24:27]
  ds_read_b64_tr_b16 v[164:165], v219 offset:16384
  v_mfma_f32_16x16x32_bf16 v[28:31], v[188:191], v[128:131], v[28:31]
  ds_read_b64_tr_b16 v[166:167], v219 offset:16896
  v_mfma_f32_16x16x32_bf16 v[48:51], v[176:179], v[132:135], v[48:51]
  ds_read_b128 v[152:155], v217 offset:4096
  v_mfma_f32_16x16x32_bf16 v[52:55], v[180:183], v[132:135], v[52:55]
  ds_read_b64_tr_b16 v[168:169], v220 offset:16384
  v_mfma_f32_16x16x32_bf16 v[56:59], v[184:187], v[132:135], v[56:59]
  ds_read_b64_tr_b16 v[170:171], v220 offset:16896
  v_mfma_f32_16x16x32_bf16 v[60:63], v[188:191], v[132:135], v[60:63]
  ds_read_b64_tr_b16 v[172:173], v221 offset:16384
  v_mfma_f32_16x16x32_bf16 v[80:83], v[176:179], v[136:139], v[80:83]
  ds_read_b64_tr_b16 v[174:175], v221 offset:16896
  v_mfma_f32_16x16x32_bf16 v[84:87], v[180:183], v[136:139], v[84:87]
  ds_read_b128 v[156:159], v217 offset:6144
  v_mfma_f32_16x16x32_bf16 v[200:203], v[128:131], v[192:195], v[200:203]
  v_mfma_f32_16x16x32_bf16 v[88:91], v[184:187], v[136:139], v[88:91]
  v_mfma_f32_16x16x32_bf16 v[208:211], v[128:131], v[196:199], v[208:211]
  v_mfma_f32_16x16x32_bf16 v[92:95], v[188:191], v[136:139], v[92:95]
  v_mfma_f32_16x16x32_bf16 v[204:207], v[132:135], v[192:195], v[204:207]
  v_mfma_f32_16x16x32_bf16 v[112:115], v[176:179], v[140:143], v[112:115]
  v_mfma_f32_16x16x32_bf16 v[212:215], v[132:135], v[196:199], v[212:215]
  v_mfma_f32_16x16x32_bf16 v[116:119], v[180:183], v[140:143], v[116:119]
  v_mfma_f32_16x16x32_bf16 v[120:123], v[184:187], v[140:143], v[120:123]
  v_mfma_f32_16x16x32_bf16 v[124:127], v[188:191], v[140:143], v[124:127]
  s_waitcnt lgkmcnt(0)
  v_mfma_f32_16x16x32_bf16 v[0:3], v[160:163], v[144:147], v[0:3]
  ds_read_b64_tr_b16 v[176:177], v218 offset:17408
  v_mfma_f32_16x16x32_bf16 v[4:7], v[164:167], v[144:147], v[4:7]
  ds_read_b64_tr_b16 v[178:179], v218 offset:17920
  v_mfma_f32_16x16x32_bf16 v[8:11], v[168:171], v[144:147], v[8:11]
  ds_read_b64_tr_b16 v[180:181], v219 offset:17408
  v_mfma_f32_16x16x32_bf16 v[12:15], v[172:175], v[144:147], v[12:15]
  ds_read_b64_tr_b16 v[182:183], v219 offset:17920
  v_mfma_f32_16x16x32_bf16 v[32:35], v[160:163], v[148:151], v[32:35]
  ds_read_b64_tr_b16 v[184:185], v220 offset:17408
  v_mfma_f32_16x16x32_bf16 v[36:39], v[164:167], v[148:151], v[36:39]
  ds_read_b64_tr_b16 v[186:187], v220 offset:17920
  v_mfma_f32_16x16x32_bf16 v[40:43], v[168:171], v[148:151], v[40:43]
  ds_read_b64_tr_b16 v[188:189], v221 offset:17408
  v_mfma_f32_16x16x32_bf16 v[44:47], v[172:175], v[148:151], v[44:47]
  ds_read_b64_tr_b16 v[190:191], v221 offset:17920
  v_mfma_f32_16x16x32_bf16 v[64:67], v[160:163], v[152:155], v[64:67]
  v_mfma_f32_16x16x32_bf16 v[68:71], v[164:167], v[152:155], v[68:71]
  v_mfma_f32_16x16x32_bf16 v[72:75], v[168:171], v[152:155], v[72:75]
  v_mfma_f32_16x16x32_bf16 v[76:79], v[172:175], v[152:155], v[76:79]
  v_mfma_f32_16x16x32_bf16 v[96:99], v[160:163], v[156:159], v[96:99]
  v_mfma_f32_16x16x32_bf16 v[100:103], v[164:167], v[156:159], v[100:103]
  v_mfma_f32_16x16x32_bf16 v[104:107], v[168:171], v[156:159], v[104:107]
  v_mfma_f32_16x16x32_bf16 v[108:111], v[172:175], v[156:159], v[108:111]
  s_waitcnt lgkmcnt(0)
  s_barrier
  v_mfma_f32_16x16x32_bf16 v[16:19], v[176:179], v[144:147], v[16:19]
  v_add_u32 v216, s27, v216
  v_add_u32 v218, s27, v218
  v_mfma_f32_16x16x32_bf16 v[20:23], v[180:183], v[144:147], v[20:23]
  ds_read_b128 v[128:131], v216 offset:0
  ds_read_b64_tr_b16 v[160:161], v218 offset:0
  v_mfma_f32_16x16x32_bf16 v[24:27], v[184:187], v[144:147], v[24:27]
  ds_read_b64_tr_b16 v[162:163], v218 offset:512
  v_add_u32 v219, s27, v219
  v_mfma_f32_16x16x32_bf16 v[28:31], v[188:191], v[144:147], v[28:31]
  ds_read_b128 v[132:135], v216 offset:2048
  ds_read_b64_tr_b16 v[164:165], v219 offset:0
  v_mfma_f32_16x16x32_bf16 v[48:51], v[176:179], v[148:151], v[48:51]
  ds_read_b64_tr_b16 v[166:167], v219 offset:512
  v_add_u32 v220, s27, v220
  v_mfma_f32_16x16x32_bf16 v[52:55], v[180:183], v[148:151], v[52:55]
  ds_read_b128 v[136:139], v216 offset:4096
  ds_read_b64_tr_b16 v[168:169], v220 offset:0
  v_mfma_f32_16x16x32_bf16 v[56:59], v[184:187], v[148:151], v[56:59]
  ds_read_b64_tr_b16 v[170:171], v220 offset:512
  v_add_u32 v221, s27, v221
  v_mfma_f32_16x16x32_bf16 v[60:63], v[188:191], v[148:151], v[60:63]
  ds_read_b128 v[140:143], v216 offset:6144
  ds_read_b64_tr_b16 v[172:173], v221 offset:0
  v_mfma_f32_16x16x32_bf16 v[80:83], v[176:179], v[152:155], v[80:83]
  ds_read_b64_tr_b16 v[174:175], v221 offset:512
  v_mfma_f32_16x16x32_bf16 v[84:87], v[180:183], v[152:155], v[84:87]
  v_add_u32 v217, s27, v217
  v_mfma_f32_16x16x32_bf16 v[88:91], v[184:187], v[152:155], v[88:91]
  v_add_u32 v222, s27, v222
  v_mfma_f32_16x16x32_bf16 v[92:95], v[188:191], v[152:155], v[92:95]
  s_sub_u32 s28, s28, 1
  v_mfma_f32_16x16x32_bf16 v[112:115], v[176:179], v[156:159], v[112:115]
  s_cmp_lg_u32 s28, 0
  v_mfma_f32_16x16x32_bf16 v[116:119], v[180:183], v[156:159], v[116:119]
  v_mfma_f32_16x16x32_bf16 v[120:123], v[184:187], v[156:159], v[120:123]
  v_mfma_f32_16x16x32_bf16 v[124:127], v[188:191], v[156:159], v[124:127]
  s_cbranch_scc1 p1_c_B2_loop
  s_waitcnt lgkmcnt(0)
  v_mfma_f32_16x16x32_bf16 v[0:3], v[160:163], v[128:131], v[0:3]
  ds_read_b128 v[144:147], v217 offset:0
  v_mfma_f32_16x16x32_bf16 v[4:7], v[164:167], v[128:131], v[4:7]
  ds_read_b64_tr_b16 v[176:177], v218 offset:16384
  v_mfma_f32_16x16x32_bf16 v[8:11], v[168:171], v[128:131], v[8:11]
  ds_read_b64_tr_b16 v[178:179], v218 offset:16896
  v_mfma_f32_16x16x32_bf16 v[12:15], v[172:175], v[128:131], v[12:15]
  ds_read_b128 v[148:151], v217 offset:2048
  v_mfma_f32_16x16x32_bf16 v[32:35], v[160:163], v[132:135], v[32:35]
  ds_read_b64_tr_b16 v[180:181], v219 offset:16384
  v_mfma_f32_16x16x32_bf16 v[36:39], v[164:167], v[132:135], v[36:39]
  ds_read_b64_tr_b16 v[182:183], v219 offset:16896
  v_mfma_f32_16x16x32_bf16 v[40:43], v[168:171], v[132:135], v[40:43]
  ds_read_b128 v[152:155], v217 offset:4096
  v_mfma_f32_16x16x32_bf16 v[44:47], v[172:175], v[132:135], v[44:47]
  ds_read_b64_tr_b16 v[184:185], v220 offset:16384
  v_mfma_f32_16x16x32_bf16 v[64:67], v[160:163], v[136:139], v[64:67]
  ds_read_b64_tr_b16 v[186:187], v220 offset:16896
  v_mfma_f32_16x16x32_bf16 v[68:71], v[164:167], v[136:139], v[68:71]
  ds_read_b128 v[156:159], v217 offset:6144
  v_add_u32 v236, 0xfffe6000, v222
  v_mfma_f32_16x16x32_bf16 v[72:75], v[168:171], v[136:139], v[72:75]
  ds_read_b64_tr_b16 v[188:189], v221 offset:16384
  v_add_u32 v235, 0xfffe6000, v221
  v_mfma_f32_16x16x32_bf16 v[76:79], v[172:175], v[136:139], v[76:79]
  ds_read_b64_tr_b16 v[190:191], v221 offset:16896
  v_add_u32 v234, 0xfffe6000, v220
  v_mfma_f32_16x16x32_bf16 v[96:99], v[160:163], v[140:143], v[96:99]
  v_add_u32 v233, 0xfffe6000, v219
  v_mfma_f32_16x16x32_bf16 v[100:103], v[164:167], v[140:143], v[100:103]
  v_add_u32 v232, 0xfffe6000, v218
  v_mfma_f32_16x16x32_bf16 v[104:107], v[168:171], v[140:143], v[104:107]
  v_add_u32 v231, 0xfffe6000, v217
  v_mfma_f32_16x16x32_bf16 v[108:111], v[172:175], v[140:143], v[108:111]
  v_add_u32 v230, 0xfffe6000, v216
  s_waitcnt lgkmcnt(0)
  s_barrier
  v_mfma_f32_16x16x32_bf16 v[0:3], v[176:179], v[144:147], v[0:3]
  ds_read_b128 v[128:131], v230 offset:0
  v_mfma_f32_16x16x32_bf16 v[4:7], v[180:183], v[144:147], v[4:7]
  ds_read_b64_tr_b16 v[160:161], v232 offset:0
  v_mfma_f32_16x16x32_bf16 v[8:11], v[184:187], v[144:147], v[8:11]
  ds_read_b64_tr_b16 v[162:163], v232 offset:512
  v_mfma_f32_16x16x32_bf16 v[12:15], v[188:191], v[144:147], v[12:15]
  ds_read_b128 v[132:135], v230 offset:2048
  v_mfma_f32_16x16x32_bf16 v[32:35], v[176:179], v[148:151], v[32:35]
  ds_read_b64_tr_b16 v[164:165], v233 offset:0
  v_mfma_f32_16x16x32_bf16 v[36:39], v[180:183], v[148:151], v[36:39]
  ds_read_b64_tr_b16 v[166:167], v233 offset:512
  v_mfma_f32_16x16x32_bf16 v[40:43], v[184:187], v[148:151], v[40:43]
  ds_read_b128 v[136:139], v230 offset:4096
  v_mfma_f32_16x16x32_bf16 v[44:47], v[188:191], v[148:151], v[44:47]
  ds_read_b64_tr_b16 v[168:169], v234 offset:0
  v_mfma_f32_16x16x32_bf16 v[64:67], v[176:179], v[152:155], v[64:67]
  ds_read_b64_tr_b16 v[170:171], v234 offset:512
  v_mfma_f32_16x16x32_bf16 v[68:71], v[180:183], v[152:155], v[68:71]
  ds_read_b128 v[140:143], v230 offset:6144
  v_mfma_f32_16x16x32_bf16 v[72:75], v[184:187], v[152:155], v[72:75]
  ds_read_b64_tr_b16 v[172:173], v235 offset:0
  v_mfma_f32_16x16x32_bf16 v[76:79], v[188:191], v[152:155], v[76:79]
  ds_read_b64_tr_b16 v[174:175], v235 offset:512
  v_mfma_f32_16x16x32_bf16 v[96:99], v[176:179], v[156:159], v[96:99]
  v_mfma_f32_16x16x32_bf16 v[100:103], v[180:183], v[156:159], v[100:103]
  v_mfma_f32_16x16x32_bf16 v[104:107], v[184:187], v[156:159], v[104:107]
  v_mfma_f32_16x16x32_bf16 v[108:111], v[188:191], v[156:159], v[108:111]
  s_waitcnt lgkmcnt(0)
  v_mfma_f32_16x16x32_bf16 v[0:3], v[160:163], v[128:131], v[0:3]
  ds_read_b128 v[144:147], v231 offset:0
  v_mfma_f32_16x16x32_bf16 v[4:7], v[164:167], v[128:131], v[4:7]
  ds_read_b64_tr_b16 v[176:177], v232 offset:16384
  v_mfma_f32_16x16x32_bf16 v[8:11], v[168:171], v[128:131], v[8:11]
  ds_read_b64_tr_b16 v[178:179], v232 offset:16896
  v_mfma_f32_16x16x32_bf16 v[12:15], v[172:175], v[128:131], v[12:15]
  ds_read_b128 v[148:151], v231 offset:2048
  v_mfma_f32_16x16x32_bf16 v[32:35], v[160:163], v[132:135], v[32:35]
  ds_read_b64_tr_b16 v[180:181], v233 offset:16384
  v_mfma_f32_16x16x32_bf16 v[36:39], v[164:167], v[132:135], v[36:39]
  ds_read_b64_tr_b16 v[182:183], v233 offset:16896
  v_mfma_f32_16x16x32_bf16 v[40:43], v[168:171], v[132:135], v[40:43]
  ds_read_b128 v[152:155], v231 offset:4096
  v_mfma_f32_16x16x32_bf16 v[44:47], v[172:175], v[132:135], v[44:47]
  ds_read_b64_tr_b16 v[184:185], v234 offset:16384
  v_mfma_f32_16x16x32_bf16 v[64:67], v[160:163], v[136:139], v[64:67]
  ds_read_b64_tr_b16 v[186:187], v234 offset:16896
  v_mfma_f32_16x16x32_bf16 v[68:71], v[164:167], v[136:139], v[68:71]
  ds_read_b128 v[156:159], v231 offset:6144
  v_mfma_f32_16x16x32_bf16 v[72:75], v[168:171], v[136:139], v[72:75]
  ds_read_b64_tr_b16 v[188:189], v235 offset:16384
  v_mfma_f32_16x16x32_bf16 v[76:79], v[172:175], v[136:139], v[76:79]
  ds_read_b64_tr_b16 v[190:191], v235 offset:16896
  v_mfma_f32_16x16x32_bf16 v[96:99], v[160:163], v[140:143], v[96:99]
  v_mfma_f32_16x16x32_bf16 v[100:103], v[164:167], v[140:143], v[100:103]
  v_mfma_f32_16x16x32_bf16 v[104:107], v[168:171], v[140:143], v[104:107]
  v_mfma_f32_16x16x32_bf16 v[108:111], v[172:175], v[140:143], v[108:111]
  s_waitcnt lgkmcnt(0)
  v_mfma_f32_16x16x32_bf16 v[0:3], v[176:179], v[144:147], v[0:3]
  ds_read_b64_tr_b16 v[160:161], v232 offset:1024
  v_mfma_f32_16x16x32_bf16 v[4:7], v[180:183], v[144:147], v[4:7]
  ds_read_b64_tr_b16 v[162:163], v232 offset:1536
  v_mfma_f32_16x16x32_bf16 v[8:11], v[184:187], v[144:147], v[8:11]
  ds_read_b64_tr_b16 v[164:165], v233 offset:1024
  v_mfma_f32_16x16x32_bf16 v[12:15], v[188:191], v[144:147], v[12:15]
  ds_read_b64_tr_b16 v[166:167], v233 offset:1536
  v_mfma_f32_16x16x32_bf16 v[32:35], v[176:179], v[148:151], v[32:35]
  ds_read_b64_tr_b16 v[168:169], v234 offset:1024
  v_mfma_f32_16x16x32_bf16 v[36:39], v[180:183], v[148:151], v[36:39]
  ds_read_b64_tr_b16 v[170:171], v234 offset:1536
  v_mfma_f32_16x16x32_bf16 v[40:43], v[184:187], v[148:151], v[40:43]
  ds_read_b64_tr_b16 v[172:173], v235 offset:1024
  v_mfma_f32_16x16x32_bf16 v[44:47], v[188:191], v[148:151], v[44:47]
  ds_read_b64_tr_b16 v[174:175], v235 offset:1536
  v_mfma_f32_16x16x32_bf16 v[64:67], v[176:179], v[152:155], v[64:67]
  ds_read_b64_tr_b16 v[192:193], v236 offset:0
  v_mfma_f32_16x16x32_bf16 v[68:71], v[180:183], v[152:155], v[68:71]
  ds_read_b64_tr_b16 v[194:195], v236 offset:256
  v_mfma_f32_16x16x32_bf16 v[72:75], v[184:187], v[152:155], v[72:75]
  ds_read_b64_tr_b16 v[196:197], v236 offset:32
  v_mfma_f32_16x16x32_bf16 v[76:79], v[188:191], v[152:155], v[76:79]
  ds_read_b64_tr_b16 v[198:199], v236 offset:288
  v_mfma_f32_16x16x32_bf16 v[96:99], v[176:179], v[156:159], v[96:99]
  v_mfma_f32_16x16x32_bf16 v[100:103], v[180:183], v[156:159], v[100:103]
  v_mfma_f32_16x16x32_bf16 v[104:107], v[184:187], v[156:159], v[104:107]
  v_mfma_f32_16x16x32_bf16 v[108:111], v[188:191], v[156:159], v[108:111]
  s_waitcnt lgkmcnt(0)
  v_mfma_f32_16x16x32_bf16 v[16:19], v[160:163], v[128:131], v[16:19]
  ds_read_b64_tr_b16 v[176:177], v232 offset:17408
  v_mfma_f32_16x16x32_bf16 v[20:23], v[164:167], v[128:131], v[20:23]
  ds_read_b64_tr_b16 v[178:179], v232 offset:17920
  v_mfma_f32_16x16x32_bf16 v[24:27], v[168:171], v[128:131], v[24:27]
  ds_read_b64_tr_b16 v[180:181], v233 offset:17408
  v_mfma_f32_16x16x32_bf16 v[28:31], v[172:175], v[128:131], v[28:31]
  ds_read_b64_tr_b16 v[182:183], v233 offset:17920
  v_mfma_f32_16x16x32_bf16 v[48:51], v[160:163], v[132:135], v[48:51]
  ds_read_b64_tr_b16 v[184:185], v234 offset:17408
  v_cvt_pk_bf16_f32 v0, v0, v1
  v_mfma_f32_16x16x32_bf16 v[52:55], v[164:167], v[132:135], v[52:55]
  ds_read_b64_tr_b16 v[186:187], v234 offset:17920
  v_cvt_pk_bf16_f32 v1, v2, v3
  v_mfma_f32_16x16x32_bf16 v[56:59], v[168:171], v[132:135], v[56:59]
  ds_read_b64_tr_b16 v[188:189], v235 offset:17408
  v_cvt_pk_bf16_f32 v2, v4, v5
  v_mfma_f32_16x16x32_bf16 v[60:63], v[172:175], v[132:135], v[60:63]
  ds_read_b64_tr_b16 v[190:191], v235 offset:17920
  v_cvt_pk_bf16_f32 v3, v6, v7
  v_mfma_f32_16x16x32_bf16 v[80:83], v[160:163], v[136:139], v[80:83]
  s_mul_i32 s7, s31, 0
  v_mfma_f32_16x16x32_bf16 v[84:87], v[164:167], v[136:139], v[84:87]
  s_add_u32 s7, s7, s30
  v_mfma_f32_16x16x32_bf16 v[200:203], v[128:131], v[192:195], v[200:203]
  buffer_store_dwordx4 v[0:3], v224, s[20:23], s7 offen sc1
  v_mfma_f32_16x16x32_bf16 v[88:91], v[168:171], v[136:139], v[88:91]
  v_cvt_pk_bf16_f32 v32, v32, v33
  v_mfma_f32_16x16x32_bf16 v[208:211], v[128:131], v[196:199], v[208:211]
  v_cvt_pk_bf16_f32 v33, v34, v35
  v_mfma_f32_16x16x32_bf16 v[92:95], v[172:175], v[136:139], v[92:95]
  v_cvt_pk_bf16_f32 v34, v36, v37
  v_mfma_f32_16x16x32_bf16 v[204:207], v[132:135], v[192:195], v[204:207]
  v_cvt_pk_bf16_f32 v35, v38, v39
  v_mfma_f32_16x16x32_bf16 v[112:115], v[160:163], v[140:143], v[112:115]
  buffer_store_dwordx4 v[32:35], v224, s[20:23], s7 offen offset:256 sc1
  v_mfma_f32_16x16x32_bf16 v[212:215], v[132:135], v[196:199], v[212:215]
  v_cvt_pk_bf16_f32 v8, v8, v9
  v_mfma_f32_16x16x32_bf16 v[116:119], v[164:167], v[140:143], v[116:119]
  v_cvt_pk_bf16_f32 v9, v10, v11
  v_mfma_f32_16x16x32_bf16 v[120:123], v[168:171], v[140:143], v[120:123]
  v_cvt_pk_bf16_f32 v10, v12, v13
  v_mfma_f32_16x16x32_bf16 v[124:127], v[172:175], v[140:143], v[124:127]
  v_cvt_pk_bf16_f32 v11, v14, v15
  s_waitcnt lgkmcnt(0)
  v_mfma_f32_16x16x32_bf16 v[16:19], v[176:179], v[144:147], v[16:19]
  ds_read_b128 v[128:131], v216 offset:0
  s_mul_i32 s7, s31, 1
  v_mfma_f32_16x16x32_bf16 v[20:23], v[180:183], v[144:147], v[20:23]
  ds_read_b64_tr_b16 v[160:161], v218 offset:1024
  s_add_u32 s7, s7, s30
  v_mfma_f32_16x16x32_bf16 v[24:27], v[184:187], v[144:147], v[24:27]
  ds_read_b64_tr_b16 v[162:163], v218 offset:1536
  buffer_store_dwordx4 v[8:11], v224, s[20:23], s7 offen sc1
  v_mfma_f32_16x16x32_bf16 v[28:31], v[188:191], v[144:147], v[28:31]
  ds_read_b128 v[132:135], v216 offset:2048
  v_cvt_pk_bf16_f32 v40, v40, v41
  v_mfma_f32_16x16x32_bf16 v[48:51], v[176:179], v[148:151], v[48:51]
  ds_read_b64_tr_b16 v[164:165], v219 offset:1024
  v_cvt_pk_bf16_f32 v41, v42, v43
  v_mfma_f32_16x16x32_bf16 v[52:55], v[180:183], v[148:151], v[52:55]
  ds_read_b64_tr_b16 v[166:167], v219 offset:1536
  v_cvt_pk_bf16_f32 v42, v44, v45
  v_mfma_f32_16x16x32_bf16 v[56:59], v[184:187], v[148:151], v[56:59]
  ds_read_b128 v[136:139], v216 offset:4096
  v_cvt_pk_bf16_f32 v43, v46, v47
  v_mfma_f32_16x16x32_bf16 v[60:63], v[188:191], v[148:151], v[60:63]
  ds_read_b64_tr_b16 v[168:169], v220 offset:1024
  buffer_store_dwordx4 v[40:43], v224, s[20:23], s7 offen offset:256 sc1
  v_mfma_f32_16x16x32_bf16 v[80:83], v[176:179], v[152:155], v[80:83]
  ds_read_b64_tr_b16 v[170:171], v220 offset:1536
  v_cvt_pk_bf16_f32 v64, v64, v65
  v_mfma_f32_16x16x32_bf16 v[84:87], v[180:183], v[152:155], v[84:87]
  ds_read_b128 v[140:143], v216 offset:6144
  v_cvt_pk_bf16_f32 v65, v66, v67
  v_mfma_f32_16x16x32_bf16 v[88:91], v[184:187], v[152:155], v[88:91]
  ds_read_b64_tr_b16 v[172:173], v221 offset:1024
  v_cvt_pk_bf16_f32 v66, v68, v69
  v_mfma_f32_16x16x32_bf16 v[92:95], v[188:191], v[152:155], v[92:95]
  ds_read_b64_tr_b16 v[174:175], v221 offset:1536
  v_cvt_pk_bf16_f32 v67, v70, v71
  v_mfma_f32_16x16x32_bf16 v[112:115], v[176:179], v[156:159], v[112:115]
  ds_read_b64_tr_b16 v[192:193], v222 offset:0
  s_mul_i32 s7, s31, 0
  v_mfma_f32_16x16x32_bf16 v[116:119], v[180:183], v[156:159], v[116:119]
  ds_read_b64_tr_b16 v[194:195], v222 offset:256
  s_add_u32 s7, s7, s30
  v_mfma_f32_16x16x32_bf16 v[120:123], v[184:187], v[156:159], v[120:123]
  ds_read_b64_tr_b16 v[196:197], v222 offset:32
  s_add_u32 s7, s7, s32
  v_mfma_f32_16x16x32_bf16 v[124:127], v[188:191], v[156:159], v[124:127]
  ds_read_b64_tr_b16 v[198:199], v222 offset:288
  buffer_store_dwordx4 v[64:67], v224, s[20:23], s7 offen sc1
  s_waitcnt lgkmcnt(0)
  v_mfma_f32_16x16x32_bf16 v[16:19], v[160:163], v[128:131], v[16:19]
  ds_read_b128 v[144:147], v217 offset:0
  v_cvt_pk_bf16_f32 v96, v96, v97
  v_mfma_f32_16x16x32_bf16 v[20:23], v[164:167], v[128:131], v[20:23]
  ds_read_b64_tr_b16 v[176:177], v218 offset:17408
  v_cvt_pk_bf16_f32 v97, v98, v99
  v_mfma_f32_16x16x32_bf16 v[24:27], v[168:171], v[128:131], v[24:27]
  ds_read_b64_tr_b16 v[178:179], v218 offset:17920
  v_cvt_pk_bf16_f32 v98, v100, v101
  v_mfma_f32_16x16x32_bf16 v[28:31], v[172:175], v[128:131], v[28:31]
  ds_read_b128 v[148:151], v217 offset:2048
  v_cvt_pk_bf16_f32 v99, v102, v103
  v_mfma_f32_16x16x32_bf16 v[48:51], v[160:163], v[132:135], v[48:51]
  ds_read_b64_tr_b16 v[180:181], v219 offset:17408
  buffer_store_dwordx4 v[96:99], v224, s[20:23], s7 offen offset:256 sc1
  v_mfma_f32_16x16x32_bf16 v[52:55], v[164:167], v[132:135], v[52:55]
  ds_read_b64_tr_b16 v[182:183], v219 offset:17920
  v_cvt_pk_bf16_f32 v72, v72, v73
  v_mfma_f32_16x16x32_bf16 v[56:59], v[168:171], v[132:135], v[56:59]
  ds_read_b128 v[152:155], v217 offset:4096
  v_cvt_pk_bf16_f32 v73, v74, v75
  v_mfma_f32_16x16x32_bf16 v[60:63], v[172:175], v[132:135], v[60:63]
  ds_read_b64_tr_b16 v[184:185], v220 offset:17408
  v_cvt_pk_bf16_f32 v74, v76, v77
  v_mfma_f32_16x16x32_bf16 v[80:83], v[160:163], v[136:139], v[80:83]
  ds_read_b64_tr_b16 v[186:187], v220 offset:17920
  v_cvt_pk_bf16_f32 v75, v78, v79
  v_mfma_f32_16x16x32_bf16 v[84:87], v[164:167], v[136:139], v[84:87]
  ds_read_b128 v[156:159], v217 offset:6144
  s_mul_i32 s7, s31, 1
  v_mfma_f32_16x16x32_bf16 v[200:203], v[128:131], v[192:195], v[200:203]
  ds_read_b64_tr_b16 v[188:189], v221 offset:17408
  s_add_u32 s7, s7, s30
  v_mfma_f32_16x16x32_bf16 v[88:91], v[168:171], v[136:139], v[88:91]
  ds_read_b64_tr_b16 v[190:191], v221 offset:17920
  s_add_u32 s7, s7, s32
  v_mfma_f32_16x16x32_bf16 v[208:211], v[128:131], v[196:199], v[208:211]
  buffer_store_dwordx4 v[72:75], v224, s[20:23], s7 offen sc1
  v_mfma_f32_16x16x32_bf16 v[92:95], v[172:175], v[136:139], v[92:95]
  v_cvt_pk_bf16_f32 v104, v104, v105
  v_mfma_f32_16x16x32_bf16 v[204:207], v[132:135], v[192:195], v[204:207]
  v_cvt_pk_bf16_f32 v105, v106, v107
  v_mfma_f32_16x16x32_bf16 v[112:115], v[160:163], v[140:143], v[112:115]
  v_cvt_pk_bf16_f32 v106, v108, v109
  v_mfma_f32_16x16x32_bf16 v[212:215], v[132:135], v[196:199], v[212:215]
  v_cvt_pk_bf16_f32 v107, v110, v111
  v_mfma_f32_16x16x32_bf16 v[116:119], v[164:167], v[140:143], v[116:119]
  buffer_store_dwordx4 v[104:107], v224, s[20:23], s7 offen offset:256 sc1
  v_mfma_f32_16x16x32_bf16 v[120:123], v[168:171], v[140:143], v[120:123]
  v_mfma_f32_16x16x32_bf16 v[124:127], v[172:175], v[140:143], v[124:127]
  s_waitcnt lgkmcnt(0)
  v_mfma_f32_16x16x32_bf16 v[16:19], v[176:179], v[144:147], v[16:19]
  v_mfma_f32_16x16x32_bf16 v[20:23], v[180:183], v[144:147], v[20:23]
  v_mfma_f32_16x16x32_bf16 v[24:27], v[184:187], v[144:147], v[24:27]
  v_mfma_f32_16x16x32_bf16 v[28:31], v[188:191], v[144:147], v[28:31]
  v_mfma_f32_16x16x32_bf16 v[48:51], v[176:179], v[148:151], v[48:51]
  v_mfma_f32_16x16x32_bf16 v[52:55], v[180:183], v[148:151], v[52:55]
  v_mfma_f32_16x16x32_bf16 v[56:59], v[184:187], v[148:151], v[56:59]
  v_mfma_f32_16x16x32_bf16 v[60:63], v[188:191], v[148:151], v[60:63]
  v_mfma_f32_16x16x32_bf16 v[80:83], v[176:179], v[152:155], v[80:83]
  v_mfma_f32_16x16x32_bf16 v[84:87], v[180:183], v[152:155], v[84:87]
  v_mfma_f32_16x16x32_bf16 v[88:91], v[184:187], v[152:155], v[88:91]
  v_mfma_f32_16x16x32_bf16 v[92:95], v[188:191], v[152:155], v[92:95]
  v_mfma_f32_16x16x32_bf16 v[112:115], v[176:179], v[156:159], v[112:115]
  v_mfma_f32_16x16x32_bf16 v[116:119], v[180:183], v[156:159], v[116:119]
  v_mfma_f32_16x16x32_bf16 v[120:123], v[184:187], v[156:159], v[120:123]
  v_mfma_f32_16x16x32_bf16 v[124:127], v[188:191], v[156:159], v[124:127]
  s_nop 7
  v_cvt_pk_bf16_f32 v16, v16, v17
  v_cvt_pk_bf16_f32 v17, v18, v19
  v_cvt_pk_bf16_f32 v18, v20, v21
  v_cvt_pk_bf16_f32 v19, v22, v23
  s_mul_i32 s7, s31, 2
  s_add_u32 s7, s7, s30
  buffer_store_dwordx4 v[16:19], v224, s[20:23], s7 offen sc1
  v_cvt_pk_bf16_f32 v48, v48, v49
  v_cvt_pk_bf16_f32 v49, v50, v51
  v_cvt_pk_bf16_f32 v50, v52, v53
  v_cvt_pk_bf16_f32 v51, v54, v55
  buffer_store_dwordx4 v[48:51], v224, s[20:23], s7 offen offset:256 sc1
  v_cvt_pk_bf16_f32 v24, v24, v25
  v_cvt_pk_bf16_f32 v25, v26, v27
  v_cvt_pk_bf16_f32 v26, v28, v29
  v_cvt_pk_bf16_f32 v27, v30, v31
  s_mul_i32 s7, s31, 3
  s_add_u32 s7, s7, s30
  buffer_store_dwordx4 v[24:27], v224, s[20:23], s7 offen sc1
  v_cvt_pk_bf16_f32 v56, v56, v57
  v_cvt_pk_bf16_f32 v57, v58, v59
  v_cvt_pk_bf16_f32 v58, v60, v61
  v_cvt_pk_bf16_f32 v59, v62, v63
  buffer_store_dwordx4 v[56:59], v224, s[20:23], s7 offen offset:256 sc1
  v_cvt_pk_bf16_f32 v80, v80, v81
  v_cvt_pk_bf16_f32 v81, v82, v83
  v_cvt_pk_bf16_f32 v82, v84, v85
  v_cvt_pk_bf16_f32 v83, v86, v87
  s_mul_i32 s7, s31, 2
  s_add_u32 s7, s7, s30
  s_add_u32 s7, s7, s32
  buffer_store_dwordx4 v[80:83], v224, s[20:23], s7 offen sc1
  v_cvt_pk_bf16_f32 v112, v112, v113
  v_cvt_pk_bf16_f32 v113, v114, v115
  v_cvt_pk_bf16_f32 v114, v116, v117
  v_cvt_pk_bf16_f32 v115, v118, v119
  buffer_store_dwordx4 v[112:115], v224, s[20:23], s7 offen offset:256 sc1
  v_cvt_pk_bf16_f32 v88, v88, v89
  v_cvt_pk_bf16_f32 v89, v90, v91
  v_cvt_pk_bf16_f32 v90, v92, v93
  v_cvt_pk_bf16_f32 v91, v94, v95
  s_mul_i32 s7, s31, 3
  s_add_u32 s7, s7, s30
  s_add_u32 s7, s7, s32
  buffer_store_dwordx4 v[88:91], v224, s[20:23], s7 offen sc1
  v_cvt_pk_bf16_f32 v120, v120, v121
  v_cvt_pk_bf16_f32 v121, v122, v123
  v_cvt_pk_bf16_f32 v122, v124, v125
  v_cvt_pk_bf16_f32 v123, v126, v127
  buffer_store_dwordx4 v[120:123], v224, s[20:23], s7 offen offset:256 sc1
  s_waitcnt lgkmcnt(0)
  s_barrier
  s_lshl_b32 s7, s24, 12
  s_add_u32 s7, s7, 53248
  v_add_u32 v226, s7, v223
  ds_read_b128 v[128:131], v226 offset:0
  ds_read_b128 v[132:135], v226 offset:1024
  ds_read_b128 v[136:139], v226 offset:2048
  ds_read_b128 v[140:143], v226 offset:3072
  s_waitcnt lgkmcnt(0)
  v_add_f32 v200, v200, v128
  v_add_f32 v201, v201, v129
  v_add_f32 v202, v202, v130
  v_add_f32 v203, v203, v131
  v_add_f32 v204, v204, v132
  v_add_f32 v205, v205, v133
  v_add_f32 v206, v206, v134
  v_add_f32 v207, v207, v135
  v_add_f32 v208, v208, v136
  v_add_f32 v209, v209, v137
  v_add_f32 v210, v210, v138
  v_add_f32 v211, v211, v139
  v_add_f32 v212, v212, v140
  v_add_f32 v213, v213, v141
  v_add_f32 v214, v214, v142
  v_add_f32 v215, v215, v143
  v_cvt_pk_bf16_f32 v200, v200, v201
  v_cvt_pk_bf16_f32 v201, v202, v203
  v_cvt_pk_bf16_f32 v202, v204, v205
  v_cvt_pk_bf16_f32 v203, v206, v207
  v_cvt_pk_bf16_f32 v204, v208, v209
  v_cvt_pk_bf16_f32 v205, v210, v211
  v_cvt_pk_bf16_f32 v206, v212, v213
  v_cvt_pk_bf16_f32 v207, v214, v215
  s_lshl_b32 s7, s5, 2
  s_lshl_b32 s33, s24, 1
  s_add_u32 s7, s7, s33
  s_add_u32 s7, s7, 0
  s_lshl_b32 s7, s7, 12
  s_add_u32 s7, s7, 16779264
  buffer_store_dwordx4 v[200:203], v224, s[20:23], s7 offen sc1
  buffer_store_dwordx4 v[204:207], v224, s[20:23], s7 offen offset:256 sc1
  s_endpgm
p1_c_B3:
  s_lshl_b32 s7, s6, 3
  s_lshl_b32 s33, s25, 2
  s_add_u32 s7, s7, s33
  s_lshl_b32 s33, s5, 2
  s_lshl_b32 s36, s24, 1
  s_add_u32 s33, s33, s36
  s_mov_b32 s31, 131072
  s_mov_b32 s32, 2048
  s_mov_b32 s36, 12582912
  s_mov_b32 s34, 0x3e8293ee
  s_mov_b32 s35, s34
  s_mul_i32 s7, s7, s31
  s_mul_i32 s33, s33, s32
  s_add_u32 s30, s7, s33
  s_add_u32 s30, s30, s36
  s_mov_b32 s28, 14
  s_waitcnt lgkmcnt(0)
  s_barrier
  ds_read_b128 v[128:131], v216 offset:0
  ds_read_b64_tr_b16 v[160:161], v218 offset:0
  ds_read_b64_tr_b16 v[162:163], v218 offset:512
  ds_read_b128 v[132:135], v216 offset:2048
  ds_read_b64_tr_b16 v[164:165], v219 offset:0
  ds_read_b64_tr_b16 v[166:167], v219 offset:512
  ds_read_b128 v[136:139], v216 offset:4096
  ds_read_b64_tr_b16 v[168:169], v220 offset:0
  ds_read_b64_tr_b16 v[170:171], v220 offset:512
  ds_read_b128 v[140:143], v216 offset:6144
  ds_read_b64_tr_b16 v[172:173], v221 offset:0
  ds_read_b64_tr_b16 v[174:175], v221 offset:512
  .p2align 6
p1_c_B3_loop:
  s_waitcnt lgkmcnt(0)
  v_mfma_f32_16x16x32_bf16 v[0:3], v[160:163], v[128:131], v[0:3]
  ds_read_b64_tr_b16 v[176:177], v218 offset:1024
  v_mfma_f32_16x16x32_bf16 v[4:7], v[164:167], v[128:131], v[4:7]
  ds_read_b64_tr_b16 v[178:179], v218 offset:1536
  v_mfma_f32_16x16x32_bf16 v[8:11], v[168:171], v[128:131], v[8:11]
  ds_read_b64_tr_b16 v[180:181], v219 offset:1024
  v_mfma_f32_16x16x32_bf16 v[12:15], v[172:175], v[128:131], v[12:15]
  ds_read_b64_tr_b16 v[182:183], v219 offset:1536
  v_mfma_f32_16x16x32_bf16 v[32:35], v[160:163], v[132:135], v[32:35]
  ds_read_b128 v[144:147], v217 offset:0
  v_mfma_f32_16x16x32_bf16 v[36:39], v[164:167], v[132:135], v[36:39]
  ds_read_b64_tr_b16 v[184:185], v220 offset:1024
  v_mfma_f32_16x16x32_bf16 v[40:43], v[168:171], v[132:135], v[40:43]
  ds_read_b64_tr_b16 v[186:187], v220 offset:1536
  v_mfma_f32_16x16x32_bf16 v[44:47], v[172:175], v[132:135], v[44:47]
  ds_read_b64_tr_b16 v[188:189], v221 offset:1024
  v_mfma_f32_16x16x32_bf16 v[64:67], v[160:163], v[136:139], v[64:67]
  ds_read_b64_tr_b16 v[190:191], v221 offset:1536
  v_mfma_f32_16x16x32_bf16 v[68:71], v[164:167], v[136:139], v[68:71]
  ds_read_b128 v[148:151], v217 offset:2048
  v_mfma_f32_16x16x32_bf16 v[72:75], v[168:171], v[136:139], v[72:75]
  v_mfma_f32_16x16x32_bf16 v[76:79], v[172:175], v[136:139], v[76:79]
  v_mfma_f32_16x16x32_bf16 v[96:99], v[160:163], v[140:143], v[96:99]
  v_mfma_f32_16x16x32_bf16 v[100:103], v[164:167], v[140:143], v[100:103]
  v_mfma_f32_16x16x32_bf16 v[104:107], v[168:171], v[140:143], v[104:107]
  s_add_u32 s26, s26, 1
  s_cmp_eq_u32 s26, 3
  v_mfma_f32_16x16x32_bf16 v[108:111], v[172:175], v[140:143], v[108:111]
  s_cselect_b32 s27, s50, s51
  s_cselect_b32 s26, 0, s26
  s_waitcnt lgkmcnt(0)
  v_mfma_f32_16x16x32_bf16 v[16:19], v[176:179], v[128:131], v[16:19]
  ds_read_b64_tr_b16 v[160:161], v218 offset:16384
  v_mfma_f32_16x16x32_bf16 v[20:23], v[180:183], v[128:131], v[20:23]
  ds_read_b64_tr_b16 v[162:163], v218 offset:16896
  v_mfma_f32_16x16x32_bf16 v[24:27], v[184:187], v[128:131], v[24:27]
  ds_read_b64_tr_b16 v[164:165], v219 offset:16384
  v_mfma_f32_16x16x32_bf16 v[28:31], v[188:191], v[128:131], v[28:31]
  ds_read_b64_tr_b16 v[166:167], v219 offset:16896
  v_mfma_f32_16x16x32_bf16 v[48:51], v[176:179], v[132:135], v[48:51]
  ds_read_b128 v[152:155], v217 offset:4096
  v_mfma_f32_16x16x32_bf16 v[52:55], v[180:183], v[132:135], v[52:55]
  ds_read_b64_tr_b16 v[168:169], v220 offset:16384
  v_mfma_f32_16x16x32_bf16 v[56:59], v[184:187], v[132:135], v[56:59]
  ds_read_b64_tr_b16 v[170:171], v220 offset:16896
  v_mfma_f32_16x16x32_bf16 v[60:63], v[188:191], v[132:135], v[60:63]
  ds_read_b64_tr_b16 v[172:173], v221 offset:16384
  v_mfma_f32_16x16x32_bf16 v[80:83], v[176:179], v[136:139], v[80:83]
  ds_read_b64_tr_b16 v[174:175], v221 offset:16896
  v_mfma_f32_16x16x32_bf16 v[84:87], v[180:183], v[136:139], v[84:87]
  ds_read_b128 v[156:159], v217 offset:6144
  v_mfma_f32_16x16x32_bf16 v[88:91], v[184:187], v[136:139], v[88:91]
  v_mfma_f32_16x16x32_bf16 v[92:95], v[188:191], v[136:139], v[92:95]
  v_mfma_f32_16x16x32_bf16 v[112:115], v[176:179], v[140:143], v[112:115]
  v_mfma_f32_16x16x32_bf16 v[116:119], v[180:183], v[140:143], v[116:119]
  v_mfma_f32_16x16x32_bf16 v[120:123], v[184:187], v[140:143], v[120:123]
  v_mfma_f32_16x16x32_bf16 v[124:127], v[188:191], v[140:143], v[124:127]
  s_waitcnt lgkmcnt(0)
  v_mfma_f32_16x16x32_bf16 v[0:3], v[160:163], v[144:147], v[0:3]
  ds_read_b64_tr_b16 v[176:177], v218 offset:17408
  v_mfma_f32_16x16x32_bf16 v[4:7], v[164:167], v[144:147], v[4:7]
  ds_read_b64_tr_b16 v[178:179], v218 offset:17920
  v_mfma_f32_16x16x32_bf16 v[8:11], v[168:171], v[144:147], v[8:11]
  ds_read_b64_tr_b16 v[180:181], v219 offset:17408
  v_mfma_f32_16x16x32_bf16 v[12:15], v[172:175], v[144:147], v[12:15]
  ds_read_b64_tr_b16 v[182:183], v219 offset:17920
  v_mfma_f32_16x16x32_bf16 v[32:35], v[160:163], v[148:151], v[32:35]
  ds_read_b64_tr_b16 v[184:185], v220 offset:17408
  v_mfma_f32_16x16x32_bf16 v[36:39], v[164:167], v[148:151], v[36:39]
  ds_read_b64_tr_b16 v[186:187], v220 offset:17920
  v_mfma_f32_16x16x32_bf16 v[40:43], v[168:171], v[148:151], v[40:43]
  ds_read_b64_tr_b16 v[188:189], v221 offset:17408
  v_mfma_f32_16x16x32_bf16 v[44:47], v[172:175], v[148:151], v[44:47]
  ds_read_b64_tr_b16 v[190:191], v221 offset:17920
  v_mfma_f32_16x16x32_bf16 v[64:67], v[160:163], v[152:155], v[64:67]
  ds_read_b64_tr_b16 v[192:193], v222 offset:0
  v_mfma_f32_16x16x32_bf16 v[68:71], v[164:167], v[152:155], v[68:71]
  ds_read_b64_tr_b16 v[194:195], v222 offset:256
  v_mfma_f32_16x16x32_bf16 v[72:75], v[168:171], v[152:155], v[72:75]
  ds_read_b64_tr_b16 v[196:197], v222 offset:32
  v_mfma_f32_16x16x32_bf16 v[76:79], v[172:175], v[152:155], v[76:79]
  ds_read_b64_tr_b16 v[198:199], v222 offset:288
  v_mfma_f32_16x16x32_bf16 v[96:99], v[160:163], v[156:159], v[96:99]
  v_mfma_f32_16x16x32_bf16 v[100:103], v[164:167], v[156:159], v[100:103]
  v_mfma_f32_16x16x32_bf16 v[104:107], v[168:171], v[156:159], v[104:107]
  v_mfma_f32_16x16x32_bf16 v[108:111], v[172:175], v[156:159], v[108:111]
  s_waitcnt lgkmcnt(0)
  s_barrier
  v_mfma_f32_16x16x32_bf16 v[16:19], v[176:179], v[144:147], v[16:19]
  v_add_u32 v216, s27, v216
  v_add_u32 v218, s27, v218
  v_mfma_f32_16x16x32_bf16 v[20:23], v[180:183], v[144:147], v[20:23]
  ds_read_b128 v[128:131], v216 offset:0
  ds_read_b64_tr_b16 v[160:161], v218 offset:0
  v_mfma_f32_16x16x32_bf16 v[24:27], v[184:187], v[144:147], v[24:27]
  ds_read_b64_tr_b16 v[162:163], v218 offset:512
  v_add_u32 v219, s27, v219
  v_mfma_f32_16x16x32_bf16 v[28:31], v[188:191], v[144:147], v[28:31]
  ds_read_b128 v[132:135], v216 offset:2048
  ds_read_b64_tr_b16 v[164:165], v219 offset:0
  v_mfma_f32_16x16x32_bf16 v[48:51], v[176:179], v[148:151], v[48:51]
  ds_read_b64_tr_b16 v[166:167], v219 offset:512
  v_add_u32 v220, s27, v220
  v_mfma_f32_16x16x32_bf16 v[52:55], v[180:183], v[148:151], v[52:55]
  ds_read_b128 v[136:139], v216 offset:4096
  ds_read_b64_tr_b16 v[168:169], v220 offset:0
  v_mfma_f32_16x16x32_bf16 v[56:59], v[184:187], v[148:151], v[56:59]
  ds_read_b64_tr_b16 v[170:171], v220 offset:512
  v_add_u32 v221, s27, v221
  v_mfma_f32_16x16x32_bf16 v[60:63], v[188:191], v[148:151], v[60:63]
  ds_read_b128 v[140:143], v216 offset:6144
  ds_read_b64_tr_b16 v[172:173], v221 offset:0
  v_mfma_f32_16x16x32_bf16 v[80:83], v[176:179], v[152:155], v[80:83]
  ds_read_b64_tr_b16 v[174:175], v221 offset:512
  v_mfma_f32_16x16x32_bf16 v[84:87], v[180:183], v[152:155], v[84:87]
  v_add_u32 v217, s27, v217
  v_mfma_f32_16x16x32_bf16 v[200:203], v[144:147], v[192:195], v[200:203]
  v_add_u32 v222, s27, v222
  v_mfma_f32_16x16x32_bf16 v[88:91], v[184:187], v[152:155], v[88:91]
  s_sub_u32 s28, s28, 1
  v_mfma_f32_16x16x32_bf16 v[208:211], v[144:147], v[196:199], v[208:211]
  s_cmp_lg_u32 s28, 0
  v_mfma_f32_16x16x32_bf16 v[92:95], v[188:191], v[152:155], v[92:95]
  v_mfma_f32_16x16x32_bf16 v[204:207], v[148:151], v[192:195], v[204:207]
  v_mfma_f32_16x16x32_bf16 v[112:115], v[176:179], v[156:159], v[112:115]
  v_mfma_f32_16x16x32_bf16 v[212:215], v[148:151], v[196:199], v[212:215]
  v_mfma_f32_16x16x32_bf16 v[116:119], v[180:183], v[156:159], v[116:119]
  v_mfma_f32_16x16x32_bf16 v[120:123], v[184:187], v[156:159], v[120:123]
  v_mfma_f32_16x16x32_bf16 v[124:127], v[188:191], v[156:159], v[124:127]
  s_cbranch_scc1 p1_c_B3_loop
  s_waitcnt lgkmcnt(0)
  v_mfma_f32_16x16x32_bf16 v[0:3], v[160:163], v[128:131], v[0:3]
  ds_read_b128 v[144:147], v217 offset:0
  v_mfma_f32_16x16x32_bf16 v[4:7], v[164:167], v[128:131], v[4:7]
  ds_read_b64_tr_b16 v[176:177], v218 offset:16384
  v_mfma_f32_16x16x32_bf16 v[8:11], v[168:171], v[128:131], v[8:11]
  ds_read_b64_tr_b16 v[178:179], v218 offset:16896
  v_mfma_f32_16x16x32_bf16 v[12:15], v[172:175], v[128:131], v[12:15]
  ds_read_b128 v[148:151], v217 offset:2048
  v_mfma_f32_16x16x32_bf16 v[32:35], v[160:163], v[132:135], v[32:35]
  ds_read_b64_tr_b16 v[180:181], v219 offset:16384
  v_mfma_f32_16x16x32_bf16 v[36:39], v[164:167], v[132:135], v[36:39]
  ds_read_b64_tr_b16 v[182:183], v219 offset:16896
  v_mfma_f32_16x16x32_bf16 v[40:43], v[168:171], v[132:135], v[40:43]
  ds_read_b128 v[152:155], v217 offset:4096
  v_mfma_f32_16x16x32_bf16 v[44:47], v[172:175], v[132:135], v[44:47]
  ds_read_b64_tr_b16 v[184:185], v220 offset:16384
  v_mfma_f32_16x16x32_bf16 v[64:67], v[160:163], v[136:139], v[64:67]
  ds_read_b64_tr_b16 v[186:187], v220 offset:16896
  v_mfma_f32_16x16x32_bf16 v[68:71], v[164:167], v[136:139], v[68:71]
  ds_read_b128 v[156:159], v217 offset:6144
  v_add_u32 v236, 0xfffe6000, v222
  v_mfma_f32_16x16x32_bf16 v[72:75], v[168:171], v[136:139], v[72:75]
  ds_read_b64_tr_b16 v[188:189], v221 offset:16384
  v_add_u32 v235, 0xfffe6000, v221
  v_mfma_f32_16x16x32_bf16 v[76:79], v[172:175], v[136:139], v[76:79]
  ds_read_b64_tr_b16 v[190:191], v221 offset:16896
  v_add_u32 v234, 0xfffe6000, v220
  v_mfma_f32_16x16x32_bf16 v[96:99], v[160:163], v[140:143], v[96:99]
  v_add_u32 v233, 0xfffe6000, v219
  v_mfma_f32_16x16x32_bf16 v[100:103], v[164:167], v[140:143], v[100:103]
  v_add_u32 v232, 0xfffe6000, v218
  v_mfma_f32_16x16x32_bf16 v[104:107], v[168:171], v[140:143], v[104:107]
  v_add_u32 v231, 0xfffe6000, v217
  v_mfma_f32_16x16x32_bf16 v[108:111], v[172:175], v[140:143], v[108:111]
  v_add_u32 v230, 0xfffe6000, v216
  s_waitcnt lgkmcnt(0)
  s_barrier
  v_mfma_f32_16x16x32_bf16 v[0:3], v[176:179], v[144:147], v[0:3]
  ds_read_b128 v[128:131], v230 offset:0
  v_mfma_f32_16x16x32_bf16 v[4:7], v[180:183], v[144:147], v[4:7]
  ds_read_b64_tr_b16 v[160:161], v232 offset:0
  v_mfma_f32_16x16x32_bf16 v[8:11], v[184:187], v[144:147], v[8:11]
  ds_read_b64_tr_b16 v[162:163], v232 offset:512
  v_mfma_f32_16x16x32_bf16 v[12:15], v[188:191], v[144:147], v[12:15]
  ds_read_b128 v[132:135], v230 offset:2048
  v_mfma_f32_16x16x32_bf16 v[32:35], v[176:179], v[148:151], v[32:35]
  ds_read_b64_tr_b16 v[164:165], v233 offset:0
  v_mfma_f32_16x16x32_bf16 v[36:39], v[180:183], v[148:151], v[36:39]
  ds_read_b64_tr_b16 v[166:167], v233 offset:512
  v_mfma_f32_16x16x32_bf16 v[40:43], v[184:187], v[148:151], v[40:43]
  ds_read_b128 v[136:139], v230 offset:4096
  v_mfma_f32_16x16x32_bf16 v[44:47], v[188:191], v[148:151], v[44:47]
  ds_read_b64_tr_b16 v[168:169], v234 offset:0
  v_mfma_f32_16x16x32_bf16 v[64:67], v[176:179], v[152:155], v[64:67]
  ds_read_b64_tr_b16 v[170:171], v234 offset:512
  v_mfma_f32_16x16x32_bf16 v[68:71], v[180:183], v[152:155], v[68:71]
  ds_read_b128 v[140:143], v230 offset:6144
  v_mfma_f32_16x16x32_bf16 v[72:75], v[184:187], v[152:155], v[72:75]
  ds_read_b64_tr_b16 v[172:173], v235 offset:0
  v_mfma_f32_16x16x32_bf16 v[76:79], v[188:191], v[152:155], v[76:79]
  ds_read_b64_tr_b16 v[174:175], v235 offset:512
  v_mfma_f32_16x16x32_bf16 v[96:99], v[176:179], v[156:159], v[96:99]
  v_mfma_f32_16x16x32_bf16 v[100:103], v[180:183], v[156:159], v[100:103]
  v_mfma_f32_16x16x32_bf16 v[104:107], v[184:187], v[156:159], v[104:107]
  v_mfma_f32_16x16x32_bf16 v[108:111], v[188:191], v[156:159], v[108:111]
  s_waitcnt lgkmcnt(0)
  v_mfma_f32_16x16x32_bf16 v[0:3], v[160:163], v[128:131], v[0:3]
  ds_read_b128 v[144:147], v231 offset:0
  v_mfma_f32_16x16x32_bf16 v[4:7], v[164:167], v[128:131], v[4:7]
  ds_read_b64_tr_b16 v[176:177], v232 offset:16384
  v_mfma_f32_16x16x32_bf16 v[8:11], v[168:171], v[128:131], v[8:11]
  ds_read_b64_tr_b16 v[178:179], v232 offset:16896
  v_mfma_f32_16x16x32_bf16 v[12:15], v[172:175], v[128:131], v[12:15]
  ds_read_b128 v[148:151], v231 offset:2048
  v_mfma_f32_16x16x32_bf16 v[32:35], v[160:163], v[132:135], v[32:35]
  ds_read_b64_tr_b16 v[180:181], v233 offset:16384
  v_mfma_f32_16x16x32_bf16 v[36:39], v[164:167], v[132:135], v[36:39]
  ds_read_b64_tr_b16 v[182:183], v233 offset:16896
  v_mfma_f32_16x16x32_bf16 v[40:43], v[168:171], v[132:135], v[40:43]
  ds_read_b128 v[152:155], v231 offset:4096
  v_mfma_f32_16x16x32_bf16 v[44:47], v[172:175], v[132:135], v[44:47]
  ds_read_b64_tr_b16 v[184:185], v234 offset:16384
  v_mfma_f32_16x16x32_bf16 v[64:67], v[160:163], v[136:139], v[64:67]
  ds_read_b64_tr_b16 v[186:187], v234 offset:16896
  v_mfma_f32_16x16x32_bf16 v[68:71], v[164:167], v[136:139], v[68:71]
  ds_read_b128 v[156:159], v231 offset:6144
  v_mfma_f32_16x16x32_bf16 v[72:75], v[168:171], v[136:139], v[72:75]
  ds_read_b64_tr_b16 v[188:189], v235 offset:16384
  v_mfma_f32_16x16x32_bf16 v[76:79], v[172:175], v[136:139], v[76:79]
  ds_read_b64_tr_b16 v[190:191], v235 offset:16896
  v_mfma_f32_16x16x32_bf16 v[96:99], v[160:163], v[140:143], v[96:99]
  v_mfma_f32_16x16x32_bf16 v[100:103], v[164:167], v[140:143], v[100:103]
  v_mfma_f32_16x16x32_bf16 v[104:107], v[168:171], v[140:143], v[104:107]
  v_mfma_f32_16x16x32_bf16 v[108:111], v[172:175], v[140:143], v[108:111]
  s_waitcnt lgkmcnt(0)
  v_mfma_f32_16x16x32_bf16 v[0:3], v[176:179], v[144:147], v[0:3]
  ds_read_b64_tr_b16 v[160:161], v232 offset:1024
  v_mfma_f32_16x16x32_bf16 v[4:7], v[180:183], v[144:147], v[4:7]
  ds_read_b64_tr_b16 v[162:163], v232 offset:1536
  v_mfma_f32_16x16x32_bf16 v[8:11], v[184:187], v[144:147], v[8:11]
  ds_read_b64_tr_b16 v[164:165], v233 offset:1024
  v_mfma_f32_16x16x32_bf16 v[12:15], v[188:191], v[144:147], v[12:15]
  ds_read_b64_tr_b16 v[166:167], v233 offset:1536
  v_mfma_f32_16x16x32_bf16 v[32:35], v[176:179], v[148:151], v[32:35]
  ds_read_b64_tr_b16 v[168:169], v234 offset:1024
  v_mfma_f32_16x16x32_bf16 v[36:39], v[180:183], v[148:151], v[36:39]
  ds_read_b64_tr_b16 v[170:171], v234 offset:1536
  v_mfma_f32_16x16x32_bf16 v[40:43], v[184:187], v[148:151], v[40:43]
  ds_read_b64_tr_b16 v[172:173], v235 offset:1024
  v_mfma_f32_16x16x32_bf16 v[44:47], v[188:191], v[148:151], v[44:47]
  ds_read_b64_tr_b16 v[174:175], v235 offset:1536
  v_mfma_f32_16x16x32_bf16 v[64:67], v[176:179], v[152:155], v[64:67]
  v_mfma_f32_16x16x32_bf16 v[68:71], v[180:183], v[152:155], v[68:71]
  v_mfma_f32_16x16x32_bf16 v[72:75], v[184:187], v[152:155], v[72:75]
  v_mfma_f32_16x16x32_bf16 v[76:79], v[188:191], v[152:155], v[76:79]
  v_mfma_f32_16x16x32_bf16 v[96:99], v[176:179], v[156:159], v[96:99]
  v_mfma_f32_16x16x32_bf16 v[100:103], v[180:183], v[156:159], v[100:103]
  v_mfma_f32_16x16x32_bf16 v[104:107], v[184:187], v[156:159], v[104:107]
  v_mfma_f32_16x16x32_bf16 v[108:111], v[188:191], v[156:159], v[108:111]
  s_waitcnt lgkmcnt(0)
  v_mfma_f32_16x16x32_bf16 v[16:19], v[160:163], v[128:131], v[16:19]
  ds_read_b64_tr_b16 v[176:177], v232 offset:17408
  v_mfma_f32_16x16x32_bf16 v[20:23], v[164:167], v[128:131], v[20:23]
  ds_read_b64_tr_b16 v[178:179], v232 offset:17920
  v_mfma_f32_16x16x32_bf16 v[24:27], v[168:171], v[128:131], v[24:27]
  ds_read_b64_tr_b16 v[180:181], v233 offset:17408
  v_mfma_f32_16x16x32_bf16 v[28:31], v[172:175], v[128:131], v[28:31]
  ds_read_b64_tr_b16 v[182:183], v233 offset:17920
  v_mfma_f32_16x16x32_bf16 v[48:51], v[160:163], v[132:135], v[48:51]
  ds_read_b64_tr_b16 v[184:185], v234 offset:17408
  v_cvt_pk_bf16_f32 v0, v0, v1
  v_mfma_f32_16x16x32_bf16 v[52:55], v[164:167], v[132:135], v[52:55]
  ds_read_b64_tr_b16 v[186:187], v234 offset:17920
  v_cvt_pk_bf16_f32 v1, v2, v3
  v_mfma_f32_16x16x32_bf16 v[56:59], v[168:171], v[132:135], v[56:59]
  ds_read_b64_tr_b16 v[188:189], v235 offset:17408
  v_cvt_pk_bf16_f32 v2, v4, v5
  v_mfma_f32_16x16x32_bf16 v[60:63], v[172:175], v[132:135], v[60:63]
  ds_read_b64_tr_b16 v[190:191], v235 offset:17920
  v_cvt_pk_bf16_f32 v3, v6, v7
  v_mfma_f32_16x16x32_bf16 v[80:83], v[160:163], v[136:139], v[80:83]
  ds_read_b64_tr_b16 v[192:193], v236 offset:0
  s_mul_i32 s7, s31, 0
  v_mfma_f32_16x16x32_bf16 v[84:87], v[164:167], v[136:139], v[84:87]
  ds_read_b64_tr_b16 v[194:195], v236 offset:256
  s_add_u32 s7, s7, s30
  v_mfma_f32_16x16x32_bf16 v[88:91], v[168:171], v[136:139], v[88:91]
  ds_read_b64_tr_b16 v[196:197], v236 offset:32
  buffer_store_dwordx4 v[0:3], v224, s[20:23], s7 offen sc1
  v_mfma_f32_16x16x32_bf16 v[92:95], v[172:175], v[136:139], v[92:95]
  ds_read_b64_tr_b16 v[198:199], v236 offset:288
  v_cvt_pk_bf16_f32 v32, v32, v33
  v_mfma_f32_16x16x32_bf16 v[112:115], v[160:163], v[140:143], v[112:115]
  v_cvt_pk_bf16_f32 v33, v34, v35
  v_mfma_f32_16x16x32_bf16 v[116:119], v[164:167], v[140:143], v[116:119]
  v_cvt_pk_bf16_f32 v34, v36, v37
  v_mfma_f32_16x16x32_bf16 v[120:123], v[168:171], v[140:143], v[120:123]
  v_cvt_pk_bf16_f32 v35, v38, v39
  v_mfma_f32_16x16x32_bf16 v[124:127], v[172:175], v[140:143], v[124:127]
  buffer_store_dwordx4 v[32:35], v224, s[20:23], s7 offen offset:256 sc1
  s_waitcnt lgkmcnt(0)
  v_mfma_f32_16x16x32_bf16 v[16:19], v[176:179], v[144:147], v[16:19]
  ds_read_b128 v[128:131], v216 offset:0
  v_cvt_pk_bf16_f32 v8, v8, v9
  v_mfma_f32_16x16x32_bf16 v[20:23], v[180:183], v[144:147], v[20:23]
  ds_read_b64_tr_b16 v[160:161], v218 offset:1024
  v_cvt_pk_bf16_f32 v9, v10, v11
  v_mfma_f32_16x16x32_bf16 v[24:27], v[184:187], v[144:147], v[24:27]
  ds_read_b64_tr_b16 v[162:163], v218 offset:1536
  v_cvt_pk_bf16_f32 v10, v12, v13
  v_mfma_f32_16x16x32_bf16 v[28:31], v[188:191], v[144:147], v[28:31]
  ds_read_b128 v[132:135], v216 offset:2048
  v_cvt_pk_bf16_f32 v11, v14, v15
  v_mfma_f32_16x16x32_bf16 v[48:51], v[176:179], v[148:151], v[48:51]
  ds_read_b64_tr_b16 v[164:165], v219 offset:1024
  s_mul_i32 s7, s31, 1
  v_mfma_f32_16x16x32_bf16 v[52:55], v[180:183], v[148:151], v[52:55]
  ds_read_b64_tr_b16 v[166:167], v219 offset:1536
  s_add_u32 s7, s7, s30
  v_mfma_f32_16x16x32_bf16 v[56:59], v[184:187], v[148:151], v[56:59]
  ds_read_b128 v[136:139], v216 offset:4096
  buffer_store_dwordx4 v[8:11], v224, s[20:23], s7 offen sc1
  v_mfma_f32_16x16x32_bf16 v[60:63], v[188:191], v[148:151], v[60:63]
  ds_read_b64_tr_b16 v[168:169], v220 offset:1024
  v_cvt_pk_bf16_f32 v40, v40, v41
  v_mfma_f32_16x16x32_bf16 v[80:83], v[176:179], v[152:155], v[80:83]
  ds_read_b64_tr_b16 v[170:171], v220 offset:1536
  v_cvt_pk_bf16_f32 v41, v42, v43
  v_mfma_f32_16x16x32_bf16 v[84:87], v[180:183], v[152:155], v[84:87]
  ds_read_b128 v[140:143], v216 offset:6144
  v_cvt_pk_bf16_f32 v42, v44, v45
  v_mfma_f32_16x16x32_bf16 v[200:203], v[144:147], v[192:195], v[200:203]
  ds_read_b64_tr_b16 v[172:173], v221 offset:1024
  v_cvt_pk_bf16_f32 v43, v46, v47
  v_mfma_f32_16x16x32_bf16 v[88:91], v[184:187], v[152:155], v[88:91]
  ds_read_b64_tr_b16 v[174:175], v221 offset:1536
  buffer_store_dwordx4 v[40:43], v224, s[20:23], s7 offen offset:256 sc1
  v_mfma_f32_16x16x32_bf16 v[208:211], v[144:147], v[196:199], v[208:211]
  v_cvt_pk_bf16_f32 v64, v64, v65
  v_mfma_f32_16x16x32_bf16 v[92:95], v[188:191], v[152:155], v[92:95]
  v_cvt_pk_bf16_f32 v65, v66, v67
  v_mfma_f32_16x16x32_bf16 v[204:207], v[148:151], v[192:195], v[204:207]
  v_cvt_pk_bf16_f32 v66, v68, v69
  v_mfma_f32_16x16x32_bf16 v[112:115], v[176:179], v[156:159], v[112:115]
  v_cvt_pk_bf16_f32 v67, v70, v71
  v_mfma_f32_16x16x32_bf16 v[212:215], v[148:151], v[196:199], v[212:215]
  s_mul_i32 s7, s31, 0
  v_mfma_f32_16x16x32_bf16 v[116:119], v[180:183], v[156:159], v[116:119]
  s_add_u32 s7, s7, s30
  v_mfma_f32_16x16x32_bf16 v[120:123], v[184:187], v[156:159], v[120:123]
  s_add_u32 s7, s7, s32
  v_mfma_f32_16x16x32_bf16 v[124:127], v[188:191], v[156:159], v[124:127]
  buffer_store_dwordx4 v[64:67], v224, s[20:23], s7 offen sc1
  s_waitcnt lgkmcnt(0)
  v_mfma_f32_16x16x32_bf16 v[16:19], v[160:163], v[128:131], v[16:19]
  ds_read_b128 v[144:147], v217 offset:0
  v_cvt_pk_bf16_f32 v96, v96, v97
  v_mfma_f32_16x16x32_bf16 v[20:23], v[164:167], v[128:131], v[20:23]
  ds_read_b64_tr_b16 v[176:177], v218 offset:17408
  v_cvt_pk_bf16_f32 v97, v98, v99
  v_mfma_f32_16x16x32_bf16 v[24:27], v[168:171], v[128:131], v[24:27]
  ds_read_b64_tr_b16 v[178:179], v218 offset:17920
  v_cvt_pk_bf16_f32 v98, v100, v101
  v_mfma_f32_16x16x32_bf16 v[28:31], v[172:175], v[128:131], v[28:31]
  ds_read_b128 v[148:151], v217 offset:2048
  v_cvt_pk_bf16_f32 v99, v102, v103
  v_mfma_f32_16x16x32_bf16 v[48:51], v[160:163], v[132:135], v[48:51]
  ds_read_b64_tr_b16 v[180:181], v219 offset:17408
  buffer_store_dwordx4 v[96:99], v224, s[20:23], s7 offen offset:256 sc1
  v_mfma_f32_16x16x32_bf16 v[52:55], v[164:167], v[132:135], v[52:55]
  ds_read_b64_tr_b16 v[182:183], v219 offset:17920
  v_cvt_pk_bf16_f32 v72, v72, v73
  v_mfma_f32_16x16x32_bf16 v[56:59], v[168:171], v[132:135], v[56:59]
  ds_read_b128 v[152:155], v217 offset:4096
  v_cvt_pk_bf16_f32 v73, v74, v75
  v_mfma_f32_16x16x32_bf16 v[60:63], v[172:175], v[132:135], v[60:63]
  ds_read_b64_tr_b16 v[184:185], v220 offset:17408
  v_cvt_pk_bf16_f32 v74, v76, v77
  v_mfma_f32_16x16x32_bf16 v[80:83], v[160:163], v[136:139], v[80:83]
  ds_read_b64_tr_b16 v[186:187], v220 offset:17920
  v_cvt_pk_bf16_f32 v75, v78, v79
  v_mfma_f32_16x16x32_bf16 v[84:87], v[164:167], v[136:139], v[84:87]
  ds_read_b128 v[156:159], v217 offset:6144
  s_mul_i32 s7, s31, 1
  v_mfma_f32_16x16x32_bf16 v[88:91], v[168:171], v[136:139], v[88:91]
  ds_read_b64_tr_b16 v[188:189], v221 offset:17408
  s_add_u32 s7, s7, s30
  v_mfma_f32_16x16x32_bf16 v[92:95], v[172:175], v[136:139], v[92:95]
  ds_read_b64_tr_b16 v[190:191], v221 offset:17920
  s_add_u32 s7, s7, s32
  v_mfma_f32_16x16x32_bf16 v[112:115], v[160:163], v[140:143], v[112:115]
  ds_read_b64_tr_b16 v[192:193], v222 offset:0
  buffer_store_dwordx4 v[72:75], v224, s[20:23], s7 offen sc1
  v_mfma_f32_16x16x32_bf16 v[116:119], v[164:167], v[140:143], v[116:119]
  ds_read_b64_tr_b16 v[194:195], v222 offset:256
  v_cvt_pk_bf16_f32 v104, v104, v105
  v_mfma_f32_16x16x32_bf16 v[120:123], v[168:171], v[140:143], v[120:123]
  ds_read_b64_tr_b16 v[196:197], v222 offset:32
  v_cvt_pk_bf16_f32 v105, v106, v107
  v_mfma_f32_16x16x32_bf16 v[124:127], v[172:175], v[140:143], v[124:127]
  ds_read_b64_tr_b16 v[198:199], v222 offset:288
  v_cvt_pk_bf16_f32 v106, v108, v109
  s_waitcnt lgkmcnt(0)
  v_mfma_f32_16x16x32_bf16 v[16:19], v[176:179], v[144:147], v[16:19]
  v_cvt_pk_bf16_f32 v107, v110, v111
  v_mfma_f32_16x16x32_bf16 v[20:23], v[180:183], v[144:147], v[20:23]
  buffer_store_dwordx4 v[104:107], v224, s[20:23], s7 offen offset:256 sc1
  v_mfma_f32_16x16x32_bf16 v[24:27], v[184:187], v[144:147], v[24:27]
  v_mfma_f32_16x16x32_bf16 v[28:31], v[188:191], v[144:147], v[28:31]
  v_mfma_f32_16x16x32_bf16 v[48:51], v[176:179], v[148:151], v[48:51]
  v_mfma_f32_16x16x32_bf16 v[52:55], v[180:183], v[148:151], v[52:55]
  v_mfma_f32_16x16x32_bf16 v[56:59], v[184:187], v[148:151], v[56:59]
  v_mfma_f32_16x16x32_bf16 v[60:63], v[188:191], v[148:151], v[60:63]
  v_mfma_f32_16x16x32_bf16 v[80:83], v[176:179], v[152:155], v[80:83]
  v_mfma_f32_16x16x32_bf16 v[84:87], v[180:183], v[152:155], v[84:87]
  v_mfma_f32_16x16x32_bf16 v[200:203], v[144:147], v[192:195], v[200:203]
  v_mfma_f32_16x16x32_bf16 v[88:91], v[184:187], v[152:155], v[88:91]
  v_mfma_f32_16x16x32_bf16 v[208:211], v[144:147], v[196:199], v[208:211]
  v_mfma_f32_16x16x32_bf16 v[92:95], v[188:191], v[152:155], v[92:95]
  v_mfma_f32_16x16x32_bf16 v[204:207], v[148:151], v[192:195], v[204:207]
  v_mfma_f32_16x16x32_bf16 v[112:115], v[176:179], v[156:159], v[112:115]
  v_mfma_f32_16x16x32_bf16 v[212:215], v[148:151], v[196:199], v[212:215]
  v_mfma_f32_16x16x32_bf16 v[116:119], v[180:183], v[156:159], v[116:119]
  v_mfma_f32_16x16x32_bf16 v[120:123], v[184:187], v[156:159], v[120:123]
  v_mfma_f32_16x16x32_bf16 v[124:127], v[188:191], v[156:159], v[124:127]
  s_nop 7
  s_lshl_b32 s7, s24, 12
  s_add_u32 s7, s7, 53248
  v_add_u32 v226, s7, v223
  ds_write_b128 v226, v[200:203] offset:0
  ds_write_b128 v226, v[204:207] offset:1024
  ds_write_b128 v226, v[208:211] offset:2048
  ds_write_b128 v226, v[212:215] offset:3072
  v_cvt_pk_bf16_f32 v16, v16, v17
  v_cvt_pk_bf16_f32 v17, v18, v19
  v_cvt_pk_bf16_f32 v18, v20, v21
  v_cvt_pk_bf16_f32 v19, v22, v23
  s_mul_i32 s7, s31, 2
  s_add_u32 s7, s7, s30
  buffer_store_dwordx4 v[16:19], v224, s[20:23], s7 offen sc1
  v_cvt_pk_bf16_f32 v48, v48, v49
  v_cvt_pk_bf16_f32 v49, v50, v51
  v_cvt_pk_bf16_f32 v50, v52, v53
  v_cvt_pk_bf16_f32 v51, v54, v55
  buffer_store_dwordx4 v[48:51], v224, s[20:23], s7 offen offset:256 sc1
  v_cvt_pk_bf16_f32 v24, v24, v25
  v_cvt_pk_bf16_f32 v25, v26, v27
  v_cvt_pk_bf16_f32 v26, v28, v29
  v_cvt_pk_bf16_f32 v27, v30, v31
  s_mul_i32 s7, s31, 3
  s_add_u32 s7, s7, s30
  buffer_store_dwordx4 v[24:27], v224, s[20:23], s7 offen sc1
  v_cvt_pk_bf16_f32 v56, v56, v57
  v_cvt_pk_bf16_f32 v57, v58, v59
  v_cvt_pk_bf16_f32 v58, v60, v61
  v_cvt_pk_bf16_f32 v59, v62, v63
  buffer_store_dwordx4 v[56:59], v224, s[20:23], s7 offen offset:256 sc1
  v_cvt_pk_bf16_f32 v80, v80, v81
  v_cvt_pk_bf16_f32 v81, v82, v83
  v_cvt_pk_bf16_f32 v82, v84, v85
  v_cvt_pk_bf16_f32 v83, v86, v87
  s_mul_i32 s7, s31, 2
  s_add_u32 s7, s7, s30
  s_add_u32 s7, s7, s32
  buffer_store_dwordx4 v[80:83], v224, s[20:23], s7 offen sc1
  v_cvt_pk_bf16_f32 v112, v112, v113
  v_cvt_pk_bf16_f32 v113, v114, v115
  v_cvt_pk_bf16_f32 v114, v116, v117
  v_cvt_pk_bf16_f32 v115, v118, v119
  buffer_store_dwordx4 v[112:115], v224, s[20:23], s7 offen offset:256 sc1
  v_cvt_pk_bf16_f32 v88, v88, v89
  v_cvt_pk_bf16_f32 v89, v90, v91
  v_cvt_pk_bf16_f32 v90, v92, v93
  v_cvt_pk_bf16_f32 v91, v94, v95
  s_mul_i32 s7, s31, 3
  s_add_u32 s7, s7, s30
  s_add_u32 s7, s7, s32
  buffer_store_dwordx4 v[88:91], v224, s[20:23], s7 offen sc1
  v_cvt_pk_bf16_f32 v120, v120, v121
  v_cvt_pk_bf16_f32 v121, v122, v123
  v_cvt_pk_bf16_f32 v122, v124, v125
  v_cvt_pk_bf16_f32 v123, v126, v127
  buffer_store_dwordx4 v[120:123], v224, s[20:23], s7 offen offset:256 sc1
  s_waitcnt lgkmcnt(0)
  s_barrier
  s_endpgm
p1_c_B4:
  s_lshl_b32 s7, s6, 3
  s_lshl_b32 s33, s25, 2
  s_add_u32 s7, s7, s33
  s_lshl_b32 s33, s5, 2
  s_lshl_b32 s36, s24, 1
  s_add_u32 s33, s33, s36
  s_mov_b32 s31, 131072
  s_mov_b32 s32, 2048
  s_mov_b32 s36, 12582912
  s_mov_b32 s34, 0x3e8293ee
  s_mov_b32 s35, s34
  s_mul_i32 s7, s7, s31
  s_mul_i32 s33, s33, s32
  s_add_u32 s30, s7, s33
  s_add_u32 s30, s30, s36
  s_mov_b32 s28, 14
  s_waitcnt lgkmcnt(0)
  s_barrier
  ds_read_b128 v[128:131], v216 offset:0
  ds_read_b64_tr_b16 v[160:161], v218 offset:0
  ds_read_b64_tr_b16 v[162:163], v218 offset:512
  ds_read_b128 v[132:135], v216 offset:2048
  ds_read_b64_tr_b16 v[164:165], v219 offset:0
  ds_read_b64_tr_b16 v[166:167], v219 offset:512
  ds_read_b128 v[136:139], v216 offset:4096
  ds_read_b64_tr_b16 v[168:169], v220 offset:0
  ds_read_b64_tr_b16 v[170:171], v220 offset:512
  ds_read_b128 v[140:143], v216 offset:6144
  ds_read_b64_tr_b16 v[172:173], v221 offset:0
  ds_read_b64_tr_b16 v[174:175], v221 offset:512
  .p2align 6
p1_c_B4_loop:
  s_waitcnt lgkmcnt(0)
  v_mfma_f32_16x16x32_bf16 v[0:3], v[160:163], v[128:131], v[0:3]
  ds_read_b64_tr_b16 v[176:177], v218 offset:1024
  v_mfma_f32_16x16x32_bf16 v[4:7], v[164:167], v[128:131], v[4:7]
  ds_read_b64_tr_b16 v[178:179], v218 offset:1536
  v_mfma_f32_16x16x32_bf16 v[8:11], v[168:171], v[128:131], v[8:11]
  ds_read_b64_tr_b16 v[180:181], v219 offset:1024
  v_mfma_f32_16x16x32_bf16 v[12:15], v[172:175], v[128:131], v[12:15]
  ds_read_b64_tr_b16 v[182:183], v219 offset:1536
  v_mfma_f32_16x16x32_bf16 v[32:35], v[160:163], v[132:135], v[32:35]
  ds_read_b128 v[144:147], v217 offset:0
  v_mfma_f32_16x16x32_bf16 v[36:39], v[164:167], v[132:135], v[36:39]
  ds_read_b64_tr_b16 v[184:185], v220 offset:1024
  v_mfma_f32_16x16x32_bf16 v[40:43], v[168:171], v[132:135], v[40:43]
  ds_read_b64_tr_b16 v[186:187], v220 offset:1536
  v_mfma_f32_16x16x32_bf16 v[44:47], v[172:175], v[132:135], v[44:47]
  ds_read_b64_tr_b16 v[188:189], v221 offset:1024
  v_mfma_f32_16x16x32_bf16 v[64:67], v[160:163], v[136:139], v[64:67]
  ds_read_b64_tr_b16 v[190:191], v221 offset:1536
  v_mfma_f32_16x16x32_bf16 v[68:71], v[164:167], v[136:139], v[68:71]
  ds_read_b128 v[148:151], v217 offset:2048
  v_mfma_f32_16x16x32_bf16 v[72:75], v[168:171], v[136:139], v[72:75]
  ds_read_b64_tr_b16 v[192:193], v222 offset:0
  v_mfma_f32_16x16x32_bf16 v[76:79], v[172:175], v[136:139], v[76:79]
  ds_read_b64_tr_b16 v[194:195], v222 offset:256
  v_mfma_f32_16x16x32_bf16 v[96:99], v[160:163], v[140:143], v[96:99]
  ds_read_b64_tr_b16 v[196:197], v222 offset:32
  v_mfma_f32_16x16x32_bf16 v[100:103], v[164:167], v[140:143], v[100:103]
  ds_read_b64_tr_b16 v[198:199], v222 offset:288
  v_mfma_f32_16x16x32_bf16 v[104:107], v[168:171], v[140:143], v[104:107]
  s_add_u32 s26, s26, 1
  s_cmp_eq_u32 s26, 3
  v_mfma_f32_16x16x32_bf16 v[108:111], v[172:175], v[140:143], v[108:111]
  s_cselect_b32 s27, s50, s51
  s_cselect_b32 s26, 0, s26
  s_waitcnt lgkmcnt(0)
  v_mfma_f32_16x16x32_bf16 v[16:19], v[176:179], v[128:131], v[16:19]
  ds_read_b64_tr_b16 v[160:161], v218 offset:16384
  v_mfma_f32_16x16x32_bf16 v[20:23], v[180:183], v[128:131], v[20:23]
  ds_read_b64_tr_b16 v[162:163], v218 offset:16896
  v_mfma_f32_16x16x32_bf16 v[24:27], v[184:187], v[128:131], v[24:27]
  ds_read_b64_tr_b16 v[164:165], v219 offset:16384
  v_mfma_f32_16x16x32_bf16 v[28:31], v[188:191], v[128:131], v[28:31]
  ds_read_b64_tr_b16 v[166:167], v219 offset:16896
  v_mfma_f32_16x16x32_bf16 v[48:51], v[176:179], v[132:135], v[48:51]
  ds_read_b128 v[152:155], v217 offset:4096
  v_mfma_f32_16x16x32_bf16 v[52:55], v[180:183], v[132:135], v[52:55]
  ds_read_b64_tr_b16 v[168:169], v220 offset:16384
  v_mfma_f32_16x16x32_bf16 v[56:59], v[184:187], v[132:135], v[56:59]
  ds_read_b64_tr_b16 v[170:171], v220 offset:16896
  v_mfma_f32_16x16x32_bf16 v[60:63], v[188:191], v[132:135], v[60:63]
  ds_read_b64_tr_b16 v[172:173], v221 offset:16384
  v_mfma_f32_16x16x32_bf16 v[80:83], v[176:179], v[136:139], v[80:83]
  ds_read_b64_tr_b16 v[174:175], v221 offset:16896
  v_mfma_f32_16x16x32_bf16 v[84:87], v[180:183], v[136:139], v[84:87]
  ds_read_b128 v[156:159], v217 offset:6144
  v_mfma_f32_16x16x32_bf16 v[200:203], v[192:195], v[136:139], v[200:203]
  v_mfma_f32_16x16x32_bf16 v[88:91], v[184:187], v[136:139], v[88:91]
  v_mfma_f32_16x16x32_bf16 v[204:207], v[196:199], v[136:139], v[204:207]
  v_mfma_f32_16x16x32_bf16 v[92:95], v[188:191], v[136:139], v[92:95]
  v_mfma_f32_16x16x32_bf16 v[208:211], v[192:195], v[140:143], v[208:211]
  v_mfma_f32_16x16x32_bf16 v[112:115], v[176:179], v[140:143], v[112:115]
  v_mfma_f32_16x16x32_bf16 v[212:215], v[196:199], v[140:143], v[212:215]
  v_mfma_f32_16x16x32_bf16 v[116:119], v[180:183], v[140:143], v[116:119]
  v_mfma_f32_16x16x32_bf16 v[120:123], v[184:187], v[140:143], v[120:123]
  v_mfma_f32_16x16x32_bf16 v[124:127], v[188:191], v[140:143], v[124:127]
  s_waitcnt lgkmcnt(0)
  v_mfma_f32_16x16x32_bf16 v[0:3], v[160:163], v[144:147], v[0:3]
  ds_read_b64_tr_b16 v[176:177], v218 offset:17408
  v_mfma_f32_16x16x32_bf16 v[4:7], v[164:167], v[144:147], v[4:7]
  ds_read_b64_tr_b16 v[178:179], v218 offset:17920
  v_mfma_f32_16x16x32_bf16 v[8:11], v[168:171], v[144:147], v[8:11]
  ds_read_b64_tr_b16 v[180:181], v219 offset:17408
  v_mfma_f32_16x16x32_bf16 v[12:15], v[172:175], v[144:147], v[12:15]
  ds_read_b64_tr_b16 v[182:183], v219 offset:17920
  v_mfma_f32_16x16x32_bf16 v[32:35], v[160:163], v[148:151], v[32:35]
  ds_read_b64_tr_b16 v[184:185], v220 offset:17408
  v_mfma_f32_16x16x32_bf16 v[36:39], v[164:167], v[148:151], v[36:39]
  ds_read_b64_tr_b16 v[186:187], v220 offset:17920
  v_mfma_f32_16x16x32_bf16 v[40:43], v[168:171], v[148:151], v[40:43]
  ds_read_b64_tr_b16 v[188:189], v221 offset:17408
  v_mfma_f32_16x16x32_bf16 v[44:47], v[172:175], v[148:151], v[44:47]
  ds_read_b64_tr_b16 v[190:191], v221 offset:17920
  v_mfma_f32_16x16x32_bf16 v[64:67], v[160:163], v[152:155], v[64:67]
  v_mfma_f32_16x16x32_bf16 v[68:71], v[164:167], v[152:155], v[68:71]
  v_mfma_f32_16x16x32_bf16 v[72:75], v[168:171], v[152:155], v[72:75]
  v_mfma_f32_16x16x32_bf16 v[76:79], v[172:175], v[152:155], v[76:79]
  v_mfma_f32_16x16x32_bf16 v[96:99], v[160:163], v[156:159], v[96:99]
  v_mfma_f32_16x16x32_bf16 v[100:103], v[164:167], v[156:159], v[100:103]
  v_mfma_f32_16x16x32_bf16 v[104:107], v[168:171], v[156:159], v[104:107]
  v_mfma_f32_16x16x32_bf16 v[108:111], v[172:175], v[156:159], v[108:111]
  s_waitcnt lgkmcnt(0)
  s_barrier
  v_mfma_f32_16x16x32_bf16 v[16:19], v[176:179], v[144:147], v[16:19]
  v_add_u32 v216, s27, v216
  v_add_u32 v218, s27, v218
  v_mfma_f32_16x16x32_bf16 v[20:23], v[180:183], v[144:147], v[20:23]
  ds_read_b128 v[128:131], v216 offset:0
  ds_read_b64_tr_b16 v[160:161], v218 offset:0
  v_mfma_f32_16x16x32_bf16 v[24:27], v[184:187], v[144:147], v[24:27]
  ds_read_b64_tr_b16 v[162:163], v218 offset:512
  v_add_u32 v219, s27, v219
  v_mfma_f32_16x16x32_bf16 v[28:31], v[188:191], v[144:147], v[28:31]
  ds_read_b128 v[132:135], v216 offset:2048
  ds_read_b64_tr_b16 v[164:165], v219 offset:0
  v_mfma_f32_16x16x32_bf16 v[48:51], v[176:179], v[148:151], v[48:51]
  ds_read_b64_tr_b16 v[166:167], v219 offset:512
  v_add_u32 v220, s27, v220
  v_mfma_f32_16x16x32_bf16 v[52:55], v[180:183], v[148:151], v[52:55]
  ds_read_b128 v[136:139], v216 offset:4096
  ds_read_b64_tr_b16 v[168:169], v220 offset:0
  v_mfma_f32_16x16x32_bf16 v[56:59], v[184:187], v[148:151], v[56:59]
  ds_read_b64_tr_b16 v[170:171], v220 offset:512
  v_add_u32 v221, s27, v221
  v_mfma_f32_16x16x32_bf16 v[60:63], v[188:191], v[148:151], v[60:63]
  ds_read_b128 v[140:143], v216 offset:6144
  ds_read_b64_tr_b16 v[172:173], v221 offset:0
  v_mfma_f32_16x16x32_bf16 v[80:83], v[176:179], v[152:155], v[80:83]
  ds_read_b64_tr_b16 v[174:175], v221 offset:512
  v_mfma_f32_16x16x32_bf16 v[84:87], v[180:183], v[152:155], v[84:87]
  v_add_u32 v217, s27, v217
  v_mfma_f32_16x16x32_bf16 v[88:91], v[184:187], v[152:155], v[88:91]
  v_add_u32 v222, s27, v222
  v_mfma_f32_16x16x32_bf16 v[92:95], v[188:191], v[152:155], v[92:95]
  s_sub_u32 s28, s28, 1
  v_mfma_f32_16x16x32_bf16 v[112:115], v[176:179], v[156:159], v[112:115]
  s_cmp_lg_u32 s28, 0
  v_mfma_f32_16x16x32_bf16 v[116:119], v[180:183], v[156:159], v[116:119]
  v_mfma_f32_16x16x32_bf16 v[120:123], v[184:187], v[156:159], v[120:123]
  v_mfma_f32_16x16x32_bf16 v[124:127], v[188:191], v[156:159], v[124:127]
  s_cbranch_scc1 p1_c_B4_loop
  s_waitcnt lgkmcnt(0)
  v_mfma_f32_16x16x32_bf16 v[0:3], v[160:163], v[128:131], v[0:3]
  ds_read_b128 v[144:147], v217 offset:0
  v_mfma_f32_16x16x32_bf16 v[4:7], v[164:167], v[128:131], v[4:7]
  ds_read_b64_tr_b16 v[176:177], v218 offset:16384
  v_mfma_f32_16x16x32_bf16 v[8:11], v[168:171], v[128:131], v[8:11]
  ds_read_b64_tr_b16 v[178:179], v218 offset:16896
  v_mfma_f32_16x16x32_bf16 v[12:15], v[172:175], v[128:131], v[12:15]
  ds_read_b128 v[148:151], v217 offset:2048
  v_mfma_f32_16x16x32_bf16 v[32:35], v[160:163], v[132:135], v[32:35]
  ds_read_b64_tr_b16 v[180:181], v219 offset:16384
  v_mfma_f32_16x16x32_bf16 v[36:39], v[164:167], v[132:135], v[36:39]
  ds_read_b64_tr_b16 v[182:183], v219 offset:16896
  v_mfma_f32_16x16x32_bf16 v[40:43], v[168:171], v[132:135], v[40:43]
  ds_read_b128 v[152:155], v217 offset:4096
  v_mfma_f32_16x16x32_bf16 v[44:47], v[172:175], v[132:135], v[44:47]
  ds_read_b64_tr_b16 v[184:185], v220 offset:16384
  v_mfma_f32_16x16x32_bf16 v[64:67], v[160:163], v[136:139], v[64:67]
  ds_read_b64_tr_b16 v[186:187], v220 offset:16896
  v_mfma_f32_16x16x32_bf16 v[68:71], v[164:167], v[136:139], v[68:71]
  ds_read_b128 v[156:159], v217 offset:6144
  v_add_u32 v236, 0xfffe6000, v222
  v_mfma_f32_16x16x32_bf16 v[72:75], v[168:171], v[136:139], v[72:75]
  ds_read_b64_tr_b16 v[188:189], v221 offset:16384
  v_add_u32 v235, 0xfffe6000, v221
  v_mfma_f32_16x16x32_bf16 v[76:79], v[172:175], v[136:139], v[76:79]
  ds_read_b64_tr_b16 v[190:191], v221 offset:16896
  v_add_u32 v234, 0xfffe6000, v220
  v_mfma_f32_16x16x32_bf16 v[96:99], v[160:163], v[140:143], v[96:99]
  v_add_u32 v233, 0xfffe6000, v219
  v_mfma_f32_16x16x32_bf16 v[100:103], v[164:167], v[140:143], v[100:103]
  v_add_u32 v232, 0xfffe6000, v218
  v_mfma_f32_16x16x32_bf16 v[104:107], v[168:171], v[140:143], v[104:107]
  v_add_u32 v231, 0xfffe6000, v217
  v_mfma_f32_16x16x32_bf16 v[108:111], v[172:175], v[140:143], v[108:111]
  v_add_u32 v230, 0xfffe6000, v216
  s_waitcnt lgkmcnt(0)
  s_barrier
  v_mfma_f32_16x16x32_bf16 v[0:3], v[176:179], v[144:147], v[0:3]
  ds_read_b128 v[128:131], v230 offset:0
  v_mfma_f32_16x16x32_bf16 v[4:7], v[180:183], v[144:147], v[4:7]
  ds_read_b64_tr_b16 v[160:161], v232 offset:0
  v_mfma_f32_16x16x32_bf16 v[8:11], v[184:187], v[144:147], v[8:11]
  ds_read_b64_tr_b16 v[162:163], v232 offset:512
  v_mfma_f32_16x16x32_bf16 v[12:15], v[188:191], v[144:147], v[12:15]
  ds_read_b128 v[132:135], v230 offset:2048
  v_mfma_f32_16x16x32_bf16 v[32:35], v[176:179], v[148:151], v[32:35]
  ds_read_b64_tr_b16 v[164:165], v233 offset:0
  v_mfma_f32_16x16x32_bf16 v[36:39], v[180:183], v[148:151], v[36:39]
  ds_read_b64_tr_b16 v[166:167], v233 offset:512
  v_mfma_f32_16x16x32_bf16 v[40:43], v[184:187], v[148:151], v[40:43]
  ds_read_b128 v[136:139], v230 offset:4096
  v_mfma_f32_16x16x32_bf16 v[44:47], v[188:191], v[148:151], v[44:47]
  ds_read_b64_tr_b16 v[168:169], v234 offset:0
  v_mfma_f32_16x16x32_bf16 v[64:67], v[176:179], v[152:155], v[64:67]
  ds_read_b64_tr_b16 v[170:171], v234 offset:512
  v_mfma_f32_16x16x32_bf16 v[68:71], v[180:183], v[152:155], v[68:71]
  ds_read_b128 v[140:143], v230 offset:6144
  v_mfma_f32_16x16x32_bf16 v[72:75], v[184:187], v[152:155], v[72:75]
  ds_read_b64_tr_b16 v[172:173], v235 offset:0
  v_mfma_f32_16x16x32_bf16 v[76:79], v[188:191], v[152:155], v[76:79]
  ds_read_b64_tr_b16 v[174:175], v235 offset:512
  v_mfma_f32_16x16x32_bf16 v[96:99], v[176:179], v[156:159], v[96:99]
  v_mfma_f32_16x16x32_bf16 v[100:103], v[180:183], v[156:159], v[100:103]
  v_mfma_f32_16x16x32_bf16 v[104:107], v[184:187], v[156:159], v[104:107]
  v_mfma_f32_16x16x32_bf16 v[108:111], v[188:191], v[156:159], v[108:111]
  s_waitcnt lgkmcnt(0)
  v_mfma_f32_16x16x32_bf16 v[0:3], v[160:163], v[128:131], v[0:3]
  ds_read_b128 v[144:147], v231 offset:0
  v_mfma_f32_16x16x32_bf16 v[4:7], v[164:167], v[128:131], v[4:7]
  ds_read_b64_tr_b16 v[176:177], v232 offset:16384
  v_mfma_f32_16x16x32_bf16 v[8:11], v[168:171], v[128:131], v[8:11]
  ds_read_b64_tr_b16 v[178:179], v232 offset:16896
  v_mfma_f32_16x16x32_bf16 v[12:15], v[172:175], v[128:131], v[12:15]
  ds_read_b128 v[148:151], v231 offset:2048
  v_mfma_f32_16x16x32_bf16 v[32:35], v[160:163], v[132:135], v[32:35]
  ds_read_b64_tr_b16 v[180:181], v233 offset:16384
  v_mfma_f32_16x16x32_bf16 v[36:39], v[164:167], v[132:135], v[36:39]
  ds_read_b64_tr_b16 v[182:183], v233 offset:16896
  v_mfma_f32_16x16x32_bf16 v[40:43], v[168:171], v[132:135], v[40:43]
  ds_read_b128 v[152:155], v231 offset:4096
  v_mfma_f32_16x16x32_bf16 v[44:47], v[172:175], v[132:135], v[44:47]
  ds_read_b64_tr_b16 v[184:185], v234 offset:16384
  v_mfma_f32_16x16x32_bf16 v[64:67], v[160:163], v[136:139], v[64:67]
  ds_read_b64_tr_b16 v[186:187], v234 offset:16896
  v_mfma_f32_16x16x32_bf16 v[68:71], v[164:167], v[136:139], v[68:71]
  ds_read_b128 v[156:159], v231 offset:6144
  v_mfma_f32_16x16x32_bf16 v[72:75], v[168:171], v[136:139], v[72:75]
  ds_read_b64_tr_b16 v[188:189], v235 offset:16384
  v_mfma_f32_16x16x32_bf16 v[76:79], v[172:175], v[136:139], v[76:79]
  ds_read_b64_tr_b16 v[190:191], v235 offset:16896
  v_mfma_f32_16x16x32_bf16 v[96:99], v[160:163], v[140:143], v[96:99]
  v_mfma_f32_16x16x32_bf16 v[100:103], v[164:167], v[140:143], v[100:103]
  v_mfma_f32_16x16x32_bf16 v[104:107], v[168:171], v[140:143], v[104:107]
  v_mfma_f32_16x16x32_bf16 v[108:111], v[172:175], v[140:143], v[108:111]
  s_waitcnt lgkmcnt(0)
  v_mfma_f32_16x16x32_bf16 v[0:3], v[176:179], v[144:147], v[0:3]
  ds_read_b64_tr_b16 v[160:161], v232 offset:1024
  v_mfma_f32_16x16x32_bf16 v[4:7], v[180:183], v[144:147], v[4:7]
  ds_read_b64_tr_b16 v[162:163], v232 offset:1536
  v_mfma_f32_16x16x32_bf16 v[8:11], v[184:187], v[144:147], v[8:11]
  ds_read_b64_tr_b16 v[164:165], v233 offset:1024
  v_mfma_f32_16x16x32_bf16 v[12:15], v[188:191], v[144:147], v[12:15]
  ds_read_b64_tr_b16 v[166:167], v233 offset:1536
  v_mfma_f32_16x16x32_bf16 v[32:35], v[176:179], v[148:151], v[32:35]
  ds_read_b64_tr_b16 v[168:169], v234 offset:1024
  v_mfma_f32_16x16x32_bf16 v[36:39], v[180:183], v[148:151], v[36:39]
  ds_read_b64_tr_b16 v[170:171], v234 offset:1536
  v_mfma_f32_16x16x32_bf16 v[40:43], v[184:187], v[148:151], v[40:43]
  ds_read_b64_tr_b16 v[172:173], v235 offset:1024
  v_mfma_f32_16x16x32_bf16 v[44:47], v[188:191], v[148:151], v[44:47]
  ds_read_b64_tr_b16 v[174:175], v235 offset:1536
  v_mfma_f32_16x16x32_bf16 v[64:67], v[176:179], v[152:155], v[64:67]
  ds_read_b64_tr_b16 v[192:193], v236 offset:0
  v_mfma_f32_16x16x32_bf16 v[68:71], v[180:183], v[152:155], v[68:71]
  ds_read_b64_tr_b16 v[194:195], v236 offset:256
  v_mfma_f32_16x16x32_bf16 v[72:75], v[184:187], v[152:155], v[72:75]
  ds_read_b64_tr_b16 v[196:197], v236 offset:32
  v_mfma_f32_16x16x32_bf16 v[76:79], v[188:191], v[152:155], v[76:79]
  ds_read_b64_tr_b16 v[198:199], v236 offset:288
  v_mfma_f32_16x16x32_bf16 v[96:99], v[176:179], v[156:159], v[96:99]
  v_mfma_f32_16x16x32_bf16 v[100:103], v[180:183], v[156:159], v[100:103]
  v_mfma_f32_16x16x32_bf16 v[104:107], v[184:187], v[156:159], v[104:107]
  v_mfma_f32_16x16x32_bf16 v[108:111], v[188:191], v[156:159], v[108:111]
  s_waitcnt lgkmcnt(0)
  v_mfma_f32_16x16x32_bf16 v[16:19], v[160:163], v[128:131], v[16:19]
  ds_read_b64_tr_b16 v[176:177], v232 offset:17408
  v_mfma_f32_16x16x32_bf16 v[20:23], v[164:167], v[128:131], v[20:23]
  ds_read_b64_tr_b16 v[178:179], v232 offset:17920
  v_mfma_f32_16x16x32_bf16 v[24:27], v[168:171], v[128:131], v[24:27]
  ds_read_b64_tr_b16 v[180:181], v233 offset:17408
  v_mfma_f32_16x16x32_bf16 v[28:31], v[172:175], v[128:131], v[28:31]
  ds_read_b64_tr_b16 v[182:183], v233 offset:17920
  v_mfma_f32_16x16x32_bf16 v[48:51], v[160:163], v[132:135], v[48:51]
  ds_read_b64_tr_b16 v[184:185], v234 offset:17408
  v_cvt_pk_bf16_f32 v0, v0, v1
  v_mfma_f32_16x16x32_bf16 v[52:55], v[164:167], v[132:135], v[52:55]
  ds_read_b64_tr_b16 v[186:187], v234 offset:17920
  v_cvt_pk_bf16_f32 v1, v2, v3
  v_mfma_f32_16x16x32_bf16 v[56:59], v[168:171], v[132:135], v[56:59]
  ds_read_b64_tr_b16 v[188:189], v235 offset:17408
  v_cvt_pk_bf16_f32 v2, v4, v5
  v_mfma_f32_16x16x32_bf16 v[60:63], v[172:175], v[132:135], v[60:63]
  ds_read_b64_tr_b16 v[190:191], v235 offset:17920
  v_cvt_pk_bf16_f32 v3, v6, v7
  v_mfma_f32_16x16x32_bf16 v[80:83], v[160:163], v[136:139], v[80:83]
  s_mul_i32 s7, s31, 0
  v_mfma_f32_16x16x32_bf16 v[84:87], v[164:167], v[136:139], v[84:87]
  s_add_u32 s7, s7, s30
  v_mfma_f32_16x16x32_bf16 v[200:203], v[192:195], v[136:139], v[200:203]
  buffer_store_dwordx4 v[0:3], v224, s[20:23], s7 offen sc1
  v_mfma_f32_16x16x32_bf16 v[88:91], v[168:171], v[136:139], v[88:91]
  v_cvt_pk_bf16_f32 v32, v32, v33
  v_mfma_f32_16x16x32_bf16 v[204:207], v[196:199], v[136:139], v[204:207]
  v_cvt_pk_bf16_f32 v33, v34, v35
  v_mfma_f32_16x16x32_bf16 v[92:95], v[172:175], v[136:139], v[92:95]
  v_cvt_pk_bf16_f32 v34, v36, v37
  v_mfma_f32_16x16x32_bf16 v[208:211], v[192:195], v[140:143], v[208:211]
  v_cvt_pk_bf16_f32 v35, v38, v39
  v_mfma_f32_16x16x32_bf16 v[112:115], v[160:163], v[140:143], v[112:115]
  buffer_store_dwordx4 v[32:35], v224, s[20:23], s7 offen offset:256 sc1
  v_mfma_f32_16x16x32_bf16 v[212:215], v[196:199], v[140:143], v[212:215]
  v_cvt_pk_bf16_f32 v8, v8, v9
  v_mfma_f32_16x16x32_bf16 v[116:119], v[164:167], v[140:143], v[116:119]
  v_cvt_pk_bf16_f32 v9, v10, v11
  v_mfma_f32_16x16x32_bf16 v[120:123], v[168:171], v[140:143], v[120:123]
  v_cvt_pk_bf16_f32 v10, v12, v13
  v_mfma_f32_16x16x32_bf16 v[124:127], v[172:175], v[140:143], v[124:127]
  v_cvt_pk_bf16_f32 v11, v14, v15
  s_waitcnt lgkmcnt(0)
  v_mfma_f32_16x16x32_bf16 v[16:19], v[176:179], v[144:147], v[16:19]
  ds_read_b128 v[128:131], v216 offset:0
  s_mul_i32 s7, s31, 1
  v_mfma_f32_16x16x32_bf16 v[20:23], v[180:183], v[144:147], v[20:23]
  ds_read_b64_tr_b16 v[160:161], v218 offset:1024
  s_add_u32 s7, s7, s30
  v_mfma_f32_16x16x32_bf16 v[24:27], v[184:187], v[144:147], v[24:27]
  ds_read_b64_tr_b16 v[162:163], v218 offset:1536
  buffer_store_dwordx4 v[8:11], v224, s[20:23], s7 offen sc1
  v_mfma_f32_16x16x32_bf16 v[28:31], v[188:191], v[144:147], v[28:31]
  ds_read_b128 v[132:135], v216 offset:2048
  v_cvt_pk_bf16_f32 v40, v40, v41
  v_mfma_f32_16x16x32_bf16 v[48:51], v[176:179], v[148:151], v[48:51]
  ds_read_b64_tr_b16 v[164:165], v219 offset:1024
  v_cvt_pk_bf16_f32 v41, v42, v43
  v_mfma_f32_16x16x32_bf16 v[52:55], v[180:183], v[148:151], v[52:55]
  ds_read_b64_tr_b16 v[166:167], v219 offset:1536
  v_cvt_pk_bf16_f32 v42, v44, v45
  v_mfma_f32_16x16x32_bf16 v[56:59], v[184:187], v[148:151], v[56:59]
  ds_read_b128 v[136:139], v216 offset:4096
  v_cvt_pk_bf16_f32 v43, v46, v47
  v_mfma_f32_16x16x32_bf16 v[60:63], v[188:191], v[148:151], v[60:63]
  ds_read_b64_tr_b16 v[168:169], v220 offset:1024
  buffer_store_dwordx4 v[40:43], v224, s[20:23], s7 offen offset:256 sc1
  v_mfma_f32_16x16x32_bf16 v[80:83], v[176:179], v[152:155], v[80:83]
  ds_read_b64_tr_b16 v[170:171], v220 offset:1536
  v_cvt_pk_bf16_f32 v64, v64, v65
  v_mfma_f32_16x16x32_bf16 v[84:87], v[180:183], v[152:155], v[84:87]
  ds_read_b128 v[140:143], v216 offset:6144
  v_cvt_pk_bf16_f32 v65, v66, v67
  v_mfma_f32_16x16x32_bf16 v[88:91], v[184:187], v[152:155], v[88:91]
  ds_read_b64_tr_b16 v[172:173], v221 offset:1024
  v_cvt_pk_bf16_f32 v66, v68, v69
  v_mfma_f32_16x16x32_bf16 v[92:95], v[188:191], v[152:155], v[92:95]
  ds_read_b64_tr_b16 v[174:175], v221 offset:1536
  v_cvt_pk_bf16_f32 v67, v70, v71
  v_mfma_f32_16x16x32_bf16 v[112:115], v[176:179], v[156:159], v[112:115]
  ds_read_b64_tr_b16 v[192:193], v222 offset:0
  s_mul_i32 s7, s31, 0
  v_mfma_f32_16x16x32_bf16 v[116:119], v[180:183], v[156:159], v[116:119]
  ds_read_b64_tr_b16 v[194:195], v222 offset:256
  s_add_u32 s7, s7, s30
  v_mfma_f32_16x16x32_bf16 v[120:123], v[184:187], v[156:159], v[120:123]
  ds_read_b64_tr_b16 v[196:197], v222 offset:32
  s_add_u32 s7, s7, s32
  v_mfma_f32_16x16x32_bf16 v[124:127], v[188:191], v[156:159], v[124:127]
  ds_read_b64_tr_b16 v[198:199], v222 offset:288
  buffer_store_dwordx4 v[64:67], v224, s[20:23], s7 offen sc1
  s_waitcnt lgkmcnt(0)
  v_mfma_f32_16x16x32_bf16 v[16:19], v[160:163], v[128:131], v[16:19]
  ds_read_b128 v[144:147], v217 offset:0
  v_cvt_pk_bf16_f32 v96, v96, v97
  v_mfma_f32_16x16x32_bf16 v[20:23], v[164:167], v[128:131], v[20:23]
  ds_read_b64_tr_b16 v[176:177], v218 offset:17408
  v_cvt_pk_bf16_f32 v97, v98, v99
  v_mfma_f32_16x16x32_bf16 v[24:27], v[168:171], v[128:131], v[24:27]
  ds_read_b64_tr_b16 v[178:179], v218 offset:17920
  v_cvt_pk_bf16_f32 v98, v100, v101
  v_mfma_f32_16x16x32_bf16 v[28:31], v[172:175], v[128:131], v[28:31]
  ds_read_b128 v[148:151], v217 offset:2048
  v_cvt_pk_bf16_f32 v99, v102, v103
  v_mfma_f32_16x16x32_bf16 v[48:51], v[160:163], v[132:135], v[48:51]
  ds_read_b64_tr_b16 v[180:181], v219 offset:17408
  buffer_store_dwordx4 v[96:99], v224, s[20:23], s7 offen offset:256 sc1
  v_mfma_f32_16x16x32_bf16 v[52:55], v[164:167], v[132:135], v[52:55]
  ds_read_b64_tr_b16 v[182:183], v219 offset:17920
  v_cvt_pk_bf16_f32 v72, v72, v73
  v_mfma_f32_16x16x32_bf16 v[56:59], v[168:171], v[132:135], v[56:59]
  ds_read_b128 v[152:155], v217 offset:4096
  v_cvt_pk_bf16_f32 v73, v74, v75
  v_mfma_f32_16x16x32_bf16 v[60:63], v[172:175], v[132:135], v[60:63]
  ds_read_b64_tr_b16 v[184:185], v220 offset:17408
  v_cvt_pk_bf16_f32 v74, v76, v77
  v_mfma_f32_16x16x32_bf16 v[80:83], v[160:163], v[136:139], v[80:83]
  ds_read_b64_tr_b16 v[186:187], v220 offset:17920
  v_cvt_pk_bf16_f32 v75, v78, v79
  v_mfma_f32_16x16x32_bf16 v[84:87], v[164:167], v[136:139], v[84:87]
  ds_read_b128 v[156:159], v217 offset:6144
  s_mul_i32 s7, s31, 1
  v_mfma_f32_16x16x32_bf16 v[200:203], v[192:195], v[136:139], v[200:203]
  ds_read_b64_tr_b16 v[188:189], v221 offset:17408
  s_add_u32 s7, s7, s30
  v_mfma_f32_16x16x32_bf16 v[88:91], v[168:171], v[136:139], v[88:91]
  ds_read_b64_tr_b16 v[190:191], v221 offset:17920
  s_add_u32 s7, s7, s32
  v_mfma_f32_16x16x32_bf16 v[204:207], v[196:199], v[136:139], v[204:207]
  buffer_store_dwordx4 v[72:75], v224, s[20:23], s7 offen sc1
  v_mfma_f32_16x16x32_bf16 v[92:95], v[172:175], v[136:139], v[92:95]
  v_cvt_pk_bf16_f32 v104, v104, v105
  v_mfma_f32_16x16x32_bf16 v[208:211], v[192:195], v[140:143], v[208:211]
  v_cvt_pk_bf16_f32 v105, v106, v107
  v_mfma_f32_16x16x32_bf16 v[112:115], v[160:163], v[140:143], v[112:115]
  v_cvt_pk_bf16_f32 v106, v108, v109
  v_mfma_f32_16x16x32_bf16 v[212:215], v[196:199], v[140:143], v[212:215]
  v_cvt_pk_bf16_f32 v107, v110, v111
  v_mfma_f32_16x16x32_bf16 v[116:119], v[164:167], v[140:143], v[116:119]
  buffer_store_dwordx4 v[104:107], v224, s[20:23], s7 offen offset:256 sc1
  v_mfma_f32_16x16x32_bf16 v[120:123], v[168:171], v[140:143], v[120:123]
  v_mfma_f32_16x16x32_bf16 v[124:127], v[172:175], v[140:143], v[124:127]
  s_waitcnt lgkmcnt(0)
  v_mfma_f32_16x16x32_bf16 v[16:19], v[176:179], v[144:147], v[16:19]
  v_mfma_f32_16x16x32_bf16 v[20:23], v[180:183], v[144:147], v[20:23]
  v_mfma_f32_16x16x32_bf16 v[24:27], v[184:187], v[144:147], v[24:27]
  v_mfma_f32_16x16x32_bf16 v[28:31], v[188:191], v[144:147], v[28:31]
  v_mfma_f32_16x16x32_bf16 v[48:51], v[176:179], v[148:151], v[48:51]
  v_mfma_f32_16x16x32_bf16 v[52:55], v[180:183], v[148:151], v[52:55]
  v_mfma_f32_16x16x32_bf16 v[56:59], v[184:187], v[148:151], v[56:59]
  v_mfma_f32_16x16x32_bf16 v[60:63], v[188:191], v[148:151], v[60:63]
  v_mfma_f32_16x16x32_bf16 v[80:83], v[176:179], v[152:155], v[80:83]
  v_mfma_f32_16x16x32_bf16 v[84:87], v[180:183], v[152:155], v[84:87]
  v_mfma_f32_16x16x32_bf16 v[88:91], v[184:187], v[152:155], v[88:91]
  v_mfma_f32_16x16x32_bf16 v[92:95], v[188:191], v[152:155], v[92:95]
  v_mfma_f32_16x16x32_bf16 v[112:115], v[176:179], v[156:159], v[112:115]
  v_mfma_f32_16x16x32_bf16 v[116:119], v[180:183], v[156:159], v[116:119]
  v_mfma_f32_16x16x32_bf16 v[120:123], v[184:187], v[156:159], v[120:123]
  v_mfma_f32_16x16x32_bf16 v[124:127], v[188:191], v[156:159], v[124:127]
  s_nop 7
  v_cvt_pk_bf16_f32 v16, v16, v17
  v_cvt_pk_bf16_f32 v17, v18, v19
  v_cvt_pk_bf16_f32 v18, v20, v21
  v_cvt_pk_bf16_f32 v19, v22, v23
  s_mul_i32 s7, s31, 2
  s_add_u32 s7, s7, s30
  buffer_store_dwordx4 v[16:19], v224, s[20:23], s7 offen sc1
  v_cvt_pk_bf16_f32 v48, v48, v49
  v_cvt_pk_bf16_f32 v49, v50, v51
  v_cvt_pk_bf16_f32 v50, v52, v53
  v_cvt_pk_bf16_f32 v51, v54, v55
  buffer_store_dwordx4 v[48:51], v224, s[20:23], s7 offen offset:256 sc1
  v_cvt_pk_bf16_f32 v24, v24, v25
  v_cvt_pk_bf16_f32 v25, v26, v27
  v_cvt_pk_bf16_f32 v26, v28, v29
  v_cvt_pk_bf16_f32 v27, v30, v31
  s_mul_i32 s7, s31, 3
  s_add_u32 s7, s7, s30
  buffer_store_dwordx4 v[24:27], v224, s[20:23], s7 offen sc1
  v_cvt_pk_bf16_f32 v56, v56, v57
  v_cvt_pk_bf16_f32 v57, v58, v59
  v_cvt_pk_bf16_f32 v58, v60, v61
  v_cvt_pk_bf16_f32 v59, v62, v63
  buffer_store_dwordx4 v[56:59], v224, s[20:23], s7 offen offset:256 sc1
  v_cvt_pk_bf16_f32 v80, v80, v81
  v_cvt_pk_bf16_f32 v81, v82, v83
  v_cvt_pk_bf16_f32 v82, v84, v85
  v_cvt_pk_bf16_f32 v83, v86, v87
  s_mul_i32 s7, s31, 2
  s_add_u32 s7, s7, s30
  s_add_u32 s7, s7, s32
  buffer_store_dwordx4 v[80:83], v224, s[20:23], s7 offen sc1
  v_cvt_pk_bf16_f32 v112, v112, v113
  v_cvt_pk_bf16_f32 v113, v114, v115
  v_cvt_pk_bf16_f32 v114, v116, v117
  v_cvt_pk_bf16_f32 v115, v118, v119
  buffer_store_dwordx4 v[112:115], v224, s[20:23], s7 offen offset:256 sc1
  v_cvt_pk_bf16_f32 v88, v88, v89
  v_cvt_pk_bf16_f32 v89, v90, v91
  v_cvt_pk_bf16_f32 v90, v92, v93
  v_cvt_pk_bf16_f32 v91, v94, v95
  s_mul_i32 s7, s31, 3
  s_add_u32 s7, s7, s30
  s_add_u32 s7, s7, s32
  buffer_store_dwordx4 v[88:91], v224, s[20:23], s7 offen sc1
  v_cvt_pk_bf16_f32 v120, v120, v121
  v_cvt_pk_bf16_f32 v121, v122, v123
  v_cvt_pk_bf16_f32 v122, v124, v125
  v_cvt_pk_bf16_f32 v123, v126, v127
  buffer_store_dwordx4 v[120:123], v224, s[20:23], s7 offen offset:256 sc1
  s_waitcnt lgkmcnt(0)
  s_barrier
  s_lshl_b32 s7, s24, 12
  s_add_u32 s7, s7, 53248
  v_add_u32 v226, s7, v223
  ds_read_b128 v[128:131], v226 offset:0
  ds_read_b128 v[132:135], v226 offset:1024
  ds_read_b128 v[136:139], v226 offset:2048
  ds_read_b128 v[140:143], v226 offset:3072
  s_waitcnt lgkmcnt(0)
  v_add_f32 v200, v200, v128
  v_add_f32 v201, v201, v129
  v_add_f32 v202, v202, v130
  v_add_f32 v203, v203, v131
  v_add_f32 v204, v204, v132
  v_add_f32 v205, v205, v133
  v_add_f32 v206, v206, v134
  v_add_f32 v207, v207, v135
  v_add_f32 v208, v208, v136
  v_add_f32 v209, v209, v137
  v_add_f32 v210, v210, v138
  v_add_f32 v211, v211, v139
  v_add_f32 v212, v212, v140
  v_add_f32 v213, v213, v141
  v_add_f32 v214, v214, v142
  v_add_f32 v215, v215, v143
  v_pk_mul_f32 v[200:201], v[200:201], s[34:35]
  v_pk_mul_f32 v[202:203], v[202:203], s[34:35]
  v_pk_mul_f32 v[204:205], v[204:205], s[34:35]
  v_pk_mul_f32 v[206:207], v[206:207], s[34:35]
  v_pk_mul_f32 v[208:209], v[208:209], s[34:35]
  v_pk_mul_f32 v[210:211], v[210:211], s[34:35]
  v_pk_mul_f32 v[212:213], v[212:213], s[34:35]
  v_pk_mul_f32 v[214:215], v[214:215], s[34:35]
  v_cvt_pk_bf16_f32 v200, v200, v201
  v_cvt_pk_bf16_f32 v201, v202, v203
  v_cvt_pk_bf16_f32 v202, v204, v205
  v_cvt_pk_bf16_f32 v203, v206, v207
  v_cvt_pk_bf16_f32 v204, v208, v209
  v_cvt_pk_bf16_f32 v205, v210, v211
  v_cvt_pk_bf16_f32 v206, v212, v213
  v_cvt_pk_bf16_f32 v207, v214, v215
  s_lshl_b32 s7, s5, 2
  s_lshl_b32 s33, s24, 1
  s_add_u32 s7, s7, s33
  s_add_u32 s7, s7, 1
  s_lshl_b32 s7, s7, 12
  s_add_u32 s7, s7, 16777216
  buffer_store_dwordx4 v[200:203], v225, s[20:23], s7 offen sc1
  buffer_store_dwordx4 v[204:207], v225, s[20:23], s7 offen offset:128 sc1
  s_endpgm
p1_c_B5:
  s_lshl_b32 s7, s6, 3
  s_lshl_b32 s33, s25, 2
  s_add_u32 s7, s7, s33
  s_lshl_b32 s33, s5, 2
  s_lshl_b32 s36, s24, 1
  s_add_u32 s33, s33, s36
  s_mov_b32 s31, 131072
  s_mov_b32 s32, 2048
  s_mov_b32 s36, 12582912
  s_mov_b32 s34, 0x3e8293ee
  s_mov_b32 s35, s34
  s_mul_i32 s7, s7, s31
  s_mul_i32 s33, s33, s32
  s_add_u32 s30, s7, s33
  s_add_u32 s30, s30, s36
  s_mov_b32 s28, 14
  s_waitcnt lgkmcnt(0)
  s_barrier
  ds_read_b128 v[128:131], v216 offset:0
  ds_read_b64_tr_b16 v[160:161], v218 offset:0
  ds_read_b64_tr_b16 v[162:163], v218 offset:512
  ds_read_b128 v[132:135], v216 offset:2048
  ds_read_b64_tr_b16 v[164:165], v219 offset:0
  ds_read_b64_tr_b16 v[166:167], v219 offset:512
  ds_read_b128 v[136:139], v216 offset:4096
  ds_read_b64_tr_b16 v[168:169], v220 offset:0
  ds_read_b64_tr_b16 v[170:171], v220 offset:512
  ds_read_b128 v[140:143], v216 offset:6144
  ds_read_b64_tr_b16 v[172:173], v221 offset:0
  ds_read_b64_tr_b16 v[174:175], v221 offset:512
  .p2align 6
p1_c_B5_loop:
  s_waitcnt lgkmcnt(0)
  v_mfma_f32_16x16x32_bf16 v[0:3], v[160:163], v[128:131], v[0:3]
  ds_read_b64_tr_b16 v[176:177], v218 offset:1024
  v_mfma_f32_16x16x32_bf16 v[4:7], v[164:167], v[128:131], v[4:7]
  ds_read_b64_tr_b16 v[178:179], v218 offset:1536
  v_mfma_f32_16x16x32_bf16 v[8:11], v[168:171], v[128:131], v[8:11]
  ds_read_b64_tr_b16 v[180:181], v219 offset:1024
  v_mfma_f32_16x16x32_bf16 v[12:15], v[172:175], v[128:131], v[12:15]
  ds_read_b64_tr_b16 v[182:183], v219 offset:1536
  v_mfma_f32_16x16x32_bf16 v[32:35], v[160:163], v[132:135], v[32:35]
  ds_read_b128 v[144:147], v217 offset:0
  v_mfma_f32_16x16x32_bf16 v[36:39], v[164:167], v[132:135], v[36:39]
  ds_read_b64_tr_b16 v[184:185], v220 offset:1024
  v_mfma_f32_16x16x32_bf16 v[40:43], v[168:171], v[132:135], v[40:43]
  ds_read_b64_tr_b16 v[186:187], v220 offset:1536
  v_mfma_f32_16x16x32_bf16 v[44:47], v[172:175], v[132:135], v[44:47]
  ds_read_b64_tr_b16 v[188:189], v221 offset:1024
  v_mfma_f32_16x16x32_bf16 v[64:67], v[160:163], v[136:139], v[64:67]
  ds_read_b64_tr_b16 v[190:191], v221 offset:1536
  v_mfma_f32_16x16x32_bf16 v[68:71], v[164:167], v[136:139], v[68:71]
  ds_read_b128 v[148:151], v217 offset:2048
  v_mfma_f32_16x16x32_bf16 v[72:75], v[168:171], v[136:139], v[72:75]
  v_mfma_f32_16x16x32_bf16 v[76:79], v[172:175], v[136:139], v[76:79]
  v_mfma_f32_16x16x32_bf16 v[96:99], v[160:163], v[140:143], v[96:99]
  v_mfma_f32_16x16x32_bf16 v[100:103], v[164:167], v[140:143], v[100:103]
  v_mfma_f32_16x16x32_bf16 v[104:107], v[168:171], v[140:143], v[104:107]
  s_add_u32 s26, s26, 1
  s_cmp_eq_u32 s26, 3
  v_mfma_f32_16x16x32_bf16 v[108:111], v[172:175], v[140:143], v[108:111]
  s_cselect_b32 s27, s50, s51
  s_cselect_b32 s26, 0, s26
  s_waitcnt lgkmcnt(0)
  v_mfma_f32_16x16x32_bf16 v[16:19], v[176:179], v[128:131], v[16:19]
  ds_read_b64_tr_b16 v[160:161], v218 offset:16384
  v_mfma_f32_16x16x32_bf16 v[20:23], v[180:183], v[128:131], v[20:23]
  ds_read_b64_tr_b16 v[162:163], v218 offset:16896
  v_mfma_f32_16x16x32_bf16 v[24:27], v[184:187], v[128:131], v[24:27]
  ds_read_b64_tr_b16 v[164:165], v219 offset:16384
  v_mfma_f32_16x16x32_bf16 v[28:31], v[188:191], v[128:131], v[28:31]
  ds_read_b64_tr_b16 v[166:167], v219 offset:16896
  v_mfma_f32_16x16x32_bf16 v[48:51], v[176:179], v[132:135], v[48:51]
  ds_read_b128 v[152:155], v217 offset:4096
  v_mfma_f32_16x16x32_bf16 v[52:55], v[180:183], v[132:135], v[52:55]
  ds_read_b64_tr_b16 v[168:169], v220 offset:16384
  v_mfma_f32_16x16x32_bf16 v[56:59], v[184:187], v[132:135], v[56:59]
  ds_read_b64_tr_b16 v[170:171], v220 offset:16896
  v_mfma_f32_16x16x32_bf16 v[60:63], v[188:191], v[132:135], v[60:63]
  ds_read_b64_tr_b16 v[172:173], v221 offset:16384
  v_mfma_f32_16x16x32_bf16 v[80:83], v[176:179], v[136:139], v[80:83]
  ds_read_b64_tr_b16 v[174:175], v221 offset:16896
  v_mfma_f32_16x16x32_bf16 v[84:87], v[180:183], v[136:139], v[84:87]
  ds_read_b128 v[156:159], v217 offset:6144
  v_mfma_f32_16x16x32_bf16 v[88:91], v[184:187], v[136:139], v[88:91]
  v_mfma_f32_16x16x32_bf16 v[92:95], v[188:191], v[136:139], v[92:95]
  v_mfma_f32_16x16x32_bf16 v[112:115], v[176:179], v[140:143], v[112:115]
  v_mfma_f32_16x16x32_bf16 v[116:119], v[180:183], v[140:143], v[116:119]
  v_mfma_f32_16x16x32_bf16 v[120:123], v[184:187], v[140:143], v[120:123]
  v_mfma_f32_16x16x32_bf16 v[124:127], v[188:191], v[140:143], v[124:127]
  s_waitcnt lgkmcnt(0)
  v_mfma_f32_16x16x32_bf16 v[0:3], v[160:163], v[144:147], v[0:3]
  ds_read_b64_tr_b16 v[176:177], v218 offset:17408
  v_mfma_f32_16x16x32_bf16 v[4:7], v[164:167], v[144:147], v[4:7]
  ds_read_b64_tr_b16 v[178:179], v218 offset:17920
  v_mfma_f32_16x16x32_bf16 v[8:11], v[168:171], v[144:147], v[8:11]
  ds_read_b64_tr_b16 v[180:181], v219 offset:17408
  v_mfma_f32_16x16x32_bf16 v[12:15], v[172:175], v[144:147], v[12:15]
  ds_read_b64_tr_b16 v[182:183], v219 offset:17920
  v_mfma_f32_16x16x32_bf16 v[32:35], v[160:163], v[148:151], v[32:35]
  ds_read_b64_tr_b16 v[184:185], v220 offset:17408
  v_mfma_f32_16x16x32_bf16 v[36:39], v[164:167], v[148:151], v[36:39]
  ds_read_b64_tr_b16 v[186:187], v220 offset:17920
  v_mfma_f32_16x16x32_bf16 v[40:43], v[168:171], v[148:151], v[40:43]
  ds_read_b64_tr_b16 v[188:189], v221 offset:17408
  v_mfma_f32_16x16x32_bf16 v[44:47], v[172:175], v[148:151], v[44:47]
  ds_read_b64_tr_b16 v[190:191], v221 offset:17920
  v_mfma_f32_16x16x32_bf16 v[64:67], v[160:163], v[152:155], v[64:67]
  ds_read_b64_tr_b16 v[192:193], v222 offset:0
  v_mfma_f32_16x16x32_bf16 v[68:71], v[164:167], v[152:155], v[68:71]
  ds_read_b64_tr_b16 v[194:195], v222 offset:256
  v_mfma_f32_16x16x32_bf16 v[72:75], v[168:171], v[152:155], v[72:75]
  ds_read_b64_tr_b16 v[196:197], v222 offset:32
  v_mfma_f32_16x16x32_bf16 v[76:79], v[172:175], v[152:155], v[76:79]
  ds_read_b64_tr_b16 v[198:199], v222 offset:288
  v_mfma_f32_16x16x32_bf16 v[96:99], v[160:163], v[156:159], v[96:99]
  v_mfma_f32_16x16x32_bf16 v[100:103], v[164:167], v[156:159], v[100:103]
  v_mfma_f32_16x16x32_bf16 v[104:107], v[168:171], v[156:159], v[104:107]
  v_mfma_f32_16x16x32_bf16 v[108:111], v[172:175], v[156:159], v[108:111]
  s_waitcnt lgkmcnt(0)
  s_barrier
  v_mfma_f32_16x16x32_bf16 v[16:19], v[176:179], v[144:147], v[16:19]
  v_add_u32 v216, s27, v216
  v_add_u32 v218, s27, v218
  v_mfma_f32_16x16x32_bf16 v[20:23], v[180:183], v[144:147], v[20:23]
  ds_read_b128 v[128:131], v216 offset:0
  ds_read_b64_tr_b16 v[160:161], v218 offset:0
  v_mfma_f32_16x16x32_bf16 v[24:27], v[184:187], v[144:147], v[24:27]
  ds_read_b64_tr_b16 v[162:163], v218 offset:512
  v_add_u32 v219, s27, v219
  v_mfma_f32_16x16x32_bf16 v[28:31], v[188:191], v[144:147], v[28:31]
  ds_read_b128 v[132:135], v216 offset:2048
  ds_read_b64_tr_b16 v[164:165], v219 offset:0
  v_mfma_f32_16x16x32_bf16 v[48:51], v[176:179], v[148:151], v[48:51]
  ds_read_b64_tr_b16 v[166:167], v219 offset:512
  v_add_u32 v220, s27, v220
  v_mfma_f32_16x16x32_bf16 v[52:55], v[180:183], v[148:151], v[52:55]
  ds_read_b128 v[136:139], v216 offset:4096
  ds_read_b64_tr_b16 v[168:169], v220 offset:0
  v_mfma_f32_16x16x32_bf16 v[56:59], v[184:187], v[148:151], v[56:59]
  ds_read_b64_tr_b16 v[170:171], v220 offset:512
  v_add_u32 v221, s27, v221
  v_mfma_f32_16x16x32_bf16 v[60:63], v[188:191], v[148:151], v[60:63]
  ds_read_b128 v[140:143], v216 offset:6144
  ds_read_b64_tr_b16 v[172:173], v221 offset:0
  v_mfma_f32_16x16x32_bf16 v[80:83], v[176:179], v[152:155], v[80:83]
  ds_read_b64_tr_b16 v[174:175], v221 offset:512
  v_mfma_f32_16x16x32_bf16 v[84:87], v[180:183], v[152:155], v[84:87]
  v_add_u32 v217, s27, v217
  v_mfma_f32_16x16x32_bf16 v[200:203], v[192:195], v[152:155], v[200:203]
  v_add_u32 v222, s27, v222
  v_mfma_f32_16x16x32_bf16 v[88:91], v[184:187], v[152:155], v[88:91]
  s_sub_u32 s28, s28, 1
  v_mfma_f32_16x16x32_bf16 v[204:207], v[196:199], v[152:155], v[204:207]
  s_cmp_lg_u32 s28, 0
  v_mfma_f32_16x16x32_bf16 v[92:95], v[188:191], v[152:155], v[92:95]
  v_mfma_f32_16x16x32_bf16 v[208:211], v[192:195], v[156:159], v[208:211]
  v_mfma_f32_16x16x32_bf16 v[112:115], v[176:179], v[156:159], v[112:115]
  v_mfma_f32_16x16x32_bf16 v[212:215], v[196:199], v[156:159], v[212:215]
  v_mfma_f32_16x16x32_bf16 v[116:119], v[180:183], v[156:159], v[116:119]
  v_mfma_f32_16x16x32_bf16 v[120:123], v[184:187], v[156:159], v[120:123]
  v_mfma_f32_16x16x32_bf16 v[124:127], v[188:191], v[156:159], v[124:127]
  s_cbranch_scc1 p1_c_B5_loop
  s_waitcnt lgkmcnt(0)
  v_mfma_f32_16x16x32_bf16 v[0:3], v[160:163], v[128:131], v[0:3]
  ds_read_b128 v[144:147], v217 offset:0
  v_mfma_f32_16x16x32_bf16 v[4:7], v[164:167], v[128:131], v[4:7]
  ds_read_b64_tr_b16 v[176:177], v218 offset:16384
  v_mfma_f32_16x16x32_bf16 v[8:11], v[168:171], v[128:131], v[8:11]
  ds_read_b64_tr_b16 v[178:179], v218 offset:16896
  v_mfma_f32_16x16x32_bf16 v[12:15], v[172:175], v[128:131], v[12:15]
  ds_read_b128 v[148:151], v217 offset:2048
  v_mfma_f32_16x16x32_bf16 v[32:35], v[160:163], v[132:135], v[32:35]
  ds_read_b64_tr_b16 v[180:181], v219 offset:16384
  v_mfma_f32_16x16x32_bf16 v[36:39], v[164:167], v[132:135], v[36:39]
  ds_read_b64_tr_b16 v[182:183], v219 offset:16896
  v_mfma_f32_16x16x32_bf16 v[40:43], v[168:171], v[132:135], v[40:43]
  ds_read_b128 v[152:155], v217 offset:4096
  v_mfma_f32_16x16x32_bf16 v[44:47], v[172:175], v[132:135], v[44:47]
  ds_read_b64_tr_b16 v[184:185], v220 offset:16384
  v_mfma_f32_16x16x32_bf16 v[64:67], v[160:163], v[136:139], v[64:67]
  ds_read_b64_tr_b16 v[186:187], v220 offset:16896
  v_mfma_f32_16x16x32_bf16 v[68:71], v[164:167], v[136:139], v[68:71]
  ds_read_b128 v[156:159], v217 offset:6144
  v_add_u32 v236, 0xfffe6000, v222
  v_mfma_f32_16x16x32_bf16 v[72:75], v[168:171], v[136:139], v[72:75]
  ds_read_b64_tr_b16 v[188:189], v221 offset:16384
  v_add_u32 v235, 0xfffe6000, v221
  v_mfma_f32_16x16x32_bf16 v[76:79], v[172:175], v[136:139], v[76:79]
  ds_read_b64_tr_b16 v[190:191], v221 offset:16896
  v_add_u32 v234, 0xfffe6000, v220
  v_mfma_f32_16x16x32_bf16 v[96:99], v[160:163], v[140:143], v[96:99]
  v_add_u32 v233, 0xfffe6000, v219
  v_mfma_f32_16x16x32_bf16 v[100:103], v[164:167], v[140:143], v[100:103]
  v_add_u32 v232, 0xfffe6000, v218
  v_mfma_f32_16x16x32_bf16 v[104:107], v[168:171], v[140:143], v[104:107]
  v_add_u32 v231, 0xfffe6000, v217
  v_mfma_f32_16x16x32_bf16 v[108:111], v[172:175], v[140:143], v[108:111]
  v_add_u32 v230, 0xfffe6000, v216
  s_waitcnt lgkmcnt(0)
  s_barrier
  v_mfma_f32_16x16x32_bf16 v[0:3], v[176:179], v[144:147], v[0:3]
  ds_read_b128 v[128:131], v230 offset:0
  v_mfma_f32_16x16x32_bf16 v[4:7], v[180:183], v[144:147], v[4:7]
  ds_read_b64_tr_b16 v[160:161], v232 offset:0
  v_mfma_f32_16x16x32_bf16 v[8:11], v[184:187], v[144:147], v[8:11]
  ds_read_b64_tr_b16 v[162:163], v232 offset:512
  v_mfma_f32_16x16x32_bf16 v[12:15], v[188:191], v[144:147], v[12:15]
  ds_read_b128 v[132:135], v230 offset:2048
  v_mfma_f32_16x16x32_bf16 v[32:35], v[176:179], v[148:151], v[32:35]
  ds_read_b64_tr_b16 v[164:165], v233 offset:0
  v_mfma_f32_16x16x32_bf16 v[36:39], v[180:183], v[148:151], v[36:39]
  ds_read_b64_tr_b16 v[166:167], v233 offset:512
  v_mfma_f32_16x16x32_bf16 v[40:43], v[184:187], v[148:151], v[40:43]
  ds_read_b128 v[136:139], v230 offset:4096
  v_mfma_f32_16x16x32_bf16 v[44:47], v[188:191], v[148:151], v[44:47]
  ds_read_b64_tr_b16 v[168:169], v234 offset:0
  v_mfma_f32_16x16x32_bf16 v[64:67], v[176:179], v[152:155], v[64:67]
  ds_read_b64_tr_b16 v[170:171], v234 offset:512
  v_mfma_f32_16x16x32_bf16 v[68:71], v[180:183], v[152:155], v[68:71]
  ds_read_b128 v[140:143], v230 offset:6144
  v_mfma_f32_16x16x32_bf16 v[72:75], v[184:187], v[152:155], v[72:75]
  ds_read_b64_tr_b16 v[172:173], v235 offset:0
  v_mfma_f32_16x16x32_bf16 v[76:79], v[188:191], v[152:155], v[76:79]
  ds_read_b64_tr_b16 v[174:175], v235 offset:512
  v_mfma_f32_16x16x32_bf16 v[96:99], v[176:179], v[156:159], v[96:99]
  v_mfma_f32_16x16x32_bf16 v[100:103], v[180:183], v[156:159], v[100:103]
  v_mfma_f32_16x16x32_bf16 v[104:107], v[184:187], v[156:159], v[104:107]
  v_mfma_f32_16x16x32_bf16 v[108:111], v[188:191], v[156:159], v[108:111]
  s_waitcnt lgkmcnt(0)
  v_mfma_f32_16x16x32_bf16 v[0:3], v[160:163], v[128:131], v[0:3]
  ds_read_b128 v[144:147], v231 offset:0
  v_mfma_f32_16x16x32_bf16 v[4:7], v[164:167], v[128:131], v[4:7]
  ds_read_b64_tr_b16 v[176:177], v232 offset:16384
  v_mfma_f32_16x16x32_bf16 v[8:11], v[168:171], v[128:131], v[8:11]
  ds_read_b64_tr_b16 v[178:179], v232 offset:16896
  v_mfma_f32_16x16x32_bf16 v[12:15], v[172:175], v[128:131], v[12:15]
  ds_read_b128 v[148:151], v231 offset:2048
  v_mfma_f32_16x16x32_bf16 v[32:35], v[160:163], v[132:135], v[32:35]
  ds_read_b64_tr_b16 v[180:181], v233 offset:16384
  v_mfma_f32_16x16x32_bf16 v[36:39], v[164:167], v[132:135], v[36:39]
  ds_read_b64_tr_b16 v[182:183], v233 offset:16896
  v_mfma_f32_16x16x32_bf16 v[40:43], v[168:171], v[132:135], v[40:43]
  ds_read_b128 v[152:155], v231 offset:4096
  v_mfma_f32_16x16x32_bf16 v[44:47], v[172:175], v[132:135], v[44:47]
  ds_read_b64_tr_b16 v[184:185], v234 offset:16384
  v_mfma_f32_16x16x32_bf16 v[64:67], v[160:163], v[136:139], v[64:67]
  ds_read_b64_tr_b16 v[186:187], v234 offset:16896
  v_mfma_f32_16x16x32_bf16 v[68:71], v[164:167], v[136:139], v[68:71]
  ds_read_b128 v[156:159], v231 offset:6144
  v_mfma_f32_16x16x32_bf16 v[72:75], v[168:171], v[136:139], v[72:75]
  ds_read_b64_tr_b16 v[188:189], v235 offset:16384
  v_mfma_f32_16x16x32_bf16 v[76:79], v[172:175], v[136:139], v[76:79]
  ds_read_b64_tr_b16 v[190:191], v235 offset:16896
  v_mfma_f32_16x16x32_bf16 v[96:99], v[160:163], v[140:143], v[96:99]
  v_mfma_f32_16x16x32_bf16 v[100:103], v[164:167], v[140:143], v[100:103]
  v_mfma_f32_16x16x32_bf16 v[104:107], v[168:171], v[140:143], v[104:107]
  v_mfma_f32_16x16x32_bf16 v[108:111], v[172:175], v[140:143], v[108:111]
  s_waitcnt lgkmcnt(0)
  v_mfma_f32_16x16x32_bf16 v[0:3], v[176:179], v[144:147], v[0:3]
  ds_read_b64_tr_b16 v[160:161], v232 offset:1024
  v_mfma_f32_16x16x32_bf16 v[4:7], v[180:183], v[144:147], v[4:7]
  ds_read_b64_tr_b16 v[162:163], v232 offset:1536
  v_mfma_f32_16x16x32_bf16 v[8:11], v[184:187], v[144:147], v[8:11]
  ds_read_b64_tr_b16 v[164:165], v233 offset:1024
  v_mfma_f32_16x16x32_bf16 v[12:15], v[188:191], v[144:147], v[12:15]
  ds_read_b64_tr_b16 v[166:167], v233 offset:1536
  v_mfma_f32_16x16x32_bf16 v[32:35], v[176:179], v[148:151], v[32:35]
  ds_read_b64_tr_b16 v[168:169], v234 offset:1024
  v_mfma_f32_16x16x32_bf16 v[36:39], v[180:183], v[148:151], v[36:39]
  ds_read_b64_tr_b16 v[170:171], v234 offset:1536
  v_mfma_f32_16x16x32_bf16 v[40:43], v[184:187], v[148:151], v[40:43]
  ds_read_b64_tr_b16 v[172:173], v235 offset:1024
  v_mfma_f32_16x16x32_bf16 v[44:47], v[188:191], v[148:151], v[44:47]
  ds_read_b64_tr_b16 v[174:175], v235 offset:1536
  v_mfma_f32_16x16x32_bf16 v[64:67], v[176:179], v[152:155], v[64:67]
  v_mfma_f32_16x16x32_bf16 v[68:71], v[180:183], v[152:155], v[68:71]
  v_mfma_f32_16x16x32_bf16 v[72:75], v[184:187], v[152:155], v[72:75]
  v_mfma_f32_16x16x32_bf16 v[76:79], v[188:191], v[152:155], v[76:79]
  v_mfma_f32_16x16x32_bf16 v[96:99], v[176:179], v[156:159], v[96:99]
  v_mfma_f32_16x16x32_bf16 v[100:103], v[180:183], v[156:159], v[100:103]
  v_mfma_f32_16x16x32_bf16 v[104:107], v[184:187], v[156:159], v[104:107]
  v_mfma_f32_16x16x32_bf16 v[108:111], v[188:191], v[156:159], v[108:111]
  s_waitcnt lgkmcnt(0)
  v_mfma_f32_16x16x32_bf16 v[16:19], v[160:163], v[128:131], v[16:19]
  ds_read_b64_tr_b16 v[176:177], v232 offset:17408
  v_mfma_f32_16x16x32_bf16 v[20:23], v[164:167], v[128:131], v[20:23]
  ds_read_b64_tr_b16 v[178:179], v232 offset:17920
  v_mfma_f32_16x16x32_bf16 v[24:27], v[168:171], v[128:131], v[24:27]
  ds_read_b64_tr_b16 v[180:181], v233 offset:17408
  v_mfma_f32_16x16x32_bf16 v[28:31], v[172:175], v[128:131], v[28:31]
  ds_read_b64_tr_b16 v[182:183], v233 offset:17920
  v_mfma_f32_16x16x32_bf16 v[48:51], v[160:163], v[132:135], v[48:51]
  ds_read_b64_tr_b16 v[184:185], v234 offset:17408
  v_cvt_pk_bf16_f32 v0, v0, v1
  v_mfma_f32_16x16x32_bf16 v[52:55], v[164:167], v[132:135], v[52:55]
  ds_read_b64_tr_b16 v[186:187], v234 offset:17920
  v_cvt_pk_bf16_f32 v1, v2, v3
  v_mfma_f32_16x16x32_bf16 v[56:59], v[168:171], v[132:135], v[56:59]
  ds_read_b64_tr_b16 v[188:189], v235 offset:17408
  v_cvt_pk_bf16_f32 v2, v4, v5
  v_mfma_f32_16x16x32_bf16 v[60:63], v[172:175], v[132:135], v[60:63]
  ds_read_b64_tr_b16 v[190:191], v235 offset:17920
  v_cvt_pk_bf16_f32 v3, v6, v7
  v_mfma_f32_16x16x32_bf16 v[80:83], v[160:163], v[136:139], v[80:83]
  ds_read_b64_tr_b16 v[192:193], v236 offset:0
  s_mul_i32 s7, s31, 0
  v_mfma_f32_16x16x32_bf16 v[84:87], v[164:167], v[136:139], v[84:87]
  ds_read_b64_tr_b16 v[194:195], v236 offset:256
  s_add_u32 s7, s7, s30
  v_mfma_f32_16x16x32_bf16 v[88:91], v[168:171], v[136:139], v[88:91]
  ds_read_b64_tr_b16 v[196:197], v236 offset:32
  buffer_store_dwordx4 v[0:3], v224, s[20:23], s7 offen sc1
  v_mfma_f32_16x16x32_bf16 v[92:95], v[172:175], v[136:139], v[92:95]
  ds_read_b64_tr_b16 v[198:199], v236 offset:288
  v_cvt_pk_bf16_f32 v32, v32, v33
  v_mfma_f32_16x16x32_bf16 v[112:115], v[160:163], v[140:143], v[112:115]
  v_cvt_pk_bf16_f32 v33, v34, v35
  v_mfma_f32_16x16x32_bf16 v[116:119], v[164:167], v[140:143], v[116:119]
  v_cvt_pk_bf16_f32 v34, v36, v37
  v_mfma_f32_16x16x32_bf16 v[120:123], v[168:171], v[140:143], v[120:123]
  v_cvt_pk_bf16_f32 v35, v38, v39
  v_mfma_f32_16x16x32_bf16 v[124:127], v[172:175], v[140:143], v[124:127]
  buffer_store_dwordx4 v[32:35], v224, s[20:23], s7 offen offset:256 sc1
  s_waitcnt lgkmcnt(0)
  v_mfma_f32_16x16x32_bf16 v[16:19], v[176:179], v[144:147], v[16:19]
  ds_read_b128 v[128:131], v216 offset:0
  v_cvt_pk_bf16_f32 v8, v8, v9
  v_mfma_f32_16x16x32_bf16 v[20:23], v[180:183], v[144:147], v[20:23]
  ds_read_b64_tr_b16 v[160:161], v218 offset:1024
  v_cvt_pk_bf16_f32 v9, v10, v11
  v_mfma_f32_16x16x32_bf16 v[24:27], v[184:187], v[144:147], v[24:27]
  ds_read_b64_tr_b16 v[162:163], v218 offset:1536
  v_cvt_pk_bf16_f32 v10, v12, v13
  v_mfma_f32_16x16x32_bf16 v[28:31], v[188:191], v[144:147], v[28:31]
  ds_read_b128 v[132:135], v216 offset:2048
  v_cvt_pk_bf16_f32 v11, v14, v15
  v_mfma_f32_16x16x32_bf16 v[48:51], v[176:179], v[148:151], v[48:51]
  ds_read_b64_tr_b16 v[164:165], v219 offset:1024
  s_mul_i32 s7, s31, 1
  v_mfma_f32_16x16x32_bf16 v[52:55], v[180:183], v[148:151], v[52:55]
  ds_read_b64_tr_b16 v[166:167], v219 offset:1536
  s_add_u32 s7, s7, s30
  v_mfma_f32_16x16x32_bf16 v[56:59], v[184:187], v[148:151], v[56:59]
  ds_read_b128 v[136:139], v216 offset:4096
  buffer_store_dwordx4 v[8:11], v224, s[20:23], s7 offen sc1
  v_mfma_f32_16x16x32_bf16 v[60:63], v[188:191], v[148:151], v[60:63]
  ds_read_b64_tr_b16 v[168:169], v220 offset:1024
  v_cvt_pk_bf16_f32 v40, v40, v41
  v_mfma_f32_16x16x32_bf16 v[80:83], v[176:179], v[152:155], v[80:83]
  ds_read_b64_tr_b16 v[170:171], v220 offset:1536
  v_cvt_pk_bf16_f32 v41, v42, v43
  v_mfma_f32_16x16x32_bf16 v[84:87], v[180:183], v[152:155], v[84:87]
  ds_read_b128 v[140:143], v216 offset:6144
  v_cvt_pk_bf16_f32 v42, v44, v45
  v_mfma_f32_16x16x32_bf16 v[200:203], v[192:195], v[152:155], v[200:203]
  ds_read_b64_tr_b16 v[172:173], v221 offset:1024
  v_cvt_pk_bf16_f32 v43, v46, v47
  v_mfma_f32_16x16x32_bf16 v[88:91], v[184:187], v[152:155], v[88:91]
  ds_read_b64_tr_b16 v[174:175], v221 offset:1536
  buffer_store_dwordx4 v[40:43], v224, s[20:23], s7 offen offset:256 sc1
  v_mfma_f32_16x16x32_bf16 v[204:207], v[196:199], v[152:155], v[204:207]
  v_cvt_pk_bf16_f32 v64, v64, v65
  v_mfma_f32_16x16x32_bf16 v[92:95], v[188:191], v[152:155], v[92:95]
  v_cvt_pk_bf16_f32 v65, v66, v67
  v_mfma_f32_16x16x32_bf16 v[208:211], v[192:195], v[156:159], v[208:211]
  v_cvt_pk_bf16_f32 v66, v68, v69
  v_mfma_f32_16x16x32_bf16 v[112:115], v[176:179], v[156:159], v[112:115]
  v_cvt_pk_bf16_f32 v67, v70, v71
  v_mfma_f32_16x16x32_bf16 v[212:215], v[196:199], v[156:159], v[212:215]
  s_mul_i32 s7, s31, 0
  v_mfma_f32_16x16x32_bf16 v[116:119], v[180:183], v[156:159], v[116:119]
  s_add_u32 s7, s7, s30
  v_mfma_f32_16x16x32_bf16 v[120:123], v[184:187], v[156:159], v[120:123]
  s_add_u32 s7, s7, s32
  v_mfma_f32_16x16x32_bf16 v[124:127], v[188:191], v[156:159], v[124:127]
  buffer_store_dwordx4 v[64:67], v224, s[20:23], s7 offen sc1
  s_waitcnt lgkmcnt(0)
  v_mfma_f32_16x16x32_bf16 v[16:19], v[160:163], v[128:131], v[16:19]
  ds_read_b128 v[144:147], v217 offset:0
  v_cvt_pk_bf16_f32 v96, v96, v97
  v_mfma_f32_16x16x32_bf16 v[20:23], v[164:167], v[128:131], v[20:23]
  ds_read_b64_tr_b16 v[176:177], v218 offset:17408
  v_cvt_pk_bf16_f32 v97, v98, v99
  v_mfma_f32_16x16x32_bf16 v[24:27], v[168:171], v[128:131], v[24:27]
  ds_read_b64_tr_b16 v[178:179], v218 offset:17920
  v_cvt_pk_bf16_f32 v98, v100, v101
  v_mfma_f32_16x16x32_bf16 v[28:31], v[172:175], v[128:131], v[28:31]
  ds_read_b128 v[148:151], v217 offset:2048
  v_cvt_pk_bf16_f32 v99, v102, v103
  v_mfma_f32_16x16x32_bf16 v[48:51], v[160:163], v[132:135], v[48:51]
  ds_read_b64_tr_b16 v[180:181], v219 offset:17408
  buffer_store_dwordx4 v[96:99], v224, s[20:23], s7 offen offset:256 sc1
  v_mfma_f32_16x16x32_bf16 v[52:55], v[164:167], v[132:135], v[52:55]
  ds_read_b64_tr_b16 v[182:183], v219 offset:17920
  v_cvt_pk_bf16_f32 v72, v72, v73
  v_mfma_f32_16x16x32_bf16 v[56:59], v[168:171], v[132:135], v[56:59]
  ds_read_b128 v[152:155], v217 offset:4096
  v_cvt_pk_bf16_f32 v73, v74, v75
  v_mfma_f32_16x16x32_bf16 v[60:63], v[172:175], v[132:135], v[60:63]
  ds_read_b64_tr_b16 v[184:185], v220 offset:17408
  v_cvt_pk_bf16_f32 v74, v76, v77
  v_mfma_f32_16x16x32_bf16 v[80:83], v[160:163], v[136:139], v[80:83]
  ds_read_b64_tr_b16 v[186:187], v220 offset:17920
  v_cvt_pk_bf16_f32 v75, v78, v79
  v_mfma_f32_16x16x32_bf16 v[84:87], v[164:167], v[136:139], v[84:87]
  ds_read_b128 v[156:159], v217 offset:6144
  s_mul_i32 s7, s31, 1
  v_mfma_f32_16x16x32_bf16 v[88:91], v[168:171], v[136:139], v[88:91]
  ds_read_b64_tr_b16 v[188:189], v221 offset:17408
  s_add_u32 s7, s7, s30
  v_mfma_f32_16x16x32_bf16 v[92:95], v[172:175], v[136:139], v[92:95]
  ds_read_b64_tr_b16 v[190:191], v221 offset:17920
  s_add_u32 s7, s7, s32
  v_mfma_f32_16x16x32_bf16 v[112:115], v[160:163], v[140:143], v[112:115]
  ds_read_b64_tr_b16 v[192:193], v222 offset:0
  buffer_store_dwordx4 v[72:75], v224, s[20:23], s7 offen sc1
  v_mfma_f32_16x16x32_bf16 v[116:119], v[164:167], v[140:143], v[116:119]
  ds_read_b64_tr_b16 v[194:195], v222 offset:256
  v_cvt_pk_bf16_f32 v104, v104, v105
  v_mfma_f32_16x16x32_bf16 v[120:123], v[168:171], v[140:143], v[120:123]
  ds_read_b64_tr_b16 v[196:197], v222 offset:32
  v_cvt_pk_bf16_f32 v105, v106, v107
  v_mfma_f32_16x16x32_bf16 v[124:127], v[172:175], v[140:143], v[124:127]
  ds_read_b64_tr_b16 v[198:199], v222 offset:288
  v_cvt_pk_bf16_f32 v106, v108, v109
  s_waitcnt lgkmcnt(0)
  v_mfma_f32_16x16x32_bf16 v[16:19], v[176:179], v[144:147], v[16:19]
  v_cvt_pk_bf16_f32 v107, v110, v111
  v_mfma_f32_16x16x32_bf16 v[20:23], v[180:183], v[144:147], v[20:23]
  buffer_store_dwordx4 v[104:107], v224, s[20:23], s7 offen offset:256 sc1
  v_mfma_f32_16x16x32_bf16 v[24:27], v[184:187], v[144:147], v[24:27]
  v_mfma_f32_16x16x32_bf16 v[28:31], v[188:191], v[144:147], v[28:31]
  v_mfma_f32_16x16x32_bf16 v[48:51], v[176:179], v[148:151], v[48:51]
  v_mfma_f32_16x16x32_bf16 v[52:55], v[180:183], v[148:151], v[52:55]
  v_mfma_f32_16x16x32_bf16 v[56:59], v[184:187], v[148:151], v[56:59]
  v_mfma_f32_16x16x32_bf16 v[60:63], v[188:191], v[148:151], v[60:63]
  v_mfma_f32_16x16x32_bf16 v[80:83], v[176:179], v[152:155], v[80:83]
  v_mfma_f32_16x16x32_bf16 v[84:87], v[180:183], v[152:155], v[84:87]
  v_mfma_f32_16x16x32_bf16 v[200:203], v[192:195], v[152:155], v[200:203]
  v_mfma_f32_16x16x32_bf16 v[88:91], v[184:187], v[152:155], v[88:91]
  v_mfma_f32_16x16x32_bf16 v[204:207], v[196:199], v[152:155], v[204:207]
  v_mfma_f32_16x16x32_bf16 v[92:95], v[188:191], v[152:155], v[92:95]
  v_mfma_f32_16x16x32_bf16 v[208:211], v[192:195], v[156:159], v[208:211]
  v_mfma_f32_16x16x32_bf16 v[112:115], v[176:179], v[156:159], v[112:115]
  v_mfma_f32_16x16x32_bf16 v[212:215], v[196:199], v[156:159], v[212:215]
  v_mfma_f32_16x16x32_bf16 v[116:119], v[180:183], v[156:159], v[116:119]
  v_mfma_f32_16x16x32_bf16 v[120:123], v[184:187], v[156:159], v[120:123]
  v_mfma_f32_16x16x32_bf16 v[124:127], v[188:191], v[156:159], v[124:127]
  s_nop 7
  s_lshl_b32 s7, s24, 12
  s_add_u32 s7, s7, 53248
  v_add_u32 v226, s7, v223
  ds_write_b128 v226, v[200:203] offset:0
  ds_write_b128 v226, v[204:207] offset:1024
  ds_write_b128 v226, v[208:211] offset:2048
  ds_write_b128 v226, v[212:215] offset:3072
  v_cvt_pk_bf16_f32 v16, v16, v17
  v_cvt_pk_bf16_f32 v17, v18, v19
  v_cvt_pk_bf16_f32 v18, v20, v21
  v_cvt_pk_bf16_f32 v19, v22, v23
  s_mul_i32 s7, s31, 2
  s_add_u32 s7, s7, s30
  buffer_store_dwordx4 v[16:19], v224, s[20:23], s7 offen sc1
  v_cvt_pk_bf16_f32 v48, v48, v49
  v_cvt_pk_bf16_f32 v49, v50, v51
  v_cvt_pk_bf16_f32 v50, v52, v53
  v_cvt_pk_bf16_f32 v51, v54, v55
  buffer_store_dwordx4 v[48:51], v224, s[20:23], s7 offen offset:256 sc1
  v_cvt_pk_bf16_f32 v24, v24, v25
  v_cvt_pk_bf16_f32 v25, v26, v27
  v_cvt_pk_bf16_f32 v26, v28, v29
  v_cvt_pk_bf16_f32 v27, v30, v31
  s_mul_i32 s7, s31, 3
  s_add_u32 s7, s7, s30
  buffer_store_dwordx4 v[24:27], v224, s[20:23], s7 offen sc1
  v_cvt_pk_bf16_f32 v56, v56, v57
  v_cvt_pk_bf16_f32 v57, v58, v59
  v_cvt_pk_bf16_f32 v58, v60, v61
  v_cvt_pk_bf16_f32 v59, v62, v63
  buffer_store_dwordx4 v[56:59], v224, s[20:23], s7 offen offset:256 sc1
  v_cvt_pk_bf16_f32 v80, v80, v81
  v_cvt_pk_bf16_f32 v81, v82, v83
  v_cvt_pk_bf16_f32 v82, v84, v85
  v_cvt_pk_bf16_f32 v83, v86, v87
  s_mul_i32 s7, s31, 2
  s_add_u32 s7, s7, s30
  s_add_u32 s7, s7, s32
  buffer_store_dwordx4 v[80:83], v224, s[20:23], s7 offen sc1
  v_cvt_pk_bf16_f32 v112, v112, v113
  v_cvt_pk_bf16_f32 v113, v114, v115
  v_cvt_pk_bf16_f32 v114, v116, v117
  v_cvt_pk_bf16_f32 v115, v118, v119
  buffer_store_dwordx4 v[112:115], v224, s[20:23], s7 offen offset:256 sc1
  v_cvt_pk_bf16_f32 v88, v88, v89
  v_cvt_pk_bf16_f32 v89, v90, v91
  v_cvt_pk_bf16_f32 v90, v92, v93
  v_cvt_pk_bf16_f32 v91, v94, v95
  s_mul_i32 s7, s31, 3
  s_add_u32 s7, s7, s30
  s_add_u32 s7, s7, s32
  buffer_store_dwordx4 v[88:91], v224, s[20:23], s7 offen sc1
  v_cvt_pk_bf16_f32 v120, v120, v121
  v_cvt_pk_bf16_f32 v121, v122, v123
  v_cvt_pk_bf16_f32 v122, v124, v125
  v_cvt_pk_bf16_f32 v123, v126, v127
  buffer_store_dwordx4 v[120:123], v224, s[20:23], s7 offen offset:256 sc1
  s_waitcnt lgkmcnt(0)
  s_barrier
  s_endpgm
p1_c_B6:
  s_lshl_b32 s7, s6, 3
  s_lshl_b32 s33, s25, 2
  s_add_u32 s7, s7, s33
  s_lshl_b32 s33, s5, 2
  s_lshl_b32 s36, s24, 1
  s_add_u32 s33, s33, s36
  s_mov_b32 s31, 131072
  s_mov_b32 s32, 2048
  s_mov_b32 s36, 12582912
  s_mov_b32 s34, 0x3e8293ee
  s_mov_b32 s35, s34
  s_mul_i32 s7, s7, s31
  s_mul_i32 s33, s33, s32
  s_add_u32 s30, s7, s33
  s_add_u32 s30, s30, s36
  s_mov_b32 s28, 14
  s_waitcnt lgkmcnt(0)
  s_barrier
  ds_read_b128 v[128:131], v216 offset:0
  ds_read_b64_tr_b16 v[160:161], v218 offset:0
  ds_read_b64_tr_b16 v[162:163], v218 offset:512
  ds_read_b128 v[132:135], v216 offset:2048
  ds_read_b64_tr_b16 v[164:165], v219 offset:0
  ds_read_b64_tr_b16 v[166:167], v219 offset:512
  ds_read_b128 v[136:139], v216 offset:4096
  ds_read_b64_tr_b16 v[168:169], v220 offset:0
  ds_read_b64_tr_b16 v[170:171], v220 offset:512
  ds_read_b128 v[140:143], v216 offset:6144
  ds_read_b64_tr_b16 v[172:173], v221 offset:0
  ds_read_b64_tr_b16 v[174:175], v221 offset:512
  .p2align 6
p1_c_B6_loop:
  s_waitcnt lgkmcnt(0)
  v_mfma_f32_16x16x32_bf16 v[0:3], v[160:163], v[128:131], v[0:3]
  ds_read_b64_tr_b16 v[176:177], v218 offset:1024
  v_mfma_f32_16x16x32_bf16 v[4:7], v[164:167], v[128:131], v[4:7]
  ds_read_b64_tr_b16 v[178:179], v218 offset:1536
  v_mfma_f32_16x16x32_bf16 v[8:11], v[168:171], v[128:131], v[8:11]
  ds_read_b64_tr_b16 v[180:181], v219 offset:1024
  v_mfma_f32_16x16x32_bf16 v[12:15], v[172:175], v[128:131], v[12:15]
  ds_read_b64_tr_b16 v[182:183], v219 offset:1536
  v_mfma_f32_16x16x32_bf16 v[32:35], v[160:163], v[132:135], v[32:35]
  ds_read_b128 v[144:147], v217 offset:0
  v_mfma_f32_16x16x32_bf16 v[36:39], v[164:167], v[132:135], v[36:39]
  ds_read_b64_tr_b16 v[184:185], v220 offset:1024
  v_mfma_f32_16x16x32_bf16 v[40:43], v[168:171], v[132:135], v[40:43]
  ds_read_b64_tr_b16 v[186:187], v220 offset:1536
  v_mfma_f32_16x16x32_bf16 v[44:47], v[172:175], v[132:135], v[44:47]
  ds_read_b64_tr_b16 v[188:189], v221 offset:1024
  v_mfma_f32_16x16x32_bf16 v[64:67], v[160:163], v[136:139], v[64:67]
  ds_read_b64_tr_b16 v[190:191], v221 offset:1536
  v_mfma_f32_16x16x32_bf16 v[68:71], v[164:167], v[136:139], v[68:71]
  ds_read_b128 v[148:151], v217 offset:2048
  v_mfma_f32_16x16x32_bf16 v[72:75], v[168:171], v[136:139], v[72:75]
  ds_read_b64_tr_b16 v[192:193], v222 offset:0
  v_mfma_f32_16x16x32_bf16 v[76:79], v[172:175], v[136:139], v[76:79]
  ds_read_b64_tr_b16 v[194:195], v222 offset:256
  v_mfma_f32_16x16x32_bf16 v[96:99], v[160:163], v[140:143], v[96:99]
  ds_read_b64_tr_b16 v[196:197], v222 offset:32
  v_mfma_f32_16x16x32_bf16 v[100:103], v[164:167], v[140:143], v[100:103]
  ds_read_b64_tr_b16 v[198:199], v222 offset:288
  v_mfma_f32_16x16x32_bf16 v[104:107], v[168:171], v[140:143], v[104:107]
  s_add_u32 s26, s26, 1
  s_cmp_eq_u32 s26, 3
  v_mfma_f32_16x16x32_bf16 v[108:111], v[172:175], v[140:143], v[108:111]
  s_cselect_b32 s27, s50, s51
  s_cselect_b32 s26, 0, s26
  s_waitcnt lgkmcnt(0)
  v_mfma_f32_16x16x32_bf16 v[16:19], v[176:179], v[128:131], v[16:19]
  ds_read_b64_tr_b16 v[160:161], v218 offset:16384
  v_mfma_f32_16x16x32_bf16 v[20:23], v[180:183], v[128:131], v[20:23]
  ds_read_b64_tr_b16 v[162:163], v218 offset:16896
  v_mfma_f32_16x16x32_bf16 v[24:27], v[184:187], v[128:131], v[24:27]
  ds_read_b64_tr_b16 v[164:165], v219 offset:16384
  v_mfma_f32_16x16x32_bf16 v[28:31], v[188:191], v[128:131], v[28:31]
  ds_read_b64_tr_b16 v[166:167], v219 offset:16896
  v_mfma_f32_16x16x32_bf16 v[48:51], v[176:179], v[132:135], v[48:51]
  ds_read_b128 v[152:155], v217 offset:4096
  v_mfma_f32_16x16x32_bf16 v[52:55], v[180:183], v[132:135], v[52:55]
  ds_read_b64_tr_b16 v[168:169], v220 offset:16384
  v_mfma_f32_16x16x32_bf16 v[56:59], v[184:187], v[132:135], v[56:59]
  ds_read_b64_tr_b16 v[170:171], v220 offset:16896
  v_mfma_f32_16x16x32_bf16 v[60:63], v[188:191], v[132:135], v[60:63]
  ds_read_b64_tr_b16 v[172:173], v221 offset:16384
  v_mfma_f32_16x16x32_bf16 v[80:83], v[176:179], v[136:139], v[80:83]
  ds_read_b64_tr_b16 v[174:175], v221 offset:16896
  v_mfma_f32_16x16x32_bf16 v[84:87], v[180:183], v[136:139], v[84:87]
  ds_read_b128 v[156:159], v217 offset:6144
  v_mfma_f32_16x16x32_bf16 v[200:203], v[136:139], v[192:195], v[200:203]
  v_mfma_f32_16x16x32_bf16 v[88:91], v[184:187], v[136:139], v[88:91]
  v_mfma_f32_16x16x32_bf16 v[208:211], v[136:139], v[196:199], v[208:211]
  v_mfma_f32_16x16x32_bf16 v[92:95], v[188:191], v[136:139], v[92:95]
  v_mfma_f32_16x16x32_bf16 v[204:207], v[140:143], v[192:195], v[204:207]
  v_mfma_f32_16x16x32_bf16 v[112:115], v[176:179], v[140:143], v[112:115]
  v_mfma_f32_16x16x32_bf16 v[212:215], v[140:143], v[196:199], v[212:215]
  v_mfma_f32_16x16x32_bf16 v[116:119], v[180:183], v[140:143], v[116:119]
  v_mfma_f32_16x16x32_bf16 v[120:123], v[184:187], v[140:143], v[120:123]
  v_mfma_f32_16x16x32_bf16 v[124:127], v[188:191], v[140:143], v[124:127]
  s_waitcnt lgkmcnt(0)
  v_mfma_f32_16x16x32_bf16 v[0:3], v[160:163], v[144:147], v[0:3]
  ds_read_b64_tr_b16 v[176:177], v218 offset:17408
  v_mfma_f32_16x16x32_bf16 v[4:7], v[164:167], v[144:147], v[4:7]
  ds_read_b64_tr_b16 v[178:179], v218 offset:17920
  v_mfma_f32_16x16x32_bf16 v[8:11], v[168:171], v[144:147], v[8:11]
  ds_read_b64_tr_b16 v[180:181], v219 offset:17408
  v_mfma_f32_16x16x32_bf16 v[12:15], v[172:175], v[144:147], v[12:15]
  ds_read_b64_tr_b16 v[182:183], v219 offset:17920
  v_mfma_f32_16x16x32_bf16 v[32:35], v[160:163], v[148:151], v[32:35]
  ds_read_b64_tr_b16 v[184:185], v220 offset:17408
  v_mfma_f32_16x16x32_bf16 v[36:39], v[164:167], v[148:151], v[36:39]
  ds_read_b64_tr_b16 v[186:187], v220 offset:17920
  v_mfma_f32_16x16x32_bf16 v[40:43], v[168:171], v[148:151], v[40:43]
  ds_read_b64_tr_b16 v[188:189], v221 offset:17408
  v_mfma_f32_16x16x32_bf16 v[44:47], v[172:175], v[148:151], v[44:47]
  ds_read_b64_tr_b16 v[190:191], v221 offset:17920
  v_mfma_f32_16x16x32_bf16 v[64:67], v[160:163], v[152:155], v[64:67]
  v_mfma_f32_16x16x32_bf16 v[68:71], v[164:167], v[152:155], v[68:71]
  v_mfma_f32_16x16x32_bf16 v[72:75], v[168:171], v[152:155], v[72:75]
  v_mfma_f32_16x16x32_bf16 v[76:79], v[172:175], v[152:155], v[76:79]
  v_mfma_f32_16x16x32_bf16 v[96:99], v[160:163], v[156:159], v[96:99]
  v_mfma_f32_16x16x32_bf16 v[100:103], v[164:167], v[156:159], v[100:103]
  v_mfma_f32_16x16x32_bf16 v[104:107], v[168:171], v[156:159], v[104:107]
  v_mfma_f32_16x16x32_bf16 v[108:111], v[172:175], v[156:159], v[108:111]
  s_waitcnt lgkmcnt(0)
  s_barrier
  v_mfma_f32_16x16x32_bf16 v[16:19], v[176:179], v[144:147], v[16:19]
  v_add_u32 v216, s27, v216
  v_add_u32 v218, s27, v218
  v_mfma_f32_16x16x32_bf16 v[20:23], v[180:183], v[144:147], v[20:23]
  ds_read_b128 v[128:131], v216 offset:0
  ds_read_b64_tr_b16 v[160:161], v218 offset:0
  v_mfma_f32_16x16x32_bf16 v[24:27], v[184:187], v[144:147], v[24:27]
  ds_read_b64_tr_b16 v[162:163], v218 offset:512
  v_add_u32 v219, s27, v219
  v_mfma_f32_16x16x32_bf16 v[28:31], v[188:191], v[144:147], v[28:31]
  ds_read_b128 v[132:135], v216 offset:2048
  ds_read_b64_tr_b16 v[164:165], v219 offset:0
  v_mfma_f32_16x16x32_bf16 v[48:51], v[176:179], v[148:151], v[48:51]
  ds_read_b64_tr_b16 v[166:167], v219 offset:512
  v_add_u32 v220, s27, v220
  v_mfma_f32_16x16x32_bf16 v[52:55], v[180:183], v[148:151], v[52:55]
  ds_read_b128 v[136:139], v216 offset:4096
  ds_read_b64_tr_b16 v[168:169], v220 offset:0
  v_mfma_f32_16x16x32_bf16 v[56:59], v[184:187], v[148:151], v[56:59]
  ds_read_b64_tr_b16 v[170:171], v220 offset:512
  v_add_u32 v221, s27, v221
  v_mfma_f32_16x16x32_bf16 v[60:63], v[188:191], v[148:151], v[60:63]
  ds_read_b128 v[140:143], v216 offset:6144
  ds_read_b64_tr_b16 v[172:173], v221 offset:0
  v_mfma_f32_16x16x32_bf16 v[80:83], v[176:179], v[152:155], v[80:83]
  ds_read_b64_tr_b16 v[174:175], v221 offset:512
  v_mfma_f32_16x16x32_bf16 v[84:87], v[180:183], v[152:155], v[84:87]
  v_add_u32 v217, s27, v217
  v_mfma_f32_16x16x32_bf16 v[88:91], v[184:187], v[152:155], v[88:91]
  v_add_u32 v222, s27, v222
  v_mfma_f32_16x16x32_bf16 v[92:95], v[188:191], v[152:155], v[92:95]
  s_sub_u32 s28, s28, 1
  v_mfma_f32_16x16x32_bf16 v[112:115], v[176:179], v[156:159], v[112:115]
  s_cmp_lg_u32 s28, 0
  v_mfma_f32_16x16x32_bf16 v[116:119], v[180:183], v[156:159], v[116:119]
  v_mfma_f32_16x16x32_bf16 v[120:123], v[184:187], v[156:159], v[120:123]
  v_mfma_f32_16x16x32_bf16 v[124:127], v[188:191], v[156:159], v[124:127]
  s_cbranch_scc1 p1_c_B6_loop
  s_waitcnt lgkmcnt(0)
  v_mfma_f32_16x16x32_bf16 v[0:3], v[160:163], v[128:131], v[0:3]
  ds_read_b128 v[144:147], v217 offset:0
  v_mfma_f32_16x16x32_bf16 v[4:7], v[164:167], v[128:131], v[4:7]
  ds_read_b64_tr_b16 v[176:177], v218 offset:16384
  v_mfma_f32_16x16x32_bf16 v[8:11], v[168:171], v[128:131], v[8:11]
  ds_read_b64_tr_b16 v[178:179], v218 offset:16896
  v_mfma_f32_16x16x32_bf16 v[12:15], v[172:175], v[128:131], v[12:15]
  ds_read_b128 v[148:151], v217 offset:2048
  v_mfma_f32_16x16x32_bf16 v[32:35], v[160:163], v[132:135], v[32:35]
  ds_read_b64_tr_b16 v[180:181], v219 offset:16384
  v_mfma_f32_16x16x32_bf16 v[36:39], v[164:167], v[132:135], v[36:39]
  ds_read_b64_tr_b16 v[182:183], v219 offset:16896
  v_mfma_f32_16x16x32_bf16 v[40:43], v[168:171], v[132:135], v[40:43]
  ds_read_b128 v[152:155], v217 offset:4096
  v_mfma_f32_16x16x32_bf16 v[44:47], v[172:175], v[132:135], v[44:47]
  ds_read_b64_tr_b16 v[184:185], v220 offset:16384
  v_mfma_f32_16x16x32_bf16 v[64:67], v[160:163], v[136:139], v[64:67]
  ds_read_b64_tr_b16 v[186:187], v220 offset:16896
  v_mfma_f32_16x16x32_bf16 v[68:71], v[164:167], v[136:139], v[68:71]
  ds_read_b128 v[156:159], v217 offset:6144
  v_add_u32 v236, 0xfffe6000, v222
  v_mfma_f32_16x16x32_bf16 v[72:75], v[168:171], v[136:139], v[72:75]
  ds_read_b64_tr_b16 v[188:189], v221 offset:16384
  v_add_u32 v235, 0xfffe6000, v221
  v_mfma_f32_16x16x32_bf16 v[76:79], v[172:175], v[136:139], v[76:79]
  ds_read_b64_tr_b16 v[190:191], v221 offset:16896
  v_add_u32 v234, 0xfffe6000, v220
  v_mfma_f32_16x16x32_bf16 v[96:99], v[160:163], v[140:143], v[96:99]
  v_add_u32 v233, 0xfffe6000, v219
  v_mfma_f32_16x16x32_bf16 v[100:103], v[164:167], v[140:143], v[100:103]
  v_add_u32 v232, 0xfffe6000, v218
  v_mfma_f32_16x16x32_bf16 v[104:107], v[168:171], v[140:143], v[104:107]
  v_add_u32 v231, 0xfffe6000, v217
  v_mfma_f32_16x16x32_bf16 v[108:111], v[172:175], v[140:143], v[108:111]
  v_add_u32 v230, 0xfffe6000, v216
  s_waitcnt lgkmcnt(0)
  s_barrier
  v_mfma_f32_16x16x32_bf16 v[0:3], v[176:179], v[144:147], v[0:3]
  ds_read_b128 v[128:131], v230 offset:0
  v_mfma_f32_16x16x32_bf16 v[4:7], v[180:183], v[144:147], v[4:7]
  ds_read_b64_tr_b16 v[160:161], v232 offset:0
  v_mfma_f32_16x16x32_bf16 v[8:11], v[184:187], v[144:147], v[8:11]
  ds_read_b64_tr_b16 v[162:163], v232 offset:512
  v_mfma_f32_16x16x32_bf16 v[12:15], v[188:191], v[144:147], v[12:15]
  ds_read_b128 v[132:135], v230 offset:2048
  v_mfma_f32_16x16x32_bf16 v[32:35], v[176:179], v[148:151], v[32:35]
  ds_read_b64_tr_b16 v[164:165], v233 offset:0
  v_mfma_f32_16x16x32_bf16 v[36:39], v[180:183], v[148:151], v[36:39]
  ds_read_b64_tr_b16 v[166:167], v233 offset:512
  v_mfma_f32_16x16x32_bf16 v[40:43], v[184:187], v[148:151], v[40:43]
  ds_read_b128 v[136:139], v230 offset:4096
  v_mfma_f32_16x16x32_bf16 v[44:47], v[188:191], v[148:151], v[44:47]
  ds_read_b64_tr_b16 v[168:169], v234 offset:0
  v_mfma_f32_16x16x32_bf16 v[64:67], v[176:179], v[152:155], v[64:67]
  ds_read_b64_tr_b16 v[170:171], v234 offset:512
  v_mfma_f32_16x16x32_bf16 v[68:71], v[180:183], v[152:155], v[68:71]
  ds_read_b128 v[140:143], v230 offset:6144
  v_mfma_f32_16x16x32_bf16 v[72:75], v[184:187], v[152:155], v[72:75]
  ds_read_b64_tr_b16 v[172:173], v235 offset:0
  v_mfma_f32_16x16x32_bf16 v[76:79], v[188:191], v[152:155], v[76:79]
  ds_read_b64_tr_b16 v[174:175], v235 offset:512
  v_mfma_f32_16x16x32_bf16 v[96:99], v[176:179], v[156:159], v[96:99]
  v_mfma_f32_16x16x32_bf16 v[100:103], v[180:183], v[156:159], v[100:103]
  v_mfma_f32_16x16x32_bf16 v[104:107], v[184:187], v[156:159], v[104:107]
  v_mfma_f32_16x16x32_bf16 v[108:111], v[188:191], v[156:159], v[108:111]
  s_waitcnt lgkmcnt(0)
  v_mfma_f32_16x16x32_bf16 v[0:3], v[160:163], v[128:131], v[0:3]
  ds_read_b128 v[144:147], v231 offset:0
  v_mfma_f32_16x16x32_bf16 v[4:7], v[164:167], v[128:131], v[4:7]
  ds_read_b64_tr_b16 v[176:177], v232 offset:16384
  v_mfma_f32_16x16x32_bf16 v[8:11], v[168:171], v[128:131], v[8:11]
  ds_read_b64_tr_b16 v[178:179], v232 offset:16896
  v_mfma_f32_16x16x32_bf16 v[12:15], v[172:175], v[128:131], v[12:15]
  ds_read_b128 v[148:151], v231 offset:2048
  v_mfma_f32_16x16x32_bf16 v[32:35], v[160:163], v[132:135], v[32:35]
  ds_read_b64_tr_b16 v[180:181], v233 offset:16384
  v_mfma_f32_16x16x32_bf16 v[36:39], v[164:167], v[132:135], v[36:39]
  ds_read_b64_tr_b16 v[182:183], v233 offset:16896
  v_mfma_f32_16x16x32_bf16 v[40:43], v[168:171], v[132:135], v[40:43]
  ds_read_b128 v[152:155], v231 offset:4096
  v_mfma_f32_16x16x32_bf16 v[44:47], v[172:175], v[132:135], v[44:47]
  ds_read_b64_tr_b16 v[184:185], v234 offset:16384
  v_mfma_f32_16x16x32_bf16 v[64:67], v[160:163], v[136:139], v[64:67]
  ds_read_b64_tr_b16 v[186:187], v234 offset:16896
  v_mfma_f32_16x16x32_bf16 v[68:71], v[164:167], v[136:139], v[68:71]
  ds_read_b128 v[156:159], v231 offset:6144
  v_mfma_f32_16x16x32_bf16 v[72:75], v[168:171], v[136:139], v[72:75]
  ds_read_b64_tr_b16 v[188:189], v235 offset:16384
  v_mfma_f32_16x16x32_bf16 v[76:79], v[172:175], v[136:139], v[76:79]
  ds_read_b64_tr_b16 v[190:191], v235 offset:16896
  v_mfma_f32_16x16x32_bf16 v[96:99], v[160:163], v[140:143], v[96:99]
  v_mfma_f32_16x16x32_bf16 v[100:103], v[164:167], v[140:143], v[100:103]
  v_mfma_f32_16x16x32_bf16 v[104:107], v[168:171], v[140:143], v[104:107]
  v_mfma_f32_16x16x32_bf16 v[108:111], v[172:175], v[140:143], v[108:111]
  s_waitcnt lgkmcnt(0)
  v_mfma_f32_16x16x32_bf16 v[0:3], v[176:179], v[144:147], v[0:3]
  ds_read_b64_tr_b16 v[160:161], v232 offset:1024
  v_mfma_f32_16x16x32_bf16 v[4:7], v[180:183], v[144:147], v[4:7]
  ds_read_b64_tr_b16 v[162:163], v232 offset:1536
  v_mfma_f32_16x16x32_bf16 v[8:11], v[184:187], v[144:147], v[8:11]
  ds_read_b64_tr_b16 v[164:165], v233 offset:1024
  v_mfma_f32_16x16x32_bf16 v[12:15], v[188:191], v[144:147], v[12:15]
  ds_read_b64_tr_b16 v[166:167], v233 offset:1536
  v_mfma_f32_16x16x32_bf16 v[32:35], v[176:179], v[148:151], v[32:35]
  ds_read_b64_tr_b16 v[168:169], v234 offset:1024
  v_mfma_f32_16x16x32_bf16 v[36:39], v[180:183], v[148:151], v[36:39]
  ds_read_b64_tr_b16 v[170:171], v234 offset:1536
  v_mfma_f32_16x16x32_bf16 v[40:43], v[184:187], v[148:151], v[40:43]
  ds_read_b64_tr_b16 v[172:173], v235 offset:1024
  v_mfma_f32_16x16x32_bf16 v[44:47], v[188:191], v[148:151], v[44:47]
  ds_read_b64_tr_b16 v[174:175], v235 offset:1536
  v_mfma_f32_16x16x32_bf16 v[64:67], v[176:179], v[152:155], v[64:67]
  ds_read_b64_tr_b16 v[192:193], v236 offset:0
  v_mfma_f32_16x16x32_bf16 v[68:71], v[180:183], v[152:155], v[68:71]
  ds_read_b64_tr_b16 v[194:195], v236 offset:256
  v_mfma_f32_16x16x32_bf16 v[72:75], v[184:187], v[152:155], v[72:75]
  ds_read_b64_tr_b16 v[196:197], v236 offset:32
  v_mfma_f32_16x16x32_bf16 v[76:79], v[188:191], v[152:155], v[76:79]
  ds_read_b64_tr_b16 v[198:199], v236 offset:288
  v_mfma_f32_16x16x32_bf16 v[96:99], v[176:179], v[156:159], v[96:99]
  v_mfma_f32_16x16x32_bf16 v[100:103], v[180:183], v[156:159], v[100:103]
  v_mfma_f32_16x16x32_bf16 v[104:107], v[184:187], v[156:159], v[104:107]
  v_mfma_f32_16x16x32_bf16 v[108:111], v[188:191], v[156:159], v[108:111]
  s_waitcnt lgkmcnt(0)
  v_mfma_f32_16x16x32_bf16 v[16:19], v[160:163], v[128:131], v[16:19]
  ds_read_b64_tr_b16 v[176:177], v232 offset:17408
  v_mfma_f32_16x16x32_bf16 v[20:23], v[164:167], v[128:131], v[20:23]
  ds_read_b64_tr_b16 v[178:179], v232 offset:17920
  v_mfma_f32_16x16x32_bf16 v[24:27], v[168:171], v[128:131], v[24:27]
  ds_read_b64_tr_b16 v[180:181], v233 offset:17408
  v_mfma_f32_16x16x32_bf16 v[28:31], v[172:175], v[128:131], v[28:31]
  ds_read_b64_tr_b16 v[182:183], v233 offset:17920
  v_mfma_f32_16x16x32_bf16 v[48:51], v[160:163], v[132:135], v[48:51]
  ds_read_b64_tr_b16 v[184:185], v234 offset:17408
  v_cvt_pk_bf16_f32 v0, v0, v1
  v_mfma_f32_16x16x32_bf16 v[52:55], v[164:167], v[132:135], v[52:55]
  ds_read_b64_tr_b16 v[186:187], v234 offset:17920
  v_cvt_pk_bf16_f32 v1, v2, v3
  v_mfma_f32_16x16x32_bf16 v[56:59], v[168:171], v[132:135], v[56:59]
  ds_read_b64_tr_b16 v[188:189], v235 offset:17408
  v_cvt_pk_bf16_f32 v2, v4, v5
  v_mfma_f32_16x16x32_bf16 v[60:63], v[172:175], v[132:135], v[60:63]
  ds_read_b64_tr_b16 v[190:191], v235 offset:17920
  v_cvt_pk_bf16_f32 v3, v6, v7
  v_mfma_f32_16x16x32_bf16 v[80:83], v[160:163], v[136:139], v[80:83]
  s_mul_i32 s7, s31, 0
  v_mfma_f32_16x16x32_bf16 v[84:87], v[164:167], v[136:139], v[84:87]
  s_add_u32 s7, s7, s30
  v_mfma_f32_16x16x32_bf16 v[200:203], v[136:139], v[192:195], v[200:203]
  buffer_store_dwordx4 v[0:3], v224, s[20:23], s7 offen sc1
  v_mfma_f32_16x16x32_bf16 v[88:91], v[168:171], v[136:139], v[88:91]
  v_cvt_pk_bf16_f32 v32, v32, v33
  v_mfma_f32_16x16x32_bf16 v[208:211], v[136:139], v[196:199], v[208:211]
  v_cvt_pk_bf16_f32 v33, v34, v35
  v_mfma_f32_16x16x32_bf16 v[92:95], v[172:175], v[136:139], v[92:95]
  v_cvt_pk_bf16_f32 v34, v36, v37
  v_mfma_f32_16x16x32_bf16 v[204:207], v[140:143], v[192:195], v[204:207]
  v_cvt_pk_bf16_f32 v35, v38, v39
  v_mfma_f32_16x16x32_bf16 v[112:115], v[160:163], v[140:143], v[112:115]
  buffer_store_dwordx4 v[32:35], v224, s[20:23], s7 offen offset:256 sc1
  v_mfma_f32_16x16x32_bf16 v[212:215], v[140:143], v[196:199], v[212:215]
  v_cvt_pk_bf16_f32 v8, v8, v9
  v_mfma_f32_16x16x32_bf16 v[116:119], v[164:167], v[140:143], v[116:119]
  v_cvt_pk_bf16_f32 v9, v10, v11
  v_mfma_f32_16x16x32_bf16 v[120:123], v[168:171], v[140:143], v[120:123]
  v_cvt_pk_bf16_f32 v10, v12, v13
  v_mfma_f32_16x16x32_bf16 v[124:127], v[172:175], v[140:143], v[124:127]
  v_cvt_pk_bf16_f32 v11, v14, v15
  s_waitcnt lgkmcnt(0)
  v_mfma_f32_16x16x32_bf16 v[16:19], v[176:179], v[144:147], v[16:19]
  ds_read_b128 v[128:131], v216 offset:0
  s_mul_i32 s7, s31, 1
  v_mfma_f32_16x16x32_bf16 v[20:23], v[180:183], v[144:147], v[20:23]
  ds_read_b64_tr_b16 v[160:161], v218 offset:1024
  s_add_u32 s7, s7, s30
  v_mfma_f32_16x16x32_bf16 v[24:27], v[184:187], v[144:147], v[24:27]
  ds_read_b64_tr_b16 v[162:163], v218 offset:1536
  buffer_store_dwordx4 v[8:11], v224, s[20:23], s7 offen sc1
  v_mfma_f32_16x16x32_bf16 v[28:31], v[188:191], v[144:147], v[28:31]
  ds_read_b128 v[132:135], v216 offset:2048
  v_cvt_pk_bf16_f32 v40, v40, v41
  v_mfma_f32_16x16x32_bf16 v[48:51], v[176:179], v[148:151], v[48:51]
  ds_read_b64_tr_b16 v[164:165], v219 offset:1024
  v_cvt_pk_bf16_f32 v41, v42, v43
  v_mfma_f32_16x16x32_bf16 v[52:55], v[180:183], v[148:151], v[52:55]
  ds_read_b64_tr_b16 v[166:167], v219 offset:1536
  v_cvt_pk_bf16_f32 v42, v44, v45
  v_mfma_f32_16x16x32_bf16 v[56:59], v[184:187], v[148:151], v[56:59]
  ds_read_b128 v[136:139], v216 offset:4096
  v_cvt_pk_bf16_f32 v43, v46, v47
  v_mfma_f32_16x16x32_bf16 v[60:63], v[188:191], v[148:151], v[60:63]
  ds_read_b64_tr_b16 v[168:169], v220 offset:1024
  buffer_store_dwordx4 v[40:43], v224, s[20:23], s7 offen offset:256 sc1
  v_mfma_f32_16x16x32_bf16 v[80:83], v[176:179], v[152:155], v[80:83]
  ds_read_b64_tr_b16 v[170:171], v220 offset:1536
  v_cvt_pk_bf16_f32 v64, v64, v65
  v_mfma_f32_16x16x32_bf16 v[84:87], v[180:183], v[152:155], v[84:87]
  ds_read_b128 v[140:143], v216 offset:6144
  v_cvt_pk_bf16_f32 v65, v66, v67
  v_mfma_f32_16x16x32_bf16 v[88:91], v[184:187], v[152:155], v[88:91]
  ds_read_b64_tr_b16 v[172:173], v221 offset:1024
  v_cvt_pk_bf16_f32 v66, v68, v69
  v_mfma_f32_16x16x32_bf16 v[92:95], v[188:191], v[152:155], v[92:95]
  ds_read_b64_tr_b16 v[174:175], v221 offset:1536
  v_cvt_pk_bf16_f32 v67, v70, v71
  v_mfma_f32_16x16x32_bf16 v[112:115], v[176:179], v[156:159], v[112:115]
  ds_read_b64_tr_b16 v[192:193], v222 offset:0
  s_mul_i32 s7, s31, 0
  v_mfma_f32_16x16x32_bf16 v[116:119], v[180:183], v[156:159], v[116:119]
  ds_read_b64_tr_b16 v[194:195], v222 offset:256
  s_add_u32 s7, s7, s30
  v_mfma_f32_16x16x32_bf16 v[120:123], v[184:187], v[156:159], v[120:123]
  ds_read_b64_tr_b16 v[196:197], v222 offset:32
  s_add_u32 s7, s7, s32
  v_mfma_f32_16x16x32_bf16 v[124:127], v[188:191], v[156:159], v[124:127]
  ds_read_b64_tr_b16 v[198:199], v222 offset:288
  buffer_store_dwordx4 v[64:67], v224, s[20:23], s7 offen sc1
  s_waitcnt lgkmcnt(0)
  v_mfma_f32_16x16x32_bf16 v[16:19], v[160:163], v[128:131], v[16:19]
  ds_read_b128 v[144:147], v217 offset:0
  v_cvt_pk_bf16_f32 v96, v96, v97
  v_mfma_f32_16x16x32_bf16 v[20:23], v[164:167], v[128:131], v[20:23]
  ds_read_b64_tr_b16 v[176:177], v218 offset:17408
  v_cvt_pk_bf16_f32 v97, v98, v99
  v_mfma_f32_16x16x32_bf16 v[24:27], v[168:171], v[128:131], v[24:27]
  ds_read_b64_tr_b16 v[178:179], v218 offset:17920
  v_cvt_pk_bf16_f32 v98, v100, v101
  v_mfma_f32_16x16x32_bf16 v[28:31], v[172:175], v[128:131], v[28:31]
  ds_read_b128 v[148:151], v217 offset:2048
  v_cvt_pk_bf16_f32 v99, v102, v103
  v_mfma_f32_16x16x32_bf16 v[48:51], v[160:163], v[132:135], v[48:51]
  ds_read_b64_tr_b16 v[180:181], v219 offset:17408
  buffer_store_dwordx4 v[96:99], v224, s[20:23], s7 offen offset:256 sc1
  v_mfma_f32_16x16x32_bf16 v[52:55], v[164:167], v[132:135], v[52:55]
  ds_read_b64_tr_b16 v[182:183], v219 offset:17920
  v_cvt_pk_bf16_f32 v72, v72, v73
  v_mfma_f32_16x16x32_bf16 v[56:59], v[168:171], v[132:135], v[56:59]
  ds_read_b128 v[152:155], v217 offset:4096
  v_cvt_pk_bf16_f32 v73, v74, v75
  v_mfma_f32_16x16x32_bf16 v[60:63], v[172:175], v[132:135], v[60:63]
  ds_read_b64_tr_b16 v[184:185], v220 offset:17408
  v_cvt_pk_bf16_f32 v74, v76, v77
  v_mfma_f32_16x16x32_bf16 v[80:83], v[160:163], v[136:139], v[80:83]
  ds_read_b64_tr_b16 v[186:187], v220 offset:17920
  v_cvt_pk_bf16_f32 v75, v78, v79
  v_mfma_f32_16x16x32_bf16 v[84:87], v[164:167], v[136:139], v[84:87]
  ds_read_b128 v[156:159], v217 offset:6144
  s_mul_i32 s7, s31, 1
  v_mfma_f32_16x16x32_bf16 v[200:203], v[136:139], v[192:195], v[200:203]
  ds_read_b64_tr_b16 v[188:189], v221 offset:17408
  s_add_u32 s7, s7, s30
  v_mfma_f32_16x16x32_bf16 v[88:91], v[168:171], v[136:139], v[88:91]
  ds_read_b64_tr_b16 v[190:191], v221 offset:17920
  s_add_u32 s7, s7, s32
  v_mfma_f32_16x16x32_bf16 v[208:211], v[136:139], v[196:199], v[208:211]
  buffer_store_dwordx4 v[72:75], v224, s[20:23], s7 offen sc1
  v_mfma_f32_16x16x32_bf16 v[92:95], v[172:175], v[136:139], v[92:95]
  v_cvt_pk_bf16_f32 v104, v104, v105
  v_mfma_f32_16x16x32_bf16 v[204:207], v[140:143], v[192:195], v[204:207]
  v_cvt_pk_bf16_f32 v105, v106, v107
  v_mfma_f32_16x16x32_bf16 v[112:115], v[160:163], v[140:143], v[112:115]
  v_cvt_pk_bf16_f32 v106, v108, v109
  v_mfma_f32_16x16x32_bf16 v[212:215], v[140:143], v[196:199], v[212:215]
  v_cvt_pk_bf16_f32 v107, v110, v111
  v_mfma_f32_16x16x32_bf16 v[116:119], v[164:167], v[140:143], v[116:119]
  buffer_store_dwordx4 v[104:107], v224, s[20:23], s7 offen offset:256 sc1
  v_mfma_f32_16x16x32_bf16 v[120:123], v[168:171], v[140:143], v[120:123]
  v_mfma_f32_16x16x32_bf16 v[124:127], v[172:175], v[140:143], v[124:127]
  s_waitcnt lgkmcnt(0)
  v_mfma_f32_16x16x32_bf16 v[16:19], v[176:179], v[144:147], v[16:19]
  v_mfma_f32_16x16x32_bf16 v[20:23], v[180:183], v[144:147], v[20:23]
  v_mfma_f32_16x16x32_bf16 v[24:27], v[184:187], v[144:147], v[24:27]
  v_mfma_f32_16x16x32_bf16 v[28:31], v[188:191], v[144:147], v[28:31]
  v_mfma_f32_16x16x32_bf16 v[48:51], v[176:179], v[148:151], v[48:51]
  v_mfma_f32_16x16x32_bf16 v[52:55], v[180:183], v[148:151], v[52:55]
  v_mfma_f32_16x16x32_bf16 v[56:59], v[184:187], v[148:151], v[56:59]
  v_mfma_f32_16x16x32_bf16 v[60:63], v[188:191], v[148:151], v[60:63]
  v_mfma_f32_16x16x32_bf16 v[80:83], v[176:179], v[152:155], v[80:83]
  v_mfma_f32_16x16x32_bf16 v[84:87], v[180:183], v[152:155], v[84:87]
  v_mfma_f32_16x16x32_bf16 v[88:91], v[184:187], v[152:155], v[88:91]
  v_mfma_f32_16x16x32_bf16 v[92:95], v[188:191], v[152:155], v[92:95]
  v_mfma_f32_16x16x32_bf16 v[112:115], v[176:179], v[156:159], v[112:115]
  v_mfma_f32_16x16x32_bf16 v[116:119], v[180:183], v[156:159], v[116:119]
  v_mfma_f32_16x16x32_bf16 v[120:123], v[184:187], v[156:159], v[120:123]
  v_mfma_f32_16x16x32_bf16 v[124:127], v[188:191], v[156:159], v[124:127]
  s_nop 7
  v_cvt_pk_bf16_f32 v16, v16, v17
  v_cvt_pk_bf16_f32 v17, v18, v19
  v_cvt_pk_bf16_f32 v18, v20, v21
  v_cvt_pk_bf16_f32 v19, v22, v23
  s_mul_i32 s7, s31, 2
  s_add_u32 s7, s7, s30
  buffer_store_dwordx4 v[16:19], v224, s[20:23], s7 offen sc1
  v_cvt_pk_bf16_f32 v48, v48, v49
  v_cvt_pk_bf16_f32 v49, v50, v51
  v_cvt_pk_bf16_f32 v50, v52, v53
  v_cvt_pk_bf16_f32 v51, v54, v55
  buffer_store_dwordx4 v[48:51], v224, s[20:23], s7 offen offset:256 sc1
  v_cvt_pk_bf16_f32 v24, v24, v25
  v_cvt_pk_bf16_f32 v25, v26, v27
  v_cvt_pk_bf16_f32 v26, v28, v29
  v_cvt_pk_bf16_f32 v27, v30, v31
  s_mul_i32 s7, s31, 3
  s_add_u32 s7, s7, s30
  buffer_store_dwordx4 v[24:27], v224, s[20:23], s7 offen sc1
  v_cvt_pk_bf16_f32 v56, v56, v57
  v_cvt_pk_bf16_f32 v57, v58, v59
  v_cvt_pk_bf16_f32 v58, v60, v61
  v_cvt_pk_bf16_f32 v59, v62, v63
  buffer_store_dwordx4 v[56:59], v224, s[20:23], s7 offen offset:256 sc1
  v_cvt_pk_bf16_f32 v80, v80, v81
  v_cvt_pk_bf16_f32 v81, v82, v83
  v_cvt_pk_bf16_f32 v82, v84, v85
  v_cvt_pk_bf16_f32 v83, v86, v87
  s_mul_i32 s7, s31, 2
  s_add_u32 s7, s7, s30
  s_add_u32 s7, s7, s32
  buffer_store_dwordx4 v[80:83], v224, s[20:23], s7 offen sc1
  v_cvt_pk_bf16_f32 v112, v112, v113
  v_cvt_pk_bf16_f32 v113, v114, v115
  v_cvt_pk_bf16_f32 v114, v116, v117
  v_cvt_pk_bf16_f32 v115, v118, v119
  buffer_store_dwordx4 v[112:115], v224, s[20:23], s7 offen offset:256 sc1
  v_cvt_pk_bf16_f32 v88, v88, v89
  v_cvt_pk_bf16_f32 v89, v90, v91
  v_cvt_pk_bf16_f32 v90, v92, v93
  v_cvt_pk_bf16_f32 v91, v94, v95
  s_mul_i32 s7, s31, 3
  s_add_u32 s7, s7, s30
  s_add_u32 s7, s7, s32
  buffer_store_dwordx4 v[88:91], v224, s[20:23], s7 offen sc1
  v_cvt_pk_bf16_f32 v120, v120, v121
  v_cvt_pk_bf16_f32 v121, v122, v123
  v_cvt_pk_bf16_f32 v122, v124, v125
  v_cvt_pk_bf16_f32 v123, v126, v127
  buffer_store_dwordx4 v[120:123], v224, s[20:23], s7 offen offset:256 sc1
  s_waitcnt lgkmcnt(0)
  s_barrier
  s_lshl_b32 s7, s24, 12
  s_add_u32 s7, s7, 53248
  v_add_u32 v226, s7, v223
  ds_read_b128 v[128:131], v226 offset:0
  ds_read_b128 v[132:135], v226 offset:1024
  ds_read_b128 v[136:139], v226 offset:2048
  ds_read_b128 v[140:143], v226 offset:3072
  s_waitcnt lgkmcnt(0)
  v_add_f32 v200, v200, v128
  v_add_f32 v201, v201, v129
  v_add_f32 v202, v202, v130
  v_add_f32 v203, v203, v131
  v_add_f32 v204, v204, v132
  v_add_f32 v205, v205, v133
  v_add_f32 v206, v206, v134
  v_add_f32 v207, v207, v135
  v_add_f32 v208, v208, v136
  v_add_f32 v209, v209, v137
  v_add_f32 v210, v210, v138
  v_add_f32 v211, v211, v139
  v_add_f32 v212, v212, v140
  v_add_f32 v213, v213, v141
  v_add_f32 v214, v214, v142
  v_add_f32 v215, v215, v143
  v_cvt_pk_bf16_f32 v200, v200, v201
  v_cvt_pk_bf16_f32 v201, v202, v203
  v_cvt_pk_bf16_f32 v202, v204, v205
  v_cvt_pk_bf16_f32 v203, v206, v207
  v_cvt_pk_bf16_f32 v204, v208, v209
  v_cvt_pk_bf16_f32 v205, v210, v211
  v_cvt_pk_bf16_f32 v206, v212, v213
  v_cvt_pk_bf16_f32 v207, v214, v215
  s_lshl_b32 s7, s5, 2
  s_lshl_b32 s33, s24, 1
  s_add_u32 s7, s7, s33
  s_add_u32 s7, s7, 1
  s_lshl_b32 s7, s7, 12
  s_add_u32 s7, s7, 16779264
  buffer_store_dwordx4 v[200:203], v224, s[20:23], s7 offen sc1
  buffer_store_dwordx4 v[204:207], v224, s[20:23], s7 offen offset:256 sc1
  s_endpgm
p1_c_B7:
  s_lshl_b32 s7, s6, 3
  s_lshl_b32 s33, s25, 2
  s_add_u32 s7, s7, s33
  s_lshl_b32 s33, s5, 2
  s_lshl_b32 s36, s24, 1
  s_add_u32 s33, s33, s36
  s_mov_b32 s31, 131072
  s_mov_b32 s32, 2048
  s_mov_b32 s36, 12582912
  s_mov_b32 s34, 0x3e8293ee
  s_mov_b32 s35, s34
  s_mul_i32 s7, s7, s31
  s_mul_i32 s33, s33, s32
  s_add_u32 s30, s7, s33
  s_add_u32 s30, s30, s36
  s_mov_b32 s28, 14
  s_waitcnt lgkmcnt(0)
  s_barrier
  ds_read_b128 v[128:131], v216 offset:0
  ds_read_b64_tr_b16 v[160:161], v218 offset:0
  ds_read_b64_tr_b16 v[162:163], v218 offset:512
  ds_read_b128 v[132:135], v216 offset:2048
  ds_read_b64_tr_b16 v[164:165], v219 offset:0
  ds_read_b64_tr_b16 v[166:167], v219 offset:512
  ds_read_b128 v[136:139], v216 offset:4096
  ds_read_b64_tr_b16 v[168:169], v220 offset:0
  ds_read_b64_tr_b16 v[170:171], v220 offset:512
  ds_read_b128 v[140:143], v216 offset:6144
  ds_read_b64_tr_b16 v[172:173], v221 offset:0
  ds_read_b64_tr_b16 v[174:175], v221 offset:512
  .p2align 6
p1_c_B7_loop:
  s_waitcnt lgkmcnt(0)
  v_mfma_f32_16x16x32_bf16 v[0:3], v[160:163], v[128:131], v[0:3]
  ds_read_b64_tr_b16 v[176:177], v218 offset:1024
  v_mfma_f32_16x16x32_bf16 v[4:7], v[164:167], v[128:131], v[4:7]
  ds_read_b64_tr_b16 v[178:179], v218 offset:1536
  v_mfma_f32_16x16x32_bf16 v[8:11], v[168:171], v[128:131], v[8:11]
  ds_read_b64_tr_b16 v[180:181], v219 offset:1024
  v_mfma_f32_16x16x32_bf16 v[12:15], v[172:175], v[128:131], v[12:15]
  ds_read_b64_tr_b16 v[182:183], v219 offset:1536
  v_mfma_f32_16x16x32_bf16 v[32:35], v[160:163], v[132:135], v[32:35]
  ds_read_b128 v[144:147], v217 offset:0
  v_mfma_f32_16x16x32_bf16 v[36:39], v[164:167], v[132:135], v[36:39]
  ds_read_b64_tr_b16 v[184:185], v220 offset:1024
  v_mfma_f32_16x16x32_bf16 v[40:43], v[168:171], v[132:135], v[40:43]
  ds_read_b64_tr_b16 v[186:187], v220 offset:1536
  v_mfma_f32_16x16x32_bf16 v[44:47], v[172:175], v[132:135], v[44:47]
  ds_read_b64_tr_b16 v[188:189], v221 offset:1024
  v_mfma_f32_16x16x32_bf16 v[64:67], v[160:163], v[136:139], v[64:67]
  ds_read_b64_tr_b16 v[190:191], v221 offset:1536
  v_mfma_f32_16x16x32_bf16 v[68:71], v[164:167], v[136:139], v[68:71]
  ds_read_b128 v[148:151], v217 offset:2048
  v_mfma_f32_16x16x32_bf16 v[72:75], v[168:171], v[136:139], v[72:75]
  v_mfma_f32_16x16x32_bf16 v[76:79], v[172:175], v[136:139], v[76:79]
  v_mfma_f32_16x16x32_bf16 v[96:99], v[160:163], v[140:143], v[96:99]
  v_mfma_f32_16x16x32_bf16 v[100:103], v[164:167], v[140:143], v[100:103]
  v_mfma_f32_16x16x32_bf16 v[104:107], v[168:171], v[140:143], v[104:107]
  s_add_u32 s26, s26, 1
  s_cmp_eq_u32 s26, 3
  v_mfma_f32_16x16x32_bf16 v[108:111], v[172:175], v[140:143], v[108:111]
  s_cselect_b32 s27, s50, s51
  s_cselect_b32 s26, 0, s26
  s_waitcnt lgkmcnt(0)
  v_mfma_f32_16x16x32_bf16 v[16:19], v[176:179], v[128:131], v[16:19]
  ds_read_b64_tr_b16 v[160:161], v218 offset:16384
  v_mfma_f32_16x16x32_bf16 v[20:23], v[180:183], v[128:131], v[20:23]
  ds_read_b64_tr_b16 v[162:163], v218 offset:16896
  v_mfma_f32_16x16x32_bf16 v[24:27], v[184:187], v[128:131], v[24:27]
  ds_read_b64_tr_b16 v[164:165], v219 offset:16384
  v_mfma_f32_16x16x32_bf16 v[28:31], v[188:191], v[128:131], v[28:31]
  ds_read_b64_tr_b16 v[166:167], v219 offset:16896
  v_mfma_f32_16x16x32_bf16 v[48:51], v[176:179], v[132:135], v[48:51]
  ds_read_b128 v[152:155], v217 offset:4096
  v_mfma_f32_16x16x32_bf16 v[52:55], v[180:183], v[132:135], v[52:55]
  ds_read_b64_tr_b16 v[168:169], v220 offset:16384
  v_mfma_f32_16x16x32_bf16 v[56:59], v[184:187], v[132:135], v[56:59]
  ds_read_b64_tr_b16 v[170:171], v220 offset:16896
  v_mfma_f32_16x16x32_bf16 v[60:63], v[188:191], v[132:135], v[60:63]
  ds_read_b64_tr_b16 v[172:173], v221 offset:16384
  v_mfma_f32_16x16x32_bf16 v[80:83], v[176:179], v[136:139], v[80:83]
  ds_read_b64_tr_b16 v[174:175], v221 offset:16896
  v_mfma_f32_16x16x32_bf16 v[84:87], v[180:183], v[136:139], v[84:87]
  ds_read_b128 v[156:159], v217 offset:6144
  v_mfma_f32_16x16x32_bf16 v[88:91], v[184:187], v[136:139], v[88:91]
  v_mfma_f32_16x16x32_bf16 v[92:95], v[188:191], v[136:139], v[92:95]
  v_mfma_f32_16x16x32_bf16 v[112:115], v[176:179], v[140:143], v[112:115]
  v_mfma_f32_16x16x32_bf16 v[116:119], v[180:183], v[140:143], v[116:119]
  v_mfma_f32_16x16x32_bf16 v[120:123], v[184:187], v[140:143], v[120:123]
  v_mfma_f32_16x16x32_bf16 v[124:127], v[188:191], v[140:143], v[124:127]
  s_waitcnt lgkmcnt(0)
  v_mfma_f32_16x16x32_bf16 v[0:3], v[160:163], v[144:147], v[0:3]
  ds_read_b64_tr_b16 v[176:177], v218 offset:17408
  v_mfma_f32_16x16x32_bf16 v[4:7], v[164:167], v[144:147], v[4:7]
  ds_read_b64_tr_b16 v[178:179], v218 offset:17920
  v_mfma_f32_16x16x32_bf16 v[8:11], v[168:171], v[144:147], v[8:11]
  ds_read_b64_tr_b16 v[180:181], v219 offset:17408
  v_mfma_f32_16x16x32_bf16 v[12:15], v[172:175], v[144:147], v[12:15]
  ds_read_b64_tr_b16 v[182:183], v219 offset:17920
  v_mfma_f32_16x16x32_bf16 v[32:35], v[160:163], v[148:151], v[32:35]
  ds_read_b64_tr_b16 v[184:185], v220 offset:17408
  v_mfma_f32_16x16x32_bf16 v[36:39], v[164:167], v[148:151], v[36:39]
  ds_read_b64_tr_b16 v[186:187], v220 offset:17920
  v_mfma_f32_16x16x32_bf16 v[40:43], v[168:171], v[148:151], v[40:43]
  ds_read_b64_tr_b16 v[188:189], v221 offset:17408
  v_mfma_f32_16x16x32_bf16 v[44:47], v[172:175], v[148:151], v[44:47]
  ds_read_b64_tr_b16 v[190:191], v221 offset:17920
  v_mfma_f32_16x16x32_bf16 v[64:67], v[160:163], v[152:155], v[64:67]
  ds_read_b64_tr_b16 v[192:193], v222 offset:0
  v_mfma_f32_16x16x32_bf16 v[68:71], v[164:167], v[152:155], v[68:71]
  ds_read_b64_tr_b16 v[194:195], v222 offset:256
  v_mfma_f32_16x16x32_bf16 v[72:75], v[168:171], v[152:155], v[72:75]
  ds_read_b64_tr_b16 v[196:197], v222 offset:32
  v_mfma_f32_16x16x32_bf16 v[76:79], v[172:175], v[152:155], v[76:79]
  ds_read_b64_tr_b16 v[198:199], v222 offset:288
  v_mfma_f32_16x16x32_bf16 v[96:99], v[160:163], v[156:159], v[96:99]
  v_mfma_f32_16x16x32_bf16 v[100:103], v[164:167], v[156:159], v[100:103]
  v_mfma_f32_16x16x32_bf16 v[104:107], v[168:171], v[156:159], v[104:107]
  v_mfma_f32_16x16x32_bf16 v[108:111], v[172:175], v[156:159], v[108:111]
  s_waitcnt lgkmcnt(0)
  s_barrier
  v_mfma_f32_16x16x32_bf16 v[16:19], v[176:179], v[144:147], v[16:19]
  v_add_u32 v216, s27, v216
  v_add_u32 v218, s27, v218
  v_mfma_f32_16x16x32_bf16 v[20:23], v[180:183], v[144:147], v[20:23]
  ds_read_b128 v[128:131], v216 offset:0
  ds_read_b64_tr_b16 v[160:161], v218 offset:0
  v_mfma_f32_16x16x32_bf16 v[24:27], v[184:187], v[144:147], v[24:27]
  ds_read_b64_tr_b16 v[162:163], v218 offset:512
  v_add_u32 v219, s27, v219
  v_mfma_f32_16x16x32_bf16 v[28:31], v[188:191], v[144:147], v[28:31]
  ds_read_b128 v[132:135], v216 offset:2048
  ds_read_b64_tr_b16 v[164:165], v219 offset:0
  v_mfma_f32_16x16x32_bf16 v[48:51], v[176:179], v[148:151], v[48:51]
  ds_read_b64_tr_b16 v[166:167], v219 offset:512
  v_add_u32 v220, s27, v220
  v_mfma_f32_16x16x32_bf16 v[52:55], v[180:183], v[148:151], v[52:55]
  ds_read_b128 v[136:139], v216 offset:4096
  ds_read_b64_tr_b16 v[168:169], v220 offset:0
  v_mfma_f32_16x16x32_bf16 v[56:59], v[184:187], v[148:151], v[56:59]
  ds_read_b64_tr_b16 v[170:171], v220 offset:512
  v_add_u32 v221, s27, v221
  v_mfma_f32_16x16x32_bf16 v[60:63], v[188:191], v[148:151], v[60:63]
  ds_read_b128 v[140:143], v216 offset:6144
  ds_read_b64_tr_b16 v[172:173], v221 offset:0
  v_mfma_f32_16x16x32_bf16 v[80:83], v[176:179], v[152:155], v[80:83]
  ds_read_b64_tr_b16 v[174:175], v221 offset:512
  v_mfma_f32_16x16x32_bf16 v[84:87], v[180:183], v[152:155], v[84:87]
  v_add_u32 v217, s27, v217
  v_mfma_f32_16x16x32_bf16 v[200:203], v[152:155], v[192:195], v[200:203]
  v_add_u32 v222, s27, v222
  v_mfma_f32_16x16x32_bf16 v[88:91], v[184:187], v[152:155], v[88:91]
  s_sub_u32 s28, s28, 1
  v_mfma_f32_16x16x32_bf16 v[208:211], v[152:155], v[196:199], v[208:211]
  s_cmp_lg_u32 s28, 0
  v_mfma_f32_16x16x32_bf16 v[92:95], v[188:191], v[152:155], v[92:95]
  v_mfma_f32_16x16x32_bf16 v[204:207], v[156:159], v[192:195], v[204:207]
  v_mfma_f32_16x16x32_bf16 v[112:115], v[176:179], v[156:159], v[112:115]
  v_mfma_f32_16x16x32_bf16 v[212:215], v[156:159], v[196:199], v[212:215]
  v_mfma_f32_16x16x32_bf16 v[116:119], v[180:183], v[156:159], v[116:119]
  v_mfma_f32_16x16x32_bf16 v[120:123], v[184:187], v[156:159], v[120:123]
  v_mfma_f32_16x16x32_bf16 v[124:127], v[188:191], v[156:159], v[124:127]
  s_cbranch_scc1 p1_c_B7_loop
  s_waitcnt lgkmcnt(0)
  v_mfma_f32_16x16x32_bf16 v[0:3], v[160:163], v[128:131], v[0:3]
  ds_read_b128 v[144:147], v217 offset:0
  v_mfma_f32_16x16x32_bf16 v[4:7], v[164:167], v[128:131], v[4:7]
  ds_read_b64_tr_b16 v[176:177], v218 offset:16384
  v_mfma_f32_16x16x32_bf16 v[8:11], v[168:171], v[128:131], v[8:11]
  ds_read_b64_tr_b16 v[178:179], v218 offset:16896
  v_mfma_f32_16x16x32_bf16 v[12:15], v[172:175], v[128:131], v[12:15]
  ds_read_b128 v[148:151], v217 offset:2048
  v_mfma_f32_16x16x32_bf16 v[32:35], v[160:163], v[132:135], v[32:35]
  ds_read_b64_tr_b16 v[180:181], v219 offset:16384
  v_mfma_f32_16x16x32_bf16 v[36:39], v[164:167], v[132:135], v[36:39]
  ds_read_b64_tr_b16 v[182:183], v219 offset:16896
  v_mfma_f32_16x16x32_bf16 v[40:43], v[168:171], v[132:135], v[40:43]
  ds_read_b128 v[152:155], v217 offset:4096
  v_mfma_f32_16x16x32_bf16 v[44:47], v[172:175], v[132:135], v[44:47]
  ds_read_b64_tr_b16 v[184:185], v220 offset:16384
  v_mfma_f32_16x16x32_bf16 v[64:67], v[160:163], v[136:139], v[64:67]
  ds_read_b64_tr_b16 v[186:187], v220 offset:16896
  v_mfma_f32_16x16x32_bf16 v[68:71], v[164:167], v[136:139], v[68:71]
  ds_read_b128 v[156:159], v217 offset:6144
  v_add_u32 v236, 0xfffe6000, v222
  v_mfma_f32_16x16x32_bf16 v[72:75], v[168:171], v[136:139], v[72:75]
  ds_read_b64_tr_b16 v[188:189], v221 offset:16384
  v_add_u32 v235, 0xfffe6000, v221
  v_mfma_f32_16x16x32_bf16 v[76:79], v[172:175], v[136:139], v[76:79]
  ds_read_b64_tr_b16 v[190:191], v221 offset:16896
  v_add_u32 v234, 0xfffe6000, v220
  v_mfma_f32_16x16x32_bf16 v[96:99], v[160:163], v[140:143], v[96:99]
  v_add_u32 v233, 0xfffe6000, v219
  v_mfma_f32_16x16x32_bf16 v[100:103], v[164:167], v[140:143], v[100:103]
  v_add_u32 v232, 0xfffe6000, v218
  v_mfma_f32_16x16x32_bf16 v[104:107], v[168:171], v[140:143], v[104:107]
  v_add_u32 v231, 0xfffe6000, v217
  v_mfma_f32_16x16x32_bf16 v[108:111], v[172:175], v[140:143], v[108:111]
  v_add_u32 v230, 0xfffe6000, v216
  s_waitcnt lgkmcnt(0)
  s_barrier
  v_mfma_f32_16x16x32_bf16 v[0:3], v[176:179], v[144:147], v[0:3]
  ds_read_b128 v[128:131], v230 offset:0
  v_mfma_f32_16x16x32_bf16 v[4:7], v[180:183], v[144:147], v[4:7]
  ds_read_b64_tr_b16 v[160:161], v232 offset:0
  v_mfma_f32_16x16x32_bf16 v[8:11], v[184:187], v[144:147], v[8:11]
  ds_read_b64_tr_b16 v[162:163], v232 offset:512
  v_mfma_f32_16x16x32_bf16 v[12:15], v[188:191], v[144:147], v[12:15]
  ds_read_b128 v[132:135], v230 offset:2048
  v_mfma_f32_16x16x32_bf16 v[32:35], v[176:179], v[148:151], v[32:35]
  ds_read_b64_tr_b16 v[164:165], v233 offset:0
  v_mfma_f32_16x16x32_bf16 v[36:39], v[180:183], v[148:151], v[36:39]
  ds_read_b64_tr_b16 v[166:167], v233 offset:512
  v_mfma_f32_16x16x32_bf16 v[40:43], v[184:187], v[148:151], v[40:43]
  ds_read_b128 v[136:139], v230 offset:4096
  v_mfma_f32_16x16x32_bf16 v[44:47], v[188:191], v[148:151], v[44:47]
  ds_read_b64_tr_b16 v[168:169], v234 offset:0
  v_mfma_f32_16x16x32_bf16 v[64:67], v[176:179], v[152:155], v[64:67]
  ds_read_b64_tr_b16 v[170:171], v234 offset:512
  v_mfma_f32_16x16x32_bf16 v[68:71], v[180:183], v[152:155], v[68:71]
  ds_read_b128 v[140:143], v230 offset:6144
  v_mfma_f32_16x16x32_bf16 v[72:75], v[184:187], v[152:155], v[72:75]
  ds_read_b64_tr_b16 v[172:173], v235 offset:0
  v_mfma_f32_16x16x32_bf16 v[76:79], v[188:191], v[152:155], v[76:79]
  ds_read_b64_tr_b16 v[174:175], v235 offset:512
  v_mfma_f32_16x16x32_bf16 v[96:99], v[176:179], v[156:159], v[96:99]
  v_mfma_f32_16x16x32_bf16 v[100:103], v[180:183], v[156:159], v[100:103]
  v_mfma_f32_16x16x32_bf16 v[104:107], v[184:187], v[156:159], v[104:107]
  v_mfma_f32_16x16x32_bf16 v[108:111], v[188:191], v[156:159], v[108:111]
  s_waitcnt lgkmcnt(0)
  v_mfma_f32_16x16x32_bf16 v[0:3], v[160:163], v[128:131], v[0:3]
  ds_read_b128 v[144:147], v231 offset:0
  v_mfma_f32_16x16x32_bf16 v[4:7], v[164:167], v[128:131], v[4:7]
  ds_read_b64_tr_b16 v[176:177], v232 offset:16384
  v_mfma_f32_16x16x32_bf16 v[8:11], v[168:171], v[128:131], v[8:11]
  ds_read_b64_tr_b16 v[178:179], v232 offset:16896
  v_mfma_f32_16x16x32_bf16 v[12:15], v[172:175], v[128:131], v[12:15]
  ds_read_b128 v[148:151], v231 offset:2048
  v_mfma_f32_16x16x32_bf16 v[32:35], v[160:163], v[132:135], v[32:35]
  ds_read_b64_tr_b16 v[180:181], v233 offset:16384
  v_mfma_f32_16x16x32_bf16 v[36:39], v[164:167], v[132:135], v[36:39]
  ds_read_b64_tr_b16 v[182:183], v233 offset:16896
  v_mfma_f32_16x16x32_bf16 v[40:43], v[168:171], v[132:135], v[40:43]
  ds_read_b128 v[152:155], v231 offset:4096
  v_mfma_f32_16x16x32_bf16 v[44:47], v[172:175], v[132:135], v[44:47]
  ds_read_b64_tr_b16 v[184:185], v234 offset:16384
  v_mfma_f32_16x16x32_bf16 v[64:67], v[160:163], v[136:139], v[64:67]
  ds_read_b64_tr_b16 v[186:187], v234 offset:16896
  v_mfma_f32_16x16x32_bf16 v[68:71], v[164:167], v[136:139], v[68:71]
  ds_read_b128 v[156:159], v231 offset:6144
  v_mfma_f32_16x16x32_bf16 v[72:75], v[168:171], v[136:139], v[72:75]
  ds_read_b64_tr_b16 v[188:189], v235 offset:16384
  v_mfma_f32_16x16x32_bf16 v[76:79], v[172:175], v[136:139], v[76:79]
  ds_read_b64_tr_b16 v[190:191], v235 offset:16896
  v_mfma_f32_16x16x32_bf16 v[96:99], v[160:163], v[140:143], v[96:99]
  v_mfma_f32_16x16x32_bf16 v[100:103], v[164:167], v[140:143], v[100:103]
  v_mfma_f32_16x16x32_bf16 v[104:107], v[168:171], v[140:143], v[104:107]
  v_mfma_f32_16x16x32_bf16 v[108:111], v[172:175], v[140:143], v[108:111]
  s_waitcnt lgkmcnt(0)
  v_mfma_f32_16x16x32_bf16 v[0:3], v[176:179], v[144:147], v[0:3]
  ds_read_b64_tr_b16 v[160:161], v232 offset:1024
  v_mfma_f32_16x16x32_bf16 v[4:7], v[180:183], v[144:147], v[4:7]
  ds_read_b64_tr_b16 v[162:163], v232 offset:1536
  v_mfma_f32_16x16x32_bf16 v[8:11], v[184:187], v[144:147], v[8:11]
  ds_read_b64_tr_b16 v[164:165], v233 offset:1024
  v_mfma_f32_16x16x32_bf16 v[12:15], v[188:191], v[144:147], v[12:15]
  ds_read_b64_tr_b16 v[166:167], v233 offset:1536
  v_mfma_f32_16x16x32_bf16 v[32:35], v[176:179], v[148:151], v[32:35]
  ds_read_b64_tr_b16 v[168:169], v234 offset:1024
  v_mfma_f32_16x16x32_bf16 v[36:39], v[180:183], v[148:151], v[36:39]
  ds_read_b64_tr_b16 v[170:171], v234 offset:1536
  v_mfma_f32_16x16x32_bf16 v[40:43], v[184:187], v[148:151], v[40:43]
  ds_read_b64_tr_b16 v[172:173], v235 offset:1024
  v_mfma_f32_16x16x32_bf16 v[44:47], v[188:191], v[148:151], v[44:47]
  ds_read_b64_tr_b16 v[174:175], v235 offset:1536
  v_mfma_f32_16x16x32_bf16 v[64:67], v[176:179], v[152:155], v[64:67]
  v_mfma_f32_16x16x32_bf16 v[68:71], v[180:183], v[152:155], v[68:71]
  v_mfma_f32_16x16x32_bf16 v[72:75], v[184:187], v[152:155], v[72:75]
  v_mfma_f32_16x16x32_bf16 v[76:79], v[188:191], v[152:155], v[76:79]
  v_mfma_f32_16x16x32_bf16 v[96:99], v[176:179], v[156:159], v[96:99]
  v_mfma_f32_16x16x32_bf16 v[100:103], v[180:183], v[156:159], v[100:103]
  v_mfma_f32_16x16x32_bf16 v[104:107], v[184:187], v[156:159], v[104:107]
  v_mfma_f32_16x16x32_bf16 v[108:111], v[188:191], v[156:159], v[108:111]
  s_waitcnt lgkmcnt(0)
  v_mfma_f32_16x16x32_bf16 v[16:19], v[160:163], v[128:131], v[16:19]
  ds_read_b64_tr_b16 v[176:177], v232 offset:17408
  v_mfma_f32_16x16x32_bf16 v[20:23], v[164:167], v[128:131], v[20:23]
  ds_read_b64_tr_b16 v[178:179], v232 offset:17920
  v_mfma_f32_16x16x32_bf16 v[24:27], v[168:171], v[128:131], v[24:27]
  ds_read_b64_tr_b16 v[180:181], v233 offset:17408
  v_mfma_f32_16x16x32_bf16 v[28:31], v[172:175], v[128:131], v[28:31]
  ds_read_b64_tr_b16 v[182:183], v233 offset:17920
  v_mfma_f32_16x16x32_bf16 v[48:51], v[160:163], v[132:135], v[48:51]
  ds_read_b64_tr_b16 v[184:185], v234 offset:17408
  v_cvt_pk_bf16_f32 v0, v0, v1
  v_mfma_f32_16x16x32_bf16 v[52:55], v[164:167], v[132:135], v[52:55]
  ds_read_b64_tr_b16 v[186:187], v234 offset:17920
  v_cvt_pk_bf16_f32 v1, v2, v3
  v_mfma_f32_16x16x32_bf16 v[56:59], v[168:171], v[132:135], v[56:59]
  ds_read_b64_tr_b16 v[188:189], v235 offset:17408
  v_cvt_pk_bf16_f32 v2, v4, v5
  v_mfma_f32_16x16x32_bf16 v[60:63], v[172:175], v[132:135], v[60:63]
  ds_read_b64_tr_b16 v[190:191], v235 offset:17920
  v_cvt_pk_bf16_f32 v3, v6, v7
  v_mfma_f32_16x16x32_bf16 v[80:83], v[160:163], v[136:139], v[80:83]
  ds_read_b64_tr_b16 v[192:193], v236 offset:0
  s_mul_i32 s7, s31, 0
  v_mfma_f32_16x16x32_bf16 v[84:87], v[164:167], v[136:139], v[84:87]
  ds_read_b64_tr_b16 v[194:195], v236 offset:256
  s_add_u32 s7, s7, s30
  v_mfma_f32_16x16x32_bf16 v[88:91], v[168:171], v[136:139], v[88:91]
  ds_read_b64_tr_b16 v[196:197], v236 offset:32
  buffer_store_dwordx4 v[0:3], v224, s[20:23], s7 offen sc1
  v_mfma_f32_16x16x32_bf16 v[92:95], v[172:175], v[136:139], v[92:95]
  ds_read_b64_tr_b16 v[198:199], v236 offset:288
  v_cvt_pk_bf16_f32 v32, v32, v33
  v_mfma_f32_16x16x32_bf16 v[112:115], v[160:163], v[140:143], v[112:115]
  v_cvt_pk_bf16_f32 v33, v34, v35
  v_mfma_f32_16x16x32_bf16 v[116:119], v[164:167], v[140:143], v[116:119]
  v_cvt_pk_bf16_f32 v34, v36, v37
  v_mfma_f32_16x16x32_bf16 v[120:123], v[168:171], v[140:143], v[120:123]
  v_cvt_pk_bf16_f32 v35, v38, v39
  v_mfma_f32_16x16x32_bf16 v[124:127], v[172:175], v[140:143], v[124:127]
  buffer_store_dwordx4 v[32:35], v224, s[20:23], s7 offen offset:256 sc1
  s_waitcnt lgkmcnt(0)
  v_mfma_f32_16x16x32_bf16 v[16:19], v[176:179], v[144:147], v[16:19]
  ds_read_b128 v[128:131], v216 offset:0
  v_cvt_pk_bf16_f32 v8, v8, v9
  v_mfma_f32_16x16x32_bf16 v[20:23], v[180:183], v[144:147], v[20:23]
  ds_read_b64_tr_b16 v[160:161], v218 offset:1024
  v_cvt_pk_bf16_f32 v9, v10, v11
  v_mfma_f32_16x16x32_bf16 v[24:27], v[184:187], v[144:147], v[24:27]
  ds_read_b64_tr_b16 v[162:163], v218 offset:1536
  v_cvt_pk_bf16_f32 v10, v12, v13
  v_mfma_f32_16x16x32_bf16 v[28:31], v[188:191], v[144:147], v[28:31]
  ds_read_b128 v[132:135], v216 offset:2048
  v_cvt_pk_bf16_f32 v11, v14, v15
  v_mfma_f32_16x16x32_bf16 v[48:51], v[176:179], v[148:151], v[48:51]
  ds_read_b64_tr_b16 v[164:165], v219 offset:1024
  s_mul_i32 s7, s31, 1
  v_mfma_f32_16x16x32_bf16 v[52:55], v[180:183], v[148:151], v[52:55]
  ds_read_b64_tr_b16 v[166:167], v219 offset:1536
  s_add_u32 s7, s7, s30
  v_mfma_f32_16x16x32_bf16 v[56:59], v[184:187], v[148:151], v[56:59]
  ds_read_b128 v[136:139], v216 offset:4096
  buffer_store_dwordx4 v[8:11], v224, s[20:23], s7 offen sc1
  v_mfma_f32_16x16x32_bf16 v[60:63], v[188:191], v[148:151], v[60:63]
  ds_read_b64_tr_b16 v[168:169], v220 offset:1024
  v_cvt_pk_bf16_f32 v40, v40, v41
  v_mfma_f32_16x16x32_bf16 v[80:83], v[176:179], v[152:155], v[80:83]
  ds_read_b64_tr_b16 v[170:171], v220 offset:1536
  v_cvt_pk_bf16_f32 v41, v42, v43
  v_mfma_f32_16x16x32_bf16 v[84:87], v[180:183], v[152:155], v[84:87]
  ds_read_b128 v[140:143], v216 offset:6144
  v_cvt_pk_bf16_f32 v42, v44, v45
  v_mfma_f32_16x16x32_bf16 v[200:203], v[152:155], v[192:195], v[200:203]
  ds_read_b64_tr_b16 v[172:173], v221 offset:1024
  v_cvt_pk_bf16_f32 v43, v46, v47
  v_mfma_f32_16x16x32_bf16 v[88:91], v[184:187], v[152:155], v[88:91]
  ds_read_b64_tr_b16 v[174:175], v221 offset:1536
  buffer_store_dwordx4 v[40:43], v224, s[20:23], s7 offen offset:256 sc1
  v_mfma_f32_16x16x32_bf16 v[208:211], v[152:155], v[196:199], v[208:211]
  v_cvt_pk_bf16_f32 v64, v64, v65
  v_mfma_f32_16x16x32_bf16 v[92:95], v[188:191], v[152:155], v[92:95]
  v_cvt_pk_bf16_f32 v65, v66, v67
  v_mfma_f32_16x16x32_bf16 v[204:207], v[156:159], v[192:195], v[204:207]
  v_cvt_pk_bf16_f32 v66, v68, v69
  v_mfma_f32_16x16x32_bf16 v[112:115], v[176:179], v[156:159], v[112:115]
  v_cvt_pk_bf16_f32 v67, v70, v71
  v_mfma_f32_16x16x32_bf16 v[212:215], v[156:159], v[196:199], v[212:215]
  s_mul_i32 s7, s31, 0
  v_mfma_f32_16x16x32_bf16 v[116:119], v[180:183], v[156:159], v[116:119]
  s_add_u32 s7, s7, s30
  v_mfma_f32_16x16x32_bf16 v[120:123], v[184:187], v[156:159], v[120:123]
  s_add_u32 s7, s7, s32
  v_mfma_f32_16x16x32_bf16 v[124:127], v[188:191], v[156:159], v[124:127]
  buffer_store_dwordx4 v[64:67], v224, s[20:23], s7 offen sc1
  s_waitcnt lgkmcnt(0)
  v_mfma_f32_16x16x32_bf16 v[16:19], v[160:163], v[128:131], v[16:19]
  ds_read_b128 v[144:147], v217 offset:0
  v_cvt_pk_bf16_f32 v96, v96, v97
  v_mfma_f32_16x16x32_bf16 v[20:23], v[164:167], v[128:131], v[20:23]
  ds_read_b64_tr_b16 v[176:177], v218 offset:17408
  v_cvt_pk_bf16_f32 v97, v98, v99
  v_mfma_f32_16x16x32_bf16 v[24:27], v[168:171], v[128:131], v[24:27]
  ds_read_b64_tr_b16 v[178:179], v218 offset:17920
  v_cvt_pk_bf16_f32 v98, v100, v101
  v_mfma_f32_16x16x32_bf16 v[28:31], v[172:175], v[128:131], v[28:31]
  ds_read_b128 v[148:151], v217 offset:2048
  v_cvt_pk_bf16_f32 v99, v102, v103
  v_mfma_f32_16x16x32_bf16 v[48:51], v[160:163], v[132:135], v[48:51]
  ds_read_b64_tr_b16 v[180:181], v219 offset:17408
  buffer_store_dwordx4 v[96:99], v224, s[20:23], s7 offen offset:256 sc1
  v_mfma_f32_16x16x32_bf16 v[52:55], v[164:167], v[132:135], v[52:55]
  ds_read_b64_tr_b16 v[182:183], v219 offset:17920
  v_cvt_pk_bf16_f32 v72, v72, v73
  v_mfma_f32_16x16x32_bf16 v[56:59], v[168:171], v[132:135], v[56:59]
  ds_read_b128 v[152:155], v217 offset:4096
  v_cvt_pk_bf16_f32 v73, v74, v75
  v_mfma_f32_16x16x32_bf16 v[60:63], v[172:175], v[132:135], v[60:63]
  ds_read_b64_tr_b16 v[184:185], v220 offset:17408
  v_cvt_pk_bf16_f32 v74, v76, v77
  v_mfma_f32_16x16x32_bf16 v[80:83], v[160:163], v[136:139], v[80:83]
  ds_read_b64_tr_b16 v[186:187], v220 offset:17920
  v_cvt_pk_bf16_f32 v75, v78, v79
  v_mfma_f32_16x16x32_bf16 v[84:87], v[164:167], v[136:139], v[84:87]
  ds_read_b128 v[156:159], v217 offset:6144
  s_mul_i32 s7, s31, 1
  v_mfma_f32_16x16x32_bf16 v[88:91], v[168:171], v[136:139], v[88:91]
  ds_read_b64_tr_b16 v[188:189], v221 offset:17408
  s_add_u32 s7, s7, s30
  v_mfma_f32_16x16x32_bf16 v[92:95], v[172:175], v[136:139], v[92:95]
  ds_read_b64_tr_b16 v[190:191], v221 offset:17920
  s_add_u32 s7, s7, s32
  v_mfma_f32_16x16x32_bf16 v[112:115], v[160:163], v[140:143], v[112:115]
  ds_read_b64_tr_b16 v[192:193], v222 offset:0
  buffer_store_dwordx4 v[72:75], v224, s[20:23], s7 offen sc1
  v_mfma_f32_16x16x32_bf16 v[116:119], v[164:167], v[140:143], v[116:119]
  ds_read_b64_tr_b16 v[194:195], v222 offset:256
  v_cvt_pk_bf16_f32 v104, v104, v105
  v_mfma_f32_16x16x32_bf16 v[120:123], v[168:171], v[140:143], v[120:123]
  ds_read_b64_tr_b16 v[196:197], v222 offset:32
  v_cvt_pk_bf16_f32 v105, v106, v107
  v_mfma_f32_16x16x32_bf16 v[124:127], v[172:175], v[140:143], v[124:127]
  ds_read_b64_tr_b16 v[198:199], v222 offset:288
  v_cvt_pk_bf16_f32 v106, v108, v109
  s_waitcnt lgkmcnt(0)
  v_mfma_f32_16x16x32_bf16 v[16:19], v[176:179], v[144:147], v[16:19]
  v_cvt_pk_bf16_f32 v107, v110, v111
  v_mfma_f32_16x16x32_bf16 v[20:23], v[180:183], v[144:147], v[20:23]
  buffer_store_dwordx4 v[104:107], v224, s[20:23], s7 offen offset:256 sc1
  v_mfma_f32_16x16x32_bf16 v[24:27], v[184:187], v[144:147], v[24:27]
  v_mfma_f32_16x16x32_bf16 v[28:31], v[188:191], v[144:147], v[28:31]
  v_mfma_f32_16x16x32_bf16 v[48:51], v[176:179], v[148:151], v[48:51]
  v_mfma_f32_16x16x32_bf16 v[52:55], v[180:183], v[148:151], v[52:55]
  v_mfma_f32_16x16x32_bf16 v[56:59], v[184:187], v[148:151], v[56:59]
  v_mfma_f32_16x16x32_bf16 v[60:63], v[188:191], v[148:151], v[60:63]
  v_mfma_f32_16x16x32_bf16 v[80:83], v[176:179], v[152:155], v[80:83]
  v_mfma_f32_16x16x32_bf16 v[84:87], v[180:183], v[152:155], v[84:87]
  v_mfma_f32_16x16x32_bf16 v[200:203], v[152:155], v[192:195], v[200:203]
  v_mfma_f32_16x16x32_bf16 v[88:91], v[184:187], v[152:155], v[88:91]
  v_mfma_f32_16x16x32_bf16 v[208:211], v[152:155], v[196:199], v[208:211]
  v_mfma_f32_16x16x32_bf16 v[92:95], v[188:191], v[152:155], v[92:95]
  v_mfma_f32_16x16x32_bf16 v[204:207], v[156:159], v[192:195], v[204:207]
  v_mfma_f32_16x16x32_bf16 v[112:115], v[176:179], v[156:159], v[112:115]
  v_mfma_f32_16x16x32_bf16 v[212:215], v[156:159], v[196:199], v[212:215]
  v_mfma_f32_16x16x32_bf16 v[116:119], v[180:183], v[156:159], v[116:119]
  v_mfma_f32_16x16x32_bf16 v[120:123], v[184:187], v[156:159], v[120:123]
  v_mfma_f32_16x16x32_bf16 v[124:127], v[188:191], v[156:159], v[124:127]
  s_nop 7
  s_lshl_b32 s7, s24, 12
  s_add_u32 s7, s7, 53248
  v_add_u32 v226, s7, v223
  ds_write_b128 v226, v[200:203] offset:0
  ds_write_b128 v226, v[204:207] offset:1024
  ds_write_b128 v226, v[208:211] offset:2048
  ds_write_b128 v226, v[212:215] offset:3072
  v_cvt_pk_bf16_f32 v16, v16, v17
  v_cvt_pk_bf16_f32 v17, v18, v19
  v_cvt_pk_bf16_f32 v18, v20, v21
  v_cvt_pk_bf16_f32 v19, v22, v23
  s_mul_i32 s7, s31, 2
  s_add_u32 s7, s7, s30
  buffer_store_dwordx4 v[16:19], v224, s[20:23], s7 offen sc1
  v_cvt_pk_bf16_f32 v48, v48, v49
  v_cvt_pk_bf16_f32 v49, v50, v51
  v_cvt_pk_bf16_f32 v50, v52, v53
  v_cvt_pk_bf16_f32 v51, v54, v55
  buffer_store_dwordx4 v[48:51], v224, s[20:23], s7 offen offset:256 sc1
  v_cvt_pk_bf16_f32 v24, v24, v25
  v_cvt_pk_bf16_f32 v25, v26, v27
  v_cvt_pk_bf16_f32 v26, v28, v29
  v_cvt_pk_bf16_f32 v27, v30, v31
  s_mul_i32 s7, s31, 3
  s_add_u32 s7, s7, s30
  buffer_store_dwordx4 v[24:27], v224, s[20:23], s7 offen sc1
  v_cvt_pk_bf16_f32 v56, v56, v57
  v_cvt_pk_bf16_f32 v57, v58, v59
  v_cvt_pk_bf16_f32 v58, v60, v61
  v_cvt_pk_bf16_f32 v59, v62, v63
  buffer_store_dwordx4 v[56:59], v224, s[20:23], s7 offen offset:256 sc1
  v_cvt_pk_bf16_f32 v80, v80, v81
  v_cvt_pk_bf16_f32 v81, v82, v83
  v_cvt_pk_bf16_f32 v82, v84, v85
  v_cvt_pk_bf16_f32 v83, v86, v87
  s_mul_i32 s7, s31, 2
  s_add_u32 s7, s7, s30
  s_add_u32 s7, s7, s32
  buffer_store_dwordx4 v[80:83], v224, s[20:23], s7 offen sc1
  v_cvt_pk_bf16_f32 v112, v112, v113
  v_cvt_pk_bf16_f32 v113, v114, v115
  v_cvt_pk_bf16_f32 v114, v116, v117
  v_cvt_pk_bf16_f32 v115, v118, v119
  buffer_store_dwordx4 v[112:115], v224, s[20:23], s7 offen offset:256 sc1
  v_cvt_pk_bf16_f32 v88, v88, v89
  v_cvt_pk_bf16_f32 v89, v90, v91
  v_cvt_pk_bf16_f32 v90, v92, v93
  v_cvt_pk_bf16_f32 v91, v94, v95
  s_mul_i32 s7, s31, 3
  s_add_u32 s7, s7, s30
  s_add_u32 s7, s7, s32
  buffer_store_dwordx4 v[88:91], v224, s[20:23], s7 offen sc1
  v_cvt_pk_bf16_f32 v120, v120, v121
  v_cvt_pk_bf16_f32 v121, v122, v123
  v_cvt_pk_bf16_f32 v122, v124, v125
  v_cvt_pk_bf16_f32 v123, v126, v127
  buffer_store_dwordx4 v[120:123], v224, s[20:23], s7 offen offset:256 sc1
  s_waitcnt lgkmcnt(0)
  s_barrier
  s_endpgm
p1_exit:
  s_endpgm
  .globl p2_kernel
  .p2align 8
  .type p2_kernel,@function
p2_kernel:
  s_cmp_ge_u32 s2, 256
  s_cbranch_scc1 p2_exit
  s_load_dwordx2 s[8:9], s[0:1], 80
  v_lshrrev_b32 v1, 6, v0
  v_and_b32 v0, 63, v0
  v_readfirstlane_b32 s3, v1
  s_and_b32 s7, s2, 7
  s_lshr_b32 s5, s2, 3
  s_and_b32 s4, s5, 3
  s_lshl_b32 s7, s7, 2
  s_add_u32 s4, s4, s7
  s_lshr_b32 s5, s5, 2
  s_mov_b32 s10, 0x2000000
  s_mov_b32 s11, 0x20000
  v_lshlrev_b32 v188, 4, v0
  s_cmp_ge_u32 s3, 4
  s_cbranch_scc1 p2_loader
  v_mov_b32 v192, v0
  s_lshl_b32 s12, s5, 3
  s_lshl_b32 s7, s3, 1
  s_add_u32 s12, s12, s7
  s_lshl_b32 s13, s4, 17
  s_lshl_b32 s7, s12, 11
  s_add_u32 s13, s13, s7
  s_add_u32 s14, s13, 12582912
  s_mov_b32 s18, 16777216
  s_waitcnt lgkmcnt(0)
  buffer_load_dwordx4 v[88:91], v188, s[8:11], s14 offen offset:0
  buffer_load_dwordx4 v[92:95], v188, s[8:11], s14 offen offset:1024
  buffer_load_dwordx4 v[120:123], v188, s[8:11], s18 offen offset:0
  buffer_load_dwordx4 v[124:127], v188, s[8:11], s18 offen offset:1024
  buffer_load_dwordx4 v[96:99], v188, s[8:11], s14 offen offset:2048
  buffer_load_dwordx4 v[100:103], v188, s[8:11], s14 offen offset:3072
  v_add_u32 v189, 65536, v188
  s_lshl_b32 s7, s3, 13
  s_add_u32 s7, s7, 0
  v_add_u32 v190, s7, v188
  s_lshl_b32 s7, s3, 12
  s_add_u32 s7, s7, 131072
  v_add_u32 v191, s7, v188
  v_and_b32 v193, 15, v192
  v_lshrrev_b32 v194, 4, v192
  v_and_b32 v194, 1, v194
  v_lshlrev_b32 v194, 2, v194
  v_and_b32 v195, 7, v193
  v_cmp_eq_u32 vcc, v194, v195
  v_mov_b32 v196, 0x3f803f80
  v_and_b32 v197, 31, v192
  v_cndmask_b32 v136, 0, v196, vcc
  v_lshrrev_b32 v198, 5, v192
  v_lshlrev_b32 v198, 2, v198
  v_sub_u32 v197, v197, v198
  v_mov_b32 v137, v136
  v_mov_b32 v138, v136
  v_mov_b32 v139, v136
  v_mov_b32 v196, 0xff800000
  v_cmp_le_i32 s[24:25], 0, v197
  v_cmp_le_i32 s[26:27], 1, v197
  s_nop 0
  v_cndmask_b32 v140, v196, 0, s[24:25]
  v_cndmask_b32 v156, 0, v196, s[24:25]
  v_cndmask_b32 v141, v196, 0, s[26:27]
  v_cndmask_b32 v157, 0, v196, s[26:27]
  v_cmp_le_i32 s[24:25], 2, v197
  v_cmp_le_i32 s[26:27], 3, v197
  s_nop 0
  v_cndmask_b32 v142, v196, 0, s[24:25]
  v_cndmask_b32 v158, 0, v196, s[24:25]
  v_cndmask_b32 v143, v196, 0, s[26:27]
  v_cndmask_b32 v159, 0, v196, s[26:27]
  v_cmp_le_i32 s[24:25], 16, v197
  v_cmp_le_i32 s[26:27], 17, v197
  s_nop 0
  v_cndmask_b32 v144, v196, 0, s[24:25]
  v_cndmask_b32 v160, 0, v196, s[24:25]
  v_cndmask_b32 v145, v196, 0, s[26:27]
  v_cndmask_b32 v161, 0, v196, s[26:27]
  v_cmp_le_i32 s[24:25], 18, v197
  v_cmp_le_i32 s[26:27], 19, v197
  s_nop 0
  v_cndmask_b32 v146, v196, 0, s[24:25]
  v_cndmask_b32 v162, 0, v196, s[24:25]
  v_cndmask_b32 v147, v196, 0, s[26:27]
  v_cndmask_b32 v163, 0, v196, s[26:27]
  v_cmp_le_i32 s[24:25], 8, v197
  v_cmp_le_i32 s[26:27], 9, v197
  s_nop 0
  v_cndmask_b32 v148, v196, 0, s[24:25]
  v_cndmask_b32 v164, 0, v196, s[24:25]
  v_cndmask_b32 v149, v196, 0, s[26:27]
  v_cndmask_b32 v165, 0, v196, s[26:27]
  v_cmp_le_i32 s[24:25], 10, v197
  v_cmp_le_i32 s[26:27], 11, v197
  s_nop 0
  v_cndmask_b32 v150, v196, 0, s[24:25]
  v_cndmask_b32 v166, 0, v196, s[24:25]
  v_cndmask_b32 v151, v196, 0, s[26:27]
  v_cndmask_b32 v167, 0, v196, s[26:27]
  v_cmp_le_i32 s[24:25], 24, v197
  v_cmp_le_i32 s[26:27], 25, v197
  s_nop 0
  v_cndmask_b32 v152, v196, 0, s[24:25]
  v_cndmask_b32 v168, 0, v196, s[24:25]
  v_cndmask_b32 v153, v196, 0, s[26:27]
  v_cndmask_b32 v169, 0, v196, s[26:27]
  v_cmp_le_i32 s[24:25], 26, v197
  v_cmp_le_i32 s[26:27], 27, v197
  s_nop 0
  v_cndmask_b32 v154, v196, 0, s[24:25]
  v_cndmask_b32 v170, 0, v196, s[24:25]
  v_cndmask_b32 v155, v196, 0, s[26:27]
  v_cndmask_b32 v171, 0, v196, s[26:27]
  v_mov_b32 v48, 0
  v_mov_b32 v49, 0
  v_mov_b32 v50, 0
  v_mov_b32 v51, 0
  v_mov_b32 v52, 0
  v_mov_b32 v53, 0
  v_mov_b32 v54, 0
  v_mov_b32 v55, 0
  v_mov_b32 v56, 0
  v_mov_b32 v57, 0
  v_mov_b32 v58, 0
  v_mov_b32 v59, 0
  v_mov_b32 v60, 0
  v_mov_b32 v61, 0
  v_mov_b32 v62, 0
  v_mov_b32 v63, 0
  v_mov_b32 v80, 0
  v_mov_b32 v81, 0
  v_mov_b32 v82, 0
  v_mov_b32 v83, 0
  v_mov_b32 v64, 0
  v_mov_b32 v65, 0
  v_mov_b32 v66, 0
  v_mov_b32 v67, 0
  v_mov_b32 v68, 0
  v_mov_b32 v69, 0
  v_mov_b32 v70, 0
  v_mov_b32 v71, 0
  v_mov_b32 v72, 0
  v_mov_b32 v73, 0
  v_mov_b32 v74, 0
  v_mov_b32 v75, 0
  v_mov_b32 v76, 0
  v_mov_b32 v77, 0
  v_mov_b32 v78, 0
  v_mov_b32 v79, 0
  v_mov_b32 v84, 0
  v_mov_b32 v85, 0
  v_mov_b32 v86, 0
  v_mov_b32 v87, 0
  v_mov_b32 v240, 0
  v_mov_b32 v241, 0
  v_mov_b32 v242, 0
  v_mov_b32 v243, 0
  s_waitcnt vmcnt(0)
  s_barrier
  ds_read_b128 v[104:107], v189 offset:2048
  ds_read_b128 v[112:115], v189 offset:0
  ds_read_b128 v[108:111], v189 offset:3072
  ds_read_b128 v[116:119], v189 offset:1024
  v_mfma_f32_32x32x16_bf16 v[0:15], v[120:123], v[88:91], 0
  v_mfma_f32_32x32x16_bf16 v[0:15], v[124:127], v[92:95], v[0:15]
  s_nop 7
  s_nop 3
  v_mfma_f32_32x32x16_bf16 v[16:31], v[120:123], v[96:99], 0
  v_exp_f32 v0, v0
  v_exp_f32 v1, v1
  v_exp_f32 v2, v2
  v_exp_f32 v3, v3
  v_cvt_pk_bf16_f32 v32, v0, v1
  v_exp_f32 v4, v4
  v_exp_f32 v5, v5
  v_cvt_pk_bf16_f32 v33, v2, v3
  v_mfma_f32_32x32x16_bf16 v[16:31], v[124:127], v[100:103], v[16:31]
  v_exp_f32 v6, v6
  v_exp_f32 v7, v7
  v_cvt_pk_bf16_f32 v34, v4, v5
  v_exp_f32 v8, v8
  v_exp_f32 v9, v9
  v_cvt_pk_bf16_f32 v35, v6, v7
  v_exp_f32 v10, v10
  v_exp_f32 v11, v11
  v_cvt_pk_bf16_f32 v36, v8, v9
  v_exp_f32 v12, v12
  v_exp_f32 v13, v13
  v_cvt_pk_bf16_f32 v37, v10, v11
  v_exp_f32 v14, v14
  v_exp_f32 v15, v15
  v_cvt_pk_bf16_f32 v38, v12, v13
  v_cvt_pk_bf16_f32 v39, v14, v15
  s_mov_b32 s20, 0
  s_mov_b32 s21, 15
  s_mov_b32 s37, -49152
  s_mov_b32 s38, 16384
  .p2align 6
p2_bloop:
  s_waitcnt lgkmcnt(0)
  v_mfma_f32_32x32x16_bf16 v[0:15], v[104:107], v[88:91], 0
  ds_read_b128 v[120:123], v189 offset:6144
  v_exp_f32 v16, v16
  v_exp_f32 v17, v17
  v_exp_f32 v18, v18
  v_exp_f32 v19, v19
  v_mfma_f32_32x32x16_bf16 v[48:63], v[112:115], v[32:35], v[48:63]
  ds_read_b128 v[128:131], v189 offset:4096
  v_cvt_pk_bf16_f32 v40, v16, v17
  v_exp_f32 v20, v20
  v_exp_f32 v21, v21
  v_cvt_pk_bf16_f32 v41, v18, v19
  v_mfma_f32_16x16x32_bf16 v[80:83], v[136:139], v[32:35], v[80:83]
  ds_read_b128 v[124:127], v189 offset:7168
  v_exp_f32 v22, v22
  v_exp_f32 v23, v23
  v_cvt_pk_bf16_f32 v42, v20, v21
  v_exp_f32 v24, v24
  v_mfma_f32_32x32x16_bf16 v[0:15], v[108:111], v[92:95], v[0:15]
  ds_read_b128 v[132:135], v189 offset:5120
  v_exp_f32 v25, v25
  v_cvt_pk_bf16_f32 v43, v22, v23
  v_exp_f32 v26, v26
  v_exp_f32 v27, v27
  v_mfma_f32_32x32x16_bf16 v[48:63], v[116:119], v[36:39], v[48:63]
  v_cvt_pk_bf16_f32 v44, v24, v25
  v_exp_f32 v28, v28
  v_exp_f32 v29, v29
  v_cvt_pk_bf16_f32 v45, v26, v27
  v_mfma_f32_16x16x32_bf16 v[80:83], v[136:139], v[36:39], v[80:83]
  v_exp_f32 v30, v30
  v_exp_f32 v31, v31
  v_cvt_pk_bf16_f32 v46, v28, v29
  v_cvt_pk_bf16_f32 v47, v30, v31
  v_mfma_f32_32x32x16_bf16 v[16:31], v[104:107], v[96:99], 0
  v_exp_f32 v0, v0
  v_exp_f32 v1, v1
  v_exp_f32 v2, v2
  v_exp_f32 v3, v3
  v_mfma_f32_32x32x16_bf16 v[64:79], v[112:115], v[40:43], v[64:79]
  v_cvt_pk_bf16_f32 v32, v0, v1
  v_exp_f32 v4, v4
  v_exp_f32 v5, v5
  v_cvt_pk_bf16_f32 v33, v2, v3
  v_mfma_f32_16x16x32_bf16 v[84:87], v[136:139], v[40:43], v[84:87]
  v_exp_f32 v6, v6
  v_exp_f32 v7, v7
  v_cvt_pk_bf16_f32 v34, v4, v5
  v_exp_f32 v8, v8
  v_mfma_f32_32x32x16_bf16 v[16:31], v[108:111], v[100:103], v[16:31]
  v_exp_f32 v9, v9
  v_cvt_pk_bf16_f32 v35, v6, v7
  v_exp_f32 v10, v10
  v_exp_f32 v11, v11
  v_mfma_f32_32x32x16_bf16 v[64:79], v[116:119], v[44:47], v[64:79]
  v_cvt_pk_bf16_f32 v36, v8, v9
  v_exp_f32 v12, v12
  v_exp_f32 v13, v13
  v_cvt_pk_bf16_f32 v37, v10, v11
  v_mfma_f32_16x16x32_bf16 v[84:87], v[136:139], v[44:47], v[84:87]
  v_exp_f32 v14, v14
  v_exp_f32 v15, v15
  v_cvt_pk_bf16_f32 v38, v12, v13
  v_cvt_pk_bf16_f32 v39, v14, v15
  s_waitcnt lgkmcnt(0)
  v_mfma_f32_32x32x16_bf16 v[0:15], v[120:123], v[88:91], 0
  ds_read_b128 v[104:107], v189 offset:10240
  v_exp_f32 v16, v16
  v_exp_f32 v17, v17
  v_exp_f32 v18, v18
  v_exp_f32 v19, v19
  v_mfma_f32_32x32x16_bf16 v[48:63], v[128:131], v[32:35], v[48:63]
  ds_read_b128 v[112:115], v189 offset:8192
  v_cvt_pk_bf16_f32 v40, v16, v17
  v_exp_f32 v20, v20
  v_exp_f32 v21, v21
  v_cvt_pk_bf16_f32 v41, v18, v19
  v_mfma_f32_16x16x32_bf16 v[80:83], v[136:139], v[32:35], v[80:83]
  ds_read_b128 v[108:111], v189 offset:11264
  v_exp_f32 v22, v22
  v_exp_f32 v23, v23
  v_cvt_pk_bf16_f32 v42, v20, v21
  v_exp_f32 v24, v24
  v_mfma_f32_32x32x16_bf16 v[0:15], v[124:127], v[92:95], v[0:15]
  ds_read_b128 v[116:119], v189 offset:9216
  v_exp_f32 v25, v25
  v_cvt_pk_bf16_f32 v43, v22, v23
  v_exp_f32 v26, v26
  v_exp_f32 v27, v27
  v_mfma_f32_32x32x16_bf16 v[48:63], v[132:135], v[36:39], v[48:63]
  v_cvt_pk_bf16_f32 v44, v24, v25
  v_exp_f32 v28, v28
  v_exp_f32 v29, v29
  v_cvt_pk_bf16_f32 v45, v26, v27
  v_mfma_f32_16x16x32_bf16 v[80:83], v[136:139], v[36:39], v[80:83]
  v_exp_f32 v30, v30
  v_exp_f32 v31, v31
  v_cvt_pk_bf16_f32 v46, v28, v29
  v_cvt_pk_bf16_f32 v47, v30, v31
  v_mfma_f32_32x32x16_bf16 v[16:31], v[120:123], v[96:99], 0
  s_add_u32 s20, s20, 1
  v_exp_f32 v0, v0
  v_exp_f32 v1, v1
  v_exp_f32 v2, v2
  v_exp_f32 v3, v3
  v_mfma_f32_32x32x16_bf16 v[64:79], v[128:131], v[40:43], v[64:79]
  s_cmp_eq_u32 s20, 4
  v_cvt_pk_bf16_f32 v32, v0, v1
  v_exp_f32 v4, v4
  v_exp_f32 v5, v5
  v_cvt_pk_bf16_f32 v33, v2, v3
  v_mfma_f32_16x16x32_bf16 v[84:87], v[136:139], v[40:43], v[84:87]
  s_cselect_b32 s22, s37, s38
  v_exp_f32 v6, v6
  v_exp_f32 v7, v7
  v_cvt_pk_bf16_f32 v34, v4, v5
  v_exp_f32 v8, v8
  v_mfma_f32_32x32x16_bf16 v[16:31], v[124:127], v[100:103], v[16:31]
  s_cselect_b32 s20, 0, s20
  v_exp_f32 v9, v9
  v_cvt_pk_bf16_f32 v35, v6, v7
  v_exp_f32 v10, v10
  v_exp_f32 v11, v11
  v_mfma_f32_32x32x16_bf16 v[64:79], v[132:135], v[44:47], v[64:79]
  v_cvt_pk_bf16_f32 v36, v8, v9
  v_exp_f32 v12, v12
  v_exp_f32 v13, v13
  v_cvt_pk_bf16_f32 v37, v10, v11
  v_mfma_f32_16x16x32_bf16 v[84:87], v[136:139], v[44:47], v[84:87]
  v_exp_f32 v14, v14
  v_exp_f32 v15, v15
  v_cvt_pk_bf16_f32 v38, v12, v13
  v_cvt_pk_bf16_f32 v39, v14, v15
  s_waitcnt lgkmcnt(0)
  v_mfma_f32_32x32x16_bf16 v[0:15], v[104:107], v[88:91], 0
  ds_read_b128 v[120:123], v189 offset:14336
  v_exp_f32 v16, v16
  v_exp_f32 v17, v17
  v_exp_f32 v18, v18
  v_exp_f32 v19, v19
  v_mfma_f32_32x32x16_bf16 v[48:63], v[112:115], v[32:35], v[48:63]
  ds_read_b128 v[128:131], v189 offset:12288
  v_cvt_pk_bf16_f32 v40, v16, v17
  v_exp_f32 v20, v20
  v_exp_f32 v21, v21
  v_cvt_pk_bf16_f32 v41, v18, v19
  v_mfma_f32_16x16x32_bf16 v[80:83], v[136:139], v[32:35], v[80:83]
  ds_read_b128 v[124:127], v189 offset:15360
  v_exp_f32 v22, v22
  v_exp_f32 v23, v23
  v_cvt_pk_bf16_f32 v42, v20, v21
  v_exp_f32 v24, v24
  v_mfma_f32_32x32x16_bf16 v[0:15], v[108:111], v[92:95], v[0:15]
  ds_read_b128 v[132:135], v189 offset:13312
  v_exp_f32 v25, v25
  v_cvt_pk_bf16_f32 v43, v22, v23
  v_exp_f32 v26, v26
  v_exp_f32 v27, v27
  v_mfma_f32_32x32x16_bf16 v[48:63], v[116:119], v[36:39], v[48:63]
  v_cvt_pk_bf16_f32 v44, v24, v25
  v_exp_f32 v28, v28
  v_exp_f32 v29, v29
  v_cvt_pk_bf16_f32 v45, v26, v27
  v_mfma_f32_16x16x32_bf16 v[80:83], v[136:139], v[36:39], v[80:83]
  v_exp_f32 v30, v30
  v_exp_f32 v31, v31
  v_cvt_pk_bf16_f32 v46, v28, v29
  v_cvt_pk_bf16_f32 v47, v30, v31
  v_mfma_f32_32x32x16_bf16 v[16:31], v[104:107], v[96:99], 0
  v_exp_f32 v0, v0
  v_exp_f32 v1, v1
  v_exp_f32 v2, v2
  v_exp_f32 v3, v3
  v_mfma_f32_32x32x16_bf16 v[64:79], v[112:115], v[40:43], v[64:79]
  v_cvt_pk_bf16_f32 v32, v0, v1
  v_exp_f32 v4, v4
  v_exp_f32 v5, v5
  v_cvt_pk_bf16_f32 v33, v2, v3
  v_mfma_f32_16x16x32_bf16 v[84:87], v[136:139], v[40:43], v[84:87]
  v_exp_f32 v6, v6
  v_exp_f32 v7, v7
  v_cvt_pk_bf16_f32 v34, v4, v5
  v_exp_f32 v8, v8
  v_mfma_f32_32x32x16_bf16 v[16:31], v[108:111], v[100:103], v[16:31]
  v_exp_f32 v9, v9
  v_cvt_pk_bf16_f32 v35, v6, v7
  v_exp_f32 v10, v10
  v_exp_f32 v11, v11
  v_mfma_f32_32x32x16_bf16 v[64:79], v[116:119], v[44:47], v[64:79]
  v_cvt_pk_bf16_f32 v36, v8, v9
  v_exp_f32 v12, v12
  v_exp_f32 v13, v13
  v_cvt_pk_bf16_f32 v37, v10, v11
  v_mfma_f32_16x16x32_bf16 v[84:87], v[136:139], v[44:47], v[84:87]
  v_exp_f32 v14, v14
  v_exp_f32 v15, v15
  v_cvt_pk_bf16_f32 v38, v12, v13
  v_cvt_pk_bf16_f32 v39, v14, v15
  s_waitcnt lgkmcnt(0)
  s_barrier
  v_add_u32 v189, s22, v189
  v_mfma_f32_32x32x16_bf16 v[0:15], v[120:123], v[88:91], 0
  ds_read_b128 v[104:107], v189 offset:2048
  v_exp_f32 v16, v16
  v_exp_f32 v17, v17
  v_exp_f32 v18, v18
  v_exp_f32 v19, v19
  v_mfma_f32_32x32x16_bf16 v[48:63], v[128:131], v[32:35], v[48:63]
  ds_read_b128 v[112:115], v189 offset:0
  v_cvt_pk_bf16_f32 v40, v16, v17
  v_exp_f32 v20, v20
  v_exp_f32 v21, v21
  v_cvt_pk_bf16_f32 v41, v18, v19
  v_mfma_f32_16x16x32_bf16 v[80:83], v[136:139], v[32:35], v[80:83]
  ds_read_b128 v[108:111], v189 offset:3072
  v_exp_f32 v22, v22
  v_exp_f32 v23, v23
  v_cvt_pk_bf16_f32 v42, v20, v21
  v_exp_f32 v24, v24
  v_mfma_f32_32x32x16_bf16 v[0:15], v[124:127], v[92:95], v[0:15]
  ds_read_b128 v[116:119], v189 offset:1024
  v_exp_f32 v25, v25
  v_cvt_pk_bf16_f32 v43, v22, v23
  v_exp_f32 v26, v26
  v_exp_f32 v27, v27
  v_mfma_f32_32x32x16_bf16 v[48:63], v[132:135], v[36:39], v[48:63]
  v_cvt_pk_bf16_f32 v44, v24, v25
  v_exp_f32 v28, v28
  v_exp_f32 v29, v29
  v_cvt_pk_bf16_f32 v45, v26, v27
  v_mfma_f32_16x16x32_bf16 v[80:83], v[136:139], v[36:39], v[80:83]
  v_exp_f32 v30, v30
  v_exp_f32 v31, v31
  v_cvt_pk_bf16_f32 v46, v28, v29
  v_cvt_pk_bf16_f32 v47, v30, v31
  v_mfma_f32_32x32x16_bf16 v[16:31], v[120:123], v[96:99], 0
  s_sub_u32 s21, s21, 1
  v_exp_f32 v0, v0
  v_exp_f32 v1, v1
  v_exp_f32 v2, v2
  v_exp_f32 v3, v3
  v_mfma_f32_32x32x16_bf16 v[64:79], v[128:131], v[40:43], v[64:79]
  s_cmp_lg_u32 s21, 0
  v_cvt_pk_bf16_f32 v32, v0, v1
  v_exp_f32 v4, v4
  v_exp_f32 v5, v5
  v_cvt_pk_bf16_f32 v33, v2, v3
  v_mfma_f32_16x16x32_bf16 v[84:87], v[136:139], v[40:43], v[84:87]
  v_exp_f32 v6, v6
  v_exp_f32 v7, v7
  v_cvt_pk_bf16_f32 v34, v4, v5
  v_exp_f32 v8, v8
  v_mfma_f32_32x32x16_bf16 v[16:31], v[124:127], v[100:103], v[16:31]
  v_exp_f32 v9, v9
  v_cvt_pk_bf16_f32 v35, v6, v7
  v_exp_f32 v10, v10
  v_exp_f32 v11, v11
  v_mfma_f32_32x32x16_bf16 v[64:79], v[132:135], v[44:47], v[64:79]
  v_cvt_pk_bf16_f32 v36, v8, v9
  v_exp_f32 v12, v12
  v_exp_f32 v13, v13
  v_cvt_pk_bf16_f32 v37, v10, v11
  v_mfma_f32_16x16x32_bf16 v[84:87], v[136:139], v[44:47], v[84:87]
  v_exp_f32 v14, v14
  v_exp_f32 v15, v15
  v_cvt_pk_bf16_f32 v38, v12, v13
  v_cvt_pk_bf16_f32 v39, v14, v15
  s_cbranch_scc1 p2_bloop
  s_waitcnt lgkmcnt(0)
  v_mfma_f32_32x32x16_bf16 v[0:15], v[104:107], v[88:91], 0
  ds_read_b128 v[120:123], v189 offset:6144
  v_exp_f32 v16, v16
  v_exp_f32 v17, v17
  v_exp_f32 v18, v18
  v_exp_f32 v19, v19
  v_mfma_f32_32x32x16_bf16 v[48:63], v[112:115], v[32:35], v[48:63]
  ds_read_b128 v[128:131], v189 offset:4096
  v_cvt_pk_bf16_f32 v40, v16, v17
  v_exp_f32 v20, v20
  v_exp_f32 v21, v21
  v_cvt_pk_bf16_f32 v41, v18, v19
  v_mfma_f32_16x16x32_bf16 v[80:83], v[136:139], v[32:35], v[80:83]
  ds_read_b128 v[124:127], v189 offset:7168
  v_exp_f32 v22, v22
  v_exp_f32 v23, v23
  v_cvt_pk_bf16_f32 v42, v20, v21
  v_exp_f32 v24, v24
  v_mfma_f32_32x32x16_bf16 v[0:15], v[108:111], v[92:95], v[0:15]
  ds_read_b128 v[132:135], v189 offset:5120
  v_exp_f32 v25, v25
  v_cvt_pk_bf16_f32 v43, v22, v23
  v_exp_f32 v26, v26
  v_exp_f32 v27, v27
  v_mfma_f32_32x32x16_bf16 v[48:63], v[116:119], v[36:39], v[48:63]
  v_cvt_pk_bf16_f32 v44, v24, v25
  v_exp_f32 v28, v28
  v_exp_f32 v29, v29
  v_cvt_pk_bf16_f32 v45, v26, v27
  v_mfma_f32_16x16x32_bf16 v[80:83], v[136:139], v[36:39], v[80:83]
  v_exp_f32 v30, v30
  v_exp_f32 v31, v31
  v_cvt_pk_bf16_f32 v46, v28, v29
  v_cvt_pk_bf16_f32 v47, v30, v31
  v_mfma_f32_32x32x16_bf16 v[16:31], v[104:107], v[96:99], 0
  v_exp_f32 v0, v0
  v_exp_f32 v1, v1
  v_exp_f32 v2, v2
  v_exp_f32 v3, v3
  v_mfma_f32_32x32x16_bf16 v[64:79], v[112:115], v[40:43], v[64:79]
  v_cvt_pk_bf16_f32 v32, v0, v1
  v_exp_f32 v4, v4
  v_exp_f32 v5, v5
  v_cvt_pk_bf16_f32 v33, v2, v3
  v_mfma_f32_16x16x32_bf16 v[84:87], v[136:139], v[40:43], v[84:87]
  v_exp_f32 v6, v6
  v_exp_f32 v7, v7
  v_cvt_pk_bf16_f32 v34, v4, v5
  v_exp_f32 v8, v8
  v_mfma_f32_32x32x16_bf16 v[16:31], v[108:111], v[100:103], v[16:31]
  v_exp_f32 v9, v9
  v_cvt_pk_bf16_f32 v35, v6, v7
  v_exp_f32 v10, v10
  v_exp_f32 v11, v11
  v_mfma_f32_32x32x16_bf16 v[64:79], v[116:119], v[44:47], v[64:79]
  v_cvt_pk_bf16_f32 v36, v8, v9
  v_exp_f32 v12, v12
  v_exp_f32 v13, v13
  v_cvt_pk_bf16_f32 v37, v10, v11
  v_mfma_f32_16x16x32_bf16 v[84:87], v[136:139], v[44:47], v[84:87]
  v_exp_f32 v14, v14
  v_exp_f32 v15, v15
  v_cvt_pk_bf16_f32 v38, v12, v13
  v_cvt_pk_bf16_f32 v39, v14, v15
  s_waitcnt lgkmcnt(0)
  v_mfma_f32_32x32x16_bf16 v[0:15], v[120:123], v[88:91], 0
  ds_read_b128 v[104:107], v189 offset:10240
  v_exp_f32 v16, v16
  v_exp_f32 v17, v17
  v_exp_f32 v18, v18
  v_exp_f32 v19, v19
  v_mfma_f32_32x32x16_bf16 v[48:63], v[128:131], v[32:35], v[48:63]
  ds_read_b128 v[112:115], v189 offset:8192
  v_cvt_pk_bf16_f32 v40, v16, v17
  v_exp_f32 v20, v20
  v_exp_f32 v21, v21
  v_cvt_pk_bf16_f32 v41, v18, v19
  v_mfma_f32_16x16x32_bf16 v[80:83], v[136:139], v[32:35], v[80:83]
  ds_read_b128 v[108:111], v189 offset:11264
  v_exp_f32 v22, v22
  v_exp_f32 v23, v23
  v_cvt_pk_bf16_f32 v42, v20, v21
  v_exp_f32 v24, v24
  v_mfma_f32_32x32x16_bf16 v[0:15], v[124:127], v[92:95], v[0:15]
  ds_read_b128 v[116:119], v189 offset:9216
  v_exp_f32 v25, v25
  v_cvt_pk_bf16_f32 v43, v22, v23
  v_exp_f32 v26, v26
  v_exp_f32 v27, v27
  v_mfma_f32_32x32x16_bf16 v[48:63], v[132:135], v[36:39], v[48:63]
  v_cvt_pk_bf16_f32 v44, v24, v25
  v_exp_f32 v28, v28
  v_exp_f32 v29, v29
  v_cvt_pk_bf16_f32 v45, v26, v27
  v_mfma_f32_16x16x32_bf16 v[80:83], v[136:139], v[36:39], v[80:83]
  v_exp_f32 v30, v30
  v_exp_f32 v31, v31
  v_cvt_pk_bf16_f32 v46, v28, v29
  v_cvt_pk_bf16_f32 v47, v30, v31
  v_mfma_f32_32x32x16_bf16 v[16:31], v[120:123], v[96:99], 0
  v_exp_f32 v0, v0
  v_exp_f32 v1, v1
  v_exp_f32 v2, v2
  v_exp_f32 v3, v3
  v_mfma_f32_32x32x16_bf16 v[64:79], v[128:131], v[40:43], v[64:79]
  v_cvt_pk_bf16_f32 v32, v0, v1
  v_exp_f32 v4, v4
  v_exp_f32 v5, v5
  v_cvt_pk_bf16_f32 v33, v2, v3
  v_mfma_f32_16x16x32_bf16 v[84:87], v[136:139], v[40:43], v[84:87]
  v_exp_f32 v6, v6
  v_exp_f32 v7, v7
  v_cvt_pk_bf16_f32 v34, v4, v5
  v_exp_f32 v8, v8
  v_mfma_f32_32x32x16_bf16 v[16:31], v[124:127], v[100:103], v[16:31]
  v_exp_f32 v9, v9
  v_cvt_pk_bf16_f32 v35, v6, v7
  v_exp_f32 v10, v10
  v_exp_f32 v11, v11
  v_mfma_f32_32x32x16_bf16 v[64:79], v[132:135], v[44:47], v[64:79]
  v_cvt_pk_bf16_f32 v36, v8, v9
  v_exp_f32 v12, v12
  v_exp_f32 v13, v13
  v_cvt_pk_bf16_f32 v37, v10, v11
  v_mfma_f32_16x16x32_bf16 v[84:87], v[136:139], v[44:47], v[84:87]
  v_exp_f32 v14, v14
  v_exp_f32 v15, v15
  v_cvt_pk_bf16_f32 v38, v12, v13
  v_cvt_pk_bf16_f32 v39, v14, v15
  s_waitcnt lgkmcnt(0)
  v_mfma_f32_32x32x16_bf16 v[0:15], v[104:107], v[88:91], 0
  ds_read_b128 v[120:123], v189 offset:14336
  v_exp_f32 v16, v16
  v_exp_f32 v17, v17
  v_exp_f32 v18, v18
  v_exp_f32 v19, v19
  v_mfma_f32_32x32x16_bf16 v[48:63], v[112:115], v[32:35], v[48:63]
  ds_read_b128 v[128:131], v189 offset:12288
  v_cvt_pk_bf16_f32 v40, v16, v17
  v_exp_f32 v20, v20
  v_exp_f32 v21, v21
  v_cvt_pk_bf16_f32 v41, v18, v19
  v_mfma_f32_16x16x32_bf16 v[80:83], v[136:139], v[32:35], v[80:83]
  ds_read_b128 v[124:127], v189 offset:15360
  v_exp_f32 v22, v22
  v_exp_f32 v23, v23
  v_cvt_pk_bf16_f32 v42, v20, v21
  v_exp_f32 v24, v24
  v_mfma_f32_32x32x16_bf16 v[0:15], v[108:111], v[92:95], v[0:15]
  ds_read_b128 v[132:135], v189 offset:13312
  v_exp_f32 v25, v25
  v_cvt_pk_bf16_f32 v43, v22, v23
  v_exp_f32 v26, v26
  v_exp_f32 v27, v27
  v_mfma_f32_32x32x16_bf16 v[48:63], v[116:119], v[36:39], v[48:63]
  v_cvt_pk_bf16_f32 v44, v24, v25
  v_exp_f32 v28, v28
  v_exp_f32 v29, v29
  v_cvt_pk_bf16_f32 v45, v26, v27
  v_mfma_f32_16x16x32_bf16 v[80:83], v[136:139], v[36:39], v[80:83]
  v_exp_f32 v30, v30
  v_exp_f32 v31, v31
  v_cvt_pk_bf16_f32 v46, v28, v29
  v_cvt_pk_bf16_f32 v47, v30, v31
  v_mfma_f32_32x32x16_bf16 v[16:31], v[104:107], v[96:99], 0
  v_exp_f32 v0, v0
  v_exp_f32 v1, v1
  v_exp_f32 v2, v2
  v_exp_f32 v3, v3
  v_mfma_f32_32x32x16_bf16 v[64:79], v[112:115], v[40:43], v[64:79]
  v_cvt_pk_bf16_f32 v32, v0, v1
  v_exp_f32 v4, v4
  v_exp_f32 v5, v5
  v_cvt_pk_bf16_f32 v33, v2, v3
  v_mfma_f32_16x16x32_bf16 v[84:87], v[136:139], v[40:43], v[84:87]
  v_exp_f32 v6, v6
  v_exp_f32 v7, v7
  v_cvt_pk_bf16_f32 v34, v4, v5
  v_exp_f32 v8, v8
  v_mfma_f32_32x32x16_bf16 v[16:31], v[108:111], v[100:103], v[16:31]
  v_exp_f32 v9, v9
  v_cvt_pk_bf16_f32 v35, v6, v7
  v_exp_f32 v10, v10
  v_exp_f32 v11, v11
  v_mfma_f32_32x32x16_bf16 v[64:79], v[116:119], v[44:47], v[64:79]
  v_cvt_pk_bf16_f32 v36, v8, v9
  v_exp_f32 v12, v12
  v_exp_f32 v13, v13
  v_cvt_pk_bf16_f32 v37, v10, v11
  v_mfma_f32_16x16x32_bf16 v[84:87], v[136:139], v[44:47], v[84:87]
  v_exp_f32 v14, v14
  v_exp_f32 v15, v15
  v_cvt_pk_bf16_f32 v38, v12, v13
  v_cvt_pk_bf16_f32 v39, v14, v15
  s_waitcnt lgkmcnt(0)
  s_barrier
  v_exp_f32 v16, v16
  v_exp_f32 v17, v17
  v_exp_f32 v18, v18
  v_exp_f32 v19, v19
  v_mfma_f32_32x32x16_bf16 v[48:63], v[128:131], v[32:35], v[48:63]
  ds_read_b128 v[104:107], v190 offset:32768
  v_cvt_pk_bf16_f32 v40, v16, v17
  v_exp_f32 v20, v20
  v_exp_f32 v21, v21
  v_cvt_pk_bf16_f32 v41, v18, v19
  v_mfma_f32_16x16x32_bf16 v[80:83], v[136:139], v[32:35], v[80:83]
  ds_read_b128 v[112:115], v190 offset:38912
  v_exp_f32 v22, v22
  v_exp_f32 v23, v23
  v_cvt_pk_bf16_f32 v42, v20, v21
  v_exp_f32 v24, v24
  v_exp_f32 v25, v25
  v_cvt_pk_bf16_f32 v43, v22, v23
  v_mfma_f32_32x32x16_bf16 v[48:63], v[132:135], v[36:39], v[48:63]
  ds_read_b128 v[108:111], v190 offset:33792
  v_exp_f32 v26, v26
  v_exp_f32 v27, v27
  v_cvt_pk_bf16_f32 v44, v24, v25
  v_exp_f32 v28, v28
  v_mfma_f32_16x16x32_bf16 v[80:83], v[136:139], v[36:39], v[80:83]
  ds_read_b128 v[116:119], v190 offset:39936
  v_exp_f32 v29, v29
  v_cvt_pk_bf16_f32 v45, v26, v27
  v_exp_f32 v30, v30
  v_exp_f32 v31, v31
  v_cvt_pk_bf16_f32 v46, v28, v29
  v_cvt_pk_bf16_f32 v47, v30, v31
  ds_read_b128 v[120:123], v190 offset:36864
  ds_read_b128 v[124:127], v190 offset:37888
  ds_read_b128 v[172:175], v191 offset:0
  ds_read_b128 v[176:179], v191 offset:1024
  ds_read_b128 v[180:183], v191 offset:2048
  ds_read_b128 v[184:187], v191 offset:3072
  s_nop 1
  v_mfma_f32_32x32x16_bf16 v[64:79], v[128:131], v[40:43], v[64:79]
  v_mfma_f32_16x16x32_bf16 v[84:87], v[136:139], v[40:43], v[84:87]
  v_mfma_f32_32x32x16_bf16 v[64:79], v[132:135], v[44:47], v[64:79]
  v_mfma_f32_16x16x32_bf16 v[84:87], v[136:139], v[44:47], v[84:87]
  s_nop 7
  s_nop 7
  s_lshl_b32 s7, s12, 16
  s_lshl_b32 s19, s4, 11
  s_add_u32 s7, s7, s19
  s_add_u32 s7, s7, 25165824
  v_rcp_f32 v192, v80
  v_rcp_f32 v194, v84
  s_nop 0
  v_mov_b32 v193, v192
  v_mov_b32 v195, v194
  v_pk_mul_f32 v[48:49], v[48:49], v[192:193]
  v_pk_mul_f32 v[50:51], v[50:51], v[192:193]
  v_pk_mul_f32 v[52:53], v[52:53], v[192:193]
  v_pk_mul_f32 v[54:55], v[54:55], v[192:193]
  v_pk_mul_f32 v[56:57], v[56:57], v[192:193]
  v_pk_mul_f32 v[58:59], v[58:59], v[192:193]
  v_pk_mul_f32 v[60:61], v[60:61], v[192:193]
  v_pk_mul_f32 v[62:63], v[62:63], v[192:193]
  v_cvt_pk_bf16_f32 v48, v48, v49
  v_cvt_pk_bf16_f32 v49, v50, v51
  v_cvt_pk_bf16_f32 v50, v52, v53
  v_cvt_pk_bf16_f32 v51, v54, v55
  v_cvt_pk_bf16_f32 v52, v56, v57
  v_cvt_pk_bf16_f32 v53, v58, v59
  v_cvt_pk_bf16_f32 v54, v60, v61
  v_cvt_pk_bf16_f32 v55, v62, v63
  buffer_store_dwordx4 v[48:51], v188, s[8:11], s7 offen sc1
  buffer_store_dwordx4 v[52:55], v188, s[8:11], s7 offen offset:1024 sc1
  v_mfma_f32_16x16x32_bf16 v[244:247], v[240:243], v[48:51], 0
  v_mfma_f32_16x16x32_bf16 v[244:247], v[240:243], v[52:55], v[244:247]
  v_pk_mul_f32 v[64:65], v[64:65], v[194:195]
  v_pk_mul_f32 v[66:67], v[66:67], v[194:195]
  v_pk_mul_f32 v[68:69], v[68:69], v[194:195]
  v_pk_mul_f32 v[70:71], v[70:71], v[194:195]
  v_pk_mul_f32 v[72:73], v[72:73], v[194:195]
  v_pk_mul_f32 v[74:75], v[74:75], v[194:195]
  v_pk_mul_f32 v[76:77], v[76:77], v[194:195]
  v_pk_mul_f32 v[78:79], v[78:79], v[194:195]
  v_cvt_pk_bf16_f32 v64, v64, v65
  v_cvt_pk_bf16_f32 v65, v66, v67
  v_cvt_pk_bf16_f32 v66, v68, v69
  v_cvt_pk_bf16_f32 v67, v70, v71
  v_cvt_pk_bf16_f32 v68, v72, v73
  v_cvt_pk_bf16_f32 v69, v74, v75
  v_cvt_pk_bf16_f32 v70, v76, v77
  v_cvt_pk_bf16_f32 v71, v78, v79
  s_add_u32 s7, s7, 65536
  buffer_store_dwordx4 v[64:67], v188, s[8:11], s7 offen sc1
  buffer_store_dwordx4 v[68:71], v188, s[8:11], s7 offen offset:1024 sc1
  v_mfma_f32_16x16x32_bf16 v[244:247], v[240:243], v[64:67], v[244:247]
  v_mfma_f32_16x16x32_bf16 v[244:247], v[240:243], v[68:71], v[244:247]
  v_mov_b32 v196, 0x21800000
  v_mov_b32 v197, 0x5d800000
  v_cmp_gt_f32 s[26:27], v80, v196
  v_cmp_lt_f32 s[28:29], v80, v197
  s_nop 0
  s_and_b64 s[26:27], s[26:27], s[28:29]
  s_mov_b64 s[24:25], s[26:27]
  v_cmp_gt_f32 s[26:27], v84, v196
  v_cmp_lt_f32 s[28:29], v84, v197
  s_nop 0
  s_and_b64 s[26:27], s[26:27], s[28:29]
  s_and_b64 s[24:25], s[26:27], s[24:25]
  v_cmp_eq_f32 s[26:27], 0, v244
  s_nop 0
  s_and_b64 s[24:25], s[24:25], s[26:27]
  s_cmp_eq_u64 s[24:25], -1
  s_cbranch_scc0 p2_slowB
p2_backB:
  s_lshl_b32 s30, s3, 1
  s_cmp_eq_u32 s5, 0
  s_cselect_b32 s30, s30, -1
  s_waitcnt lgkmcnt(0)
  v_mfma_f32_32x32x16_bf16 v[16:31], v[120:123], v[180:183], v[140:155]
  v_mfma_f32_32x32x16_bf16 v[16:31], v[124:127], v[184:187], v[16:31]
  s_nop 7
  s_nop 3
  v_mfma_f32_32x32x16_bf16 v[0:15], v[104:107], v[172:175], v[140:155]
  ds_read_b128 v[120:123], v190 offset:28672
  v_exp_f32 v16, v16
  v_exp_f32 v17, v17
  v_exp_f32 v18, v18
  v_exp_f32 v19, v19
  v_cvt_pk_bf16_f32 v40, v16, v17
  v_exp_f32 v20, v20
  v_exp_f32 v21, v21
  v_cvt_pk_bf16_f32 v41, v18, v19
  v_mfma_f32_32x32x16_bf16 v[0:15], v[108:111], v[176:179], v[0:15]
  ds_read_b128 v[128:131], v190 offset:34816
  v_exp_f32 v22, v22
  v_exp_f32 v23, v23
  v_cvt_pk_bf16_f32 v42, v20, v21
  v_exp_f32 v24, v24
  v_exp_f32 v25, v25
  v_cvt_pk_bf16_f32 v43, v22, v23
  v_exp_f32 v26, v26
  v_exp_f32 v27, v27
  v_cvt_pk_bf16_f32 v44, v24, v25
  v_exp_f32 v28, v28
  v_exp_f32 v29, v29
  v_cvt_pk_bf16_f32 v45, v26, v27
  v_exp_f32 v30, v30
  v_exp_f32 v31, v31
  v_cvt_pk_bf16_f32 v46, v28, v29
  v_cvt_pk_bf16_f32 v47, v30, v31
  ds_read_b128 v[124:127], v190 offset:29696
  ds_read_b128 v[132:135], v190 offset:35840
  v_mfma_f32_32x32x16_bf16 v[16:31], v[104:107], v[180:183], 0
  v_exp_f32 v0, v0
  v_exp_f32 v1, v1
  v_exp_f32 v2, v2
  v_exp_f32 v3, v3
  v_mfma_f32_32x32x16_bf16 v[64:79], v[112:115], v[40:43], 0
  v_cvt_pk_bf16_f32 v32, v0, v1
  v_exp_f32 v4, v4
  v_exp_f32 v5, v5
  v_cvt_pk_bf16_f32 v33, v2, v3
  v_mfma_f32_16x16x32_bf16 v[84:87], v[136:139], v[40:43], 0
  v_exp_f32 v6, v6
  v_exp_f32 v7, v7
  v_cvt_pk_bf16_f32 v34, v4, v5
  v_exp_f32 v8, v8
  v_mfma_f32_32x32x16_bf16 v[16:31], v[108:111], v[184:187], v[16:31]
  v_exp_f32 v9, v9
  v_cvt_pk_bf16_f32 v35, v6, v7
  v_exp_f32 v10, v10
  v_exp_f32 v11, v11
  v_mfma_f32_32x32x16_bf16 v[64:79], v[116:119], v[44:47], v[64:79]
  v_cvt_pk_bf16_f32 v36, v8, v9
  v_exp_f32 v12, v12
  v_exp_f32 v13, v13
  v_cvt_pk_bf16_f32 v37, v10, v11
  v_mfma_f32_16x16x32_bf16 v[84:87], v[136:139], v[44:47], v[84:87]
  v_exp_f32 v14, v14
  v_exp_f32 v15, v15
  v_cvt_pk_bf16_f32 v38, v12, v13
  v_cvt_pk_bf16_f32 v39, v14, v15
  s_waitcnt lgkmcnt(0)
  v_mfma_f32_32x32x16_bf16 v[0:15], v[120:123], v[172:175], 0
  ds_read_b128 v[104:107], v190 offset:24576
  v_exp_f32 v16, v16
  v_exp_f32 v17, v17
  v_exp_f32 v18, v18
  v_exp_f32 v19, v19
  v_mfma_f32_32x32x16_bf16 v[48:63], v[128:131], v[32:35], 0
  ds_read_b128 v[112:115], v190 offset:30720
  v_cvt_pk_bf16_f32 v40, v16, v17
  v_exp_f32 v20, v20
  v_exp_f32 v21, v21
  v_cvt_pk_bf16_f32 v41, v18, v19
  v_mfma_f32_16x16x32_bf16 v[80:83], v[136:139], v[32:35], 0
  ds_read_b128 v[108:111], v190 offset:25600
  v_exp_f32 v22, v22
  v_exp_f32 v23, v23
  v_cvt_pk_bf16_f32 v42, v20, v21
  v_exp_f32 v24, v24
  v_mfma_f32_32x32x16_bf16 v[0:15], v[124:127], v[176:179], v[0:15]
  ds_read_b128 v[116:119], v190 offset:31744
  v_exp_f32 v25, v25
  v_cvt_pk_bf16_f32 v43, v22, v23
  v_exp_f32 v26, v26
  v_exp_f32 v27, v27
  v_mfma_f32_32x32x16_bf16 v[48:63], v[132:135], v[36:39], v[48:63]
  v_cvt_pk_bf16_f32 v44, v24, v25
  v_exp_f32 v28, v28
  v_exp_f32 v29, v29
  v_cvt_pk_bf16_f32 v45, v26, v27
  v_mfma_f32_16x16x32_bf16 v[80:83], v[136:139], v[36:39], v[80:83]
  v_exp_f32 v30, v30
  v_exp_f32 v31, v31
  v_cvt_pk_bf16_f32 v46, v28, v29
  v_cvt_pk_bf16_f32 v47, v30, v31
  s_cmp_eq_u32 s30, 0
  s_cbranch_scc1 p2_drainB
  v_mfma_f32_32x32x16_bf16 v[16:31], v[120:123], v[180:183], 0
  v_exp_f32 v0, v0
  v_exp_f32 v1, v1
  v_exp_f32 v2, v2
  v_exp_f32 v3, v3
  v_mfma_f32_32x32x16_bf16 v[64:79], v[128:131], v[40:43], v[64:79]
  v_cvt_pk_bf16_f32 v32, v0, v1
  v_exp_f32 v4, v4
  v_exp_f32 v5, v5
  v_cvt_pk_bf16_f32 v33, v2, v3
  v_mfma_f32_16x16x32_bf16 v[84:87], v[136:139], v[40:43], v[84:87]
  v_exp_f32 v6, v6
  v_exp_f32 v7, v7
  v_cvt_pk_bf16_f32 v34, v4, v5
  v_exp_f32 v8, v8
  v_mfma_f32_32x32x16_bf16 v[16:31], v[124:127], v[184:187], v[16:31]
  v_exp_f32 v9, v9
  v_cvt_pk_bf16_f32 v35, v6, v7
  v_exp_f32 v10, v10
  v_exp_f32 v11, v11
  v_mfma_f32_32x32x16_bf16 v[64:79], v[132:135], v[44:47], v[64:79]
  v_cvt_pk_bf16_f32 v36, v8, v9
  v_exp_f32 v12, v12
  v_exp_f32 v13, v13
  v_cvt_pk_bf16_f32 v37, v10, v11
  v_mfma_f32_16x16x32_bf16 v[84:87], v[136:139], v[44:47], v[84:87]
  v_exp_f32 v14, v14
  v_exp_f32 v15, v15
  v_cvt_pk_bf16_f32 v38, v12, v13
  v_cvt_pk_bf16_f32 v39, v14, v15
  s_waitcnt lgkmcnt(0)
  v_mfma_f32_32x32x16_bf16 v[0:15], v[104:107], v[172:175], 0
  ds_read_b128 v[120:123], v190 offset:20480
  v_exp_f32 v16, v16
  v_exp_f32 v17, v17
  v_exp_f32 v18, v18
  v_exp_f32 v19, v19
  v_mfma_f32_32x32x16_bf16 v[48:63], v[112:115], v[32:35], v[48:63]
  ds_read_b128 v[128:131], v190 offset:26624
  v_cvt_pk_bf16_f32 v40, v16, v17
  v_exp_f32 v20, v20
  v_exp_f32 v21, v21
  v_cvt_pk_bf16_f32 v41, v18, v19
  v_mfma_f32_16x16x32_bf16 v[80:83], v[136:139], v[32:35], v[80:83]
  ds_read_b128 v[124:127], v190 offset:21504
  v_exp_f32 v22, v22
  v_exp_f32 v23, v23
  v_cvt_pk_bf16_f32 v42, v20, v21
  v_exp_f32 v24, v24
  v_mfma_f32_32x32x16_bf16 v[0:15], v[108:111], v[176:179], v[0:15]
  ds_read_b128 v[132:135], v190 offset:27648
  v_exp_f32 v25, v25
  v_cvt_pk_bf16_f32 v43, v22, v23
  v_exp_f32 v26, v26
  v_exp_f32 v27, v27
  v_mfma_f32_32x32x16_bf16 v[48:63], v[116:119], v[36:39], v[48:63]
  v_cvt_pk_bf16_f32 v44, v24, v25
  v_exp_f32 v28, v28
  v_exp_f32 v29, v29
  v_cvt_pk_bf16_f32 v45, v26, v27
  v_mfma_f32_16x16x32_bf16 v[80:83], v[136:139], v[36:39], v[80:83]
  v_exp_f32 v30, v30
  v_exp_f32 v31, v31
  v_cvt_pk_bf16_f32 v46, v28, v29
  v_cvt_pk_bf16_f32 v47, v30, v31
  v_mfma_f32_32x32x16_bf16 v[16:31], v[104:107], v[180:183], 0
  v_exp_f32 v0, v0
  v_exp_f32 v1, v1
  v_exp_f32 v2, v2
  v_exp_f32 v3, v3
  v_mfma_f32_32x32x16_bf16 v[64:79], v[112:115], v[40:43], v[64:79]
  v_cvt_pk_bf16_f32 v32, v0, v1
  v_exp_f32 v4, v4
  v_exp_f32 v5, v5
  v_cvt_pk_bf16_f32 v33, v2, v3
  v_mfma_f32_16x16x32_bf16 v[84:87], v[136:139], v[40:43], v[84:87]
  v_exp_f32 v6, v6
  v_exp_f32 v7, v7
  v_cvt_pk_bf16_f32 v34, v4, v5
  v_exp_f32 v8, v8
  v_mfma_f32_32x32x16_bf16 v[16:31], v[108:111], v[184:187], v[16:31]
  v_exp_f32 v9, v9
  v_cvt_pk_bf16_f32 v35, v6, v7
  v_exp_f32 v10, v10
  v_exp_f32 v11, v11
  v_mfma_f32_32x32x16_bf16 v[64:79], v[116:119], v[44:47], v[64:79]
  v_cvt_pk_bf16_f32 v36, v8, v9
  v_exp_f32 v12, v12
  v_exp_f32 v13, v13
  v_cvt_pk_bf16_f32 v37, v10, v11
  v_mfma_f32_16x16x32_bf16 v[84:87], v[136:139], v[44:47], v[84:87]
  v_exp_f32 v14, v14
  v_exp_f32 v15, v15
  v_cvt_pk_bf16_f32 v38, v12, v13
  v_cvt_pk_bf16_f32 v39, v14, v15
  s_waitcnt lgkmcnt(0)
  v_mfma_f32_32x32x16_bf16 v[0:15], v[120:123], v[172:175], 0
  ds_read_b128 v[104:107], v190 offset:16384
  v_exp_f32 v16, v16
  v_exp_f32 v17, v17
  v_exp_f32 v18, v18
  v_exp_f32 v19, v19
  v_mfma_f32_32x32x16_bf16 v[48:63], v[128:131], v[32:35], v[48:63]
  ds_read_b128 v[112:115], v190 offset:22528
  v_cvt_pk_bf16_f32 v40, v16, v17
  v_exp_f32 v20, v20
  v_exp_f32 v21, v21
  v_cvt_pk_bf16_f32 v41, v18, v19
  v_mfma_f32_16x16x32_bf16 v[80:83], v[136:139], v[32:35], v[80:83]
  ds_read_b128 v[108:111], v190 offset:17408
  v_exp_f32 v22, v22
  v_exp_f32 v23, v23
  v_cvt_pk_bf16_f32 v42, v20, v21
  v_exp_f32 v24, v24
  v_mfma_f32_32x32x16_bf16 v[0:15], v[124:127], v[176:179], v[0:15]
  ds_read_b128 v[116:119], v190 offset:23552
  v_exp_f32 v25, v25
  v_cvt_pk_bf16_f32 v43, v22, v23
  v_exp_f32 v26, v26
  v_exp_f32 v27, v27
  v_mfma_f32_32x32x16_bf16 v[48:63], v[132:135], v[36:39], v[48:63]
  v_cvt_pk_bf16_f32 v44, v24, v25
  v_exp_f32 v28, v28
  v_exp_f32 v29, v29
  v_cvt_pk_bf16_f32 v45, v26, v27
  v_mfma_f32_16x16x32_bf16 v[80:83], v[136:139], v[36:39], v[80:83]
  v_exp_f32 v30, v30
  v_exp_f32 v31, v31
  v_cvt_pk_bf16_f32 v46, v28, v29
  v_cvt_pk_bf16_f32 v47, v30, v31
  s_cmp_eq_u32 s30, 2
  s_cbranch_scc1 p2_drainB
  v_mfma_f32_32x32x16_bf16 v[16:31], v[120:123], v[180:183], 0
  v_exp_f32 v0, v0
  v_exp_f32 v1, v1
  v_exp_f32 v2, v2
  v_exp_f32 v3, v3
  v_mfma_f32_32x32x16_bf16 v[64:79], v[128:131], v[40:43], v[64:79]
  v_cvt_pk_bf16_f32 v32, v0, v1
  v_exp_f32 v4, v4
  v_exp_f32 v5, v5
  v_cvt_pk_bf16_f32 v33, v2, v3
  v_mfma_f32_16x16x32_bf16 v[84:87], v[136:139], v[40:43], v[84:87]
  v_exp_f32 v6, v6
  v_exp_f32 v7, v7
  v_cvt_pk_bf16_f32 v34, v4, v5
  v_exp_f32 v8, v8
  v_mfma_f32_32x32x16_bf16 v[16:31], v[124:127], v[184:187], v[16:31]
  v_exp_f32 v9, v9
  v_cvt_pk_bf16_f32 v35, v6, v7
  v_exp_f32 v10, v10
  v_exp_f32 v11, v11
  v_mfma_f32_32x32x16_bf16 v[64:79], v[132:135], v[44:47], v[64:79]
  v_cvt_pk_bf16_f32 v36, v8, v9
  v_exp_f32 v12, v12
  v_exp_f32 v13, v13
  v_cvt_pk_bf16_f32 v37, v10, v11
  v_mfma_f32_16x16x32_bf16 v[84:87], v[136:139], v[44:47], v[84:87]
  v_exp_f32 v14, v14
  v_exp_f32 v15, v15
  v_cvt_pk_bf16_f32 v38, v12, v13
  v_cvt_pk_bf16_f32 v39, v14, v15
  s_waitcnt lgkmcnt(0)
  v_mfma_f32_32x32x16_bf16 v[0:15], v[104:107], v[172:175], 0
  ds_read_b128 v[120:123], v190 offset:12288
  v_exp_f32 v16, v16
  v_exp_f32 v17, v17
  v_exp_f32 v18, v18
  v_exp_f32 v19, v19
  v_mfma_f32_32x32x16_bf16 v[48:63], v[112:115], v[32:35], v[48:63]
  ds_read_b128 v[128:131], v190 offset:18432
  v_cvt_pk_bf16_f32 v40, v16, v17
  v_exp_f32 v20, v20
  v_exp_f32 v21, v21
  v_cvt_pk_bf16_f32 v41, v18, v19
  v_mfma_f32_16x16x32_bf16 v[80:83], v[136:139], v[32:35], v[80:83]
  ds_read_b128 v[124:127], v190 offset:13312
  v_exp_f32 v22, v22
  v_exp_f32 v23, v23
  v_cvt_pk_bf16_f32 v42, v20, v21
  v_exp_f32 v24, v24
  v_mfma_f32_32x32x16_bf16 v[0:15], v[108:111], v[176:179], v[0:15]
  ds_read_b128 v[132:135], v190 offset:19456
  v_exp_f32 v25, v25
  v_cvt_pk_bf16_f32 v43, v22, v23
  v_exp_f32 v26, v26
  v_exp_f32 v27, v27
  v_mfma_f32_32x32x16_bf16 v[48:63], v[116:119], v[36:39], v[48:63]
  v_cvt_pk_bf16_f32 v44, v24, v25
  v_exp_f32 v28, v28
  v_exp_f32 v29, v29
  v_cvt_pk_bf16_f32 v45, v26, v27
  v_mfma_f32_16x16x32_bf16 v[80:83], v[136:139], v[36:39], v[80:83]
  v_exp_f32 v30, v30
  v_exp_f32 v31, v31
  v_cvt_pk_bf16_f32 v46, v28, v29
  v_cvt_pk_bf16_f32 v47, v30, v31
  v_mfma_f32_32x32x16_bf16 v[16:31], v[104:107], v[180:183], 0
  v_exp_f32 v0, v0
  v_exp_f32 v1, v1
  v_exp_f32 v2, v2
  v_exp_f32 v3, v3
  v_mfma_f32_32x32x16_bf16 v[64:79], v[112:115], v[40:43], v[64:79]
  v_cvt_pk_bf16_f32 v32, v0, v1
  v_exp_f32 v4, v4
  v_exp_f32 v5, v5
  v_cvt_pk_bf16_f32 v33, v2, v3
  v_mfma_f32_16x16x32_bf16 v[84:87], v[136:139], v[40:43], v[84:87]
  v_exp_f32 v6, v6
  v_exp_f32 v7, v7
  v_cvt_pk_bf16_f32 v34, v4, v5
  v_exp_f32 v8, v8
  v_mfma_f32_32x32x16_bf16 v[16:31], v[108:111], v[184:187], v[16:31]
  v_exp_f32 v9, v9
  v_cvt_pk_bf16_f32 v35, v6, v7
  v_exp_f32 v10, v10
  v_exp_f32 v11, v11
  v_mfma_f32_32x32x16_bf16 v[64:79], v[116:119], v[44:47], v[64:79]
  v_cvt_pk_bf16_f32 v36, v8, v9
  v_exp_f32 v12, v12
  v_exp_f32 v13, v13
  v_cvt_pk_bf16_f32 v37, v10, v11
  v_mfma_f32_16x16x32_bf16 v[84:87], v[136:139], v[44:47], v[84:87]
  v_exp_f32 v14, v14
  v_exp_f32 v15, v15
  v_cvt_pk_bf16_f32 v38, v12, v13
  v_cvt_pk_bf16_f32 v39, v14, v15
  s_waitcnt lgkmcnt(0)
  v_mfma_f32_32x32x16_bf16 v[0:15], v[120:123], v[172:175], 0
  ds_read_b128 v[104:107], v190 offset:8192
  v_exp_f32 v16, v16
  v_exp_f32 v17, v17
  v_exp_f32 v18, v18
  v_exp_f32 v19, v19
  v_mfma_f32_32x32x16_bf16 v[48:63], v[128:131], v[32:35], v[48:63]
  ds_read_b128 v[112:115], v190 offset:14336
  v_cvt_pk_bf16_f32 v40, v16, v17
  v_exp_f32 v20, v20
  v_exp_f32 v21, v21
  v_cvt_pk_bf16_f32 v41, v18, v19
  v_mfma_f32_16x16x32_bf16 v[80:83], v[136:139], v[32:35], v[80:83]
  ds_read_b128 v[108:111], v190 offset:9216
  v_exp_f32 v22, v22
  v_exp_f32 v23, v23
  v_cvt_pk_bf16_f32 v42, v20, v21
  v_exp_f32 v24, v24
  v_mfma_f32_32x32x16_bf16 v[0:15], v[124:127], v[176:179], v[0:15]
  ds_read_b128 v[116:119], v190 offset:15360
  v_exp_f32 v25, v25
  v_cvt_pk_bf16_f32 v43, v22, v23
  v_exp_f32 v26, v26
  v_exp_f32 v27, v27
  v_mfma_f32_32x32x16_bf16 v[48:63], v[132:135], v[36:39], v[48:63]
  v_cvt_pk_bf16_f32 v44, v24, v25
  v_exp_f32 v28, v28
  v_exp_f32 v29, v29
  v_cvt_pk_bf16_f32 v45, v26, v27
  v_mfma_f32_16x16x32_bf16 v[80:83], v[136:139], v[36:39], v[80:83]
  v_exp_f32 v30, v30
  v_exp_f32 v31, v31
  v_cvt_pk_bf16_f32 v46, v28, v29
  v_cvt_pk_bf16_f32 v47, v30, v31
  s_cmp_eq_u32 s30, 4
  s_cbranch_scc1 p2_drainB
  v_mfma_f32_32x32x16_bf16 v[16:31], v[120:123], v[180:183], 0
  v_exp_f32 v0, v0
  v_exp_f32 v1, v1
  v_exp_f32 v2, v2
  v_exp_f32 v3, v3
  v_mfma_f32_32x32x16_bf16 v[64:79], v[128:131], v[40:43], v[64:79]
  v_cvt_pk_bf16_f32 v32, v0, v1
  v_exp_f32 v4, v4
  v_exp_f32 v5, v5
  v_cvt_pk_bf16_f32 v33, v2, v3
  v_mfma_f32_16x16x32_bf16 v[84:87], v[136:139], v[40:43], v[84:87]
  v_exp_f32 v6, v6
  v_exp_f32 v7, v7
  v_cvt_pk_bf16_f32 v34, v4, v5
  v_exp_f32 v8, v8
  v_mfma_f32_32x32x16_bf16 v[16:31], v[124:127], v[184:187], v[16:31]
  v_exp_f32 v9, v9
  v_cvt_pk_bf16_f32 v35, v6, v7
  v_exp_f32 v10, v10
  v_exp_f32 v11, v11
  v_mfma_f32_32x32x16_bf16 v[64:79], v[132:135], v[44:47], v[64:79]
  v_cvt_pk_bf16_f32 v36, v8, v9
  v_exp_f32 v12, v12
  v_exp_f32 v13, v13
  v_cvt_pk_bf16_f32 v37, v10, v11
  v_mfma_f32_16x16x32_bf16 v[84:87], v[136:139], v[44:47], v[84:87]
  v_exp_f32 v14, v14
  v_exp_f32 v15, v15
  v_cvt_pk_bf16_f32 v38, v12, v13
  v_cvt_pk_bf16_f32 v39, v14, v15
  s_waitcnt lgkmcnt(0)
  v_mfma_f32_32x32x16_bf16 v[0:15], v[104:107], v[172:175], 0
  ds_read_b128 v[120:123], v190 offset:4096
  v_exp_f32 v16, v16
  v_exp_f32 v17, v17
  v_exp_f32 v18, v18
  v_exp_f32 v19, v19
  v_mfma_f32_32x32x16_bf16 v[48:63], v[112:115], v[32:35], v[48:63]
  ds_read_b128 v[128:131], v190 offset:10240
  v_cvt_pk_bf16_f32 v40, v16, v17
  v_exp_f32 v20, v20
  v_exp_f32 v21, v21
  v_cvt_pk_bf16_f32 v41, v18, v19
  v_mfma_f32_16x16x32_bf16 v[80:83], v[136:139], v[32:35], v[80:83]
  ds_read_b128 v[124:127], v190 offset:5120
  v_exp_f32 v22, v22
  v_exp_f32 v23, v23
  v_cvt_pk_bf16_f32 v42, v20, v21
  v_exp_f32 v24, v24
  v_mfma_f32_32x32x16_bf16 v[0:15], v[108:111], v[176:179], v[0:15]
  ds_read_b128 v[132:135], v190 offset:11264
  v_exp_f32 v25, v25
  v_cvt_pk_bf16_f32 v43, v22, v23
  v_exp_f32 v26, v26
  v_exp_f32 v27, v27
  v_mfma_f32_32x32x16_bf16 v[48:63], v[116:119], v[36:39], v[48:63]
  v_cvt_pk_bf16_f32 v44, v24, v25
  v_exp_f32 v28, v28
  v_exp_f32 v29, v29
  v_cvt_pk_bf16_f32 v45, v26, v27
  v_mfma_f32_16x16x32_bf16 v[80:83], v[136:139], v[36:39], v[80:83]
  v_exp_f32 v30, v30
  v_exp_f32 v31, v31
  v_cvt_pk_bf16_f32 v46, v28, v29
  v_cvt_pk_bf16_f32 v47, v30, v31
  v_mfma_f32_32x32x16_bf16 v[16:31], v[104:107], v[180:183], 0
  v_exp_f32 v0, v0
  v_exp_f32 v1, v1
  v_exp_f32 v2, v2
  v_exp_f32 v3, v3
  v_mfma_f32_32x32x16_bf16 v[64:79], v[112:115], v[40:43], v[64:79]
  v_cvt_pk_bf16_f32 v32, v0, v1
  v_exp_f32 v4, v4
  v_exp_f32 v5, v5
  v_cvt_pk_bf16_f32 v33, v2, v3
  v_mfma_f32_16x16x32_bf16 v[84:87], v[136:139], v[40:43], v[84:87]
  v_exp_f32 v6, v6
  v_exp_f32 v7, v7
  v_cvt_pk_bf16_f32 v34, v4, v5
  v_exp_f32 v8, v8
  v_mfma_f32_32x32x16_bf16 v[16:31], v[108:111], v[184:187], v[16:31]
  v_exp_f32 v9, v9
  v_cvt_pk_bf16_f32 v35, v6, v7
  v_exp_f32 v10, v10
  v_exp_f32 v11, v11
  v_mfma_f32_32x32x16_bf16 v[64:79], v[116:119], v[44:47], v[64:79]
  v_cvt_pk_bf16_f32 v36, v8, v9
  v_exp_f32 v12, v12
  v_exp_f32 v13, v13
  v_cvt_pk_bf16_f32 v37, v10, v11
  v_mfma_f32_16x16x32_bf16 v[84:87], v[136:139], v[44:47], v[84:87]
  v_exp_f32 v14, v14
  v_exp_f32 v15, v15
  v_cvt_pk_bf16_f32 v38, v12, v13
  v_cvt_pk_bf16_f32 v39, v14, v15
  s_waitcnt lgkmcnt(0)
  v_mfma_f32_32x32x16_bf16 v[0:15], v[120:123], v[172:175], 0
  ds_read_b128 v[104:107], v190 offset:0
  v_exp_f32 v16, v16
  v_exp_f32 v17, v17
  v_exp_f32 v18, v18
  v_exp_f32 v19, v19
  v_mfma_f32_32x32x16_bf16 v[48:63], v[128:131], v[32:35], v[48:63]
  ds_read_b128 v[112:115], v190 offset:6144
  v_cvt_pk_bf16_f32 v40, v16, v17
  v_exp_f32 v20, v20
  v_exp_f32 v21, v21
  v_cvt_pk_bf16_f32 v41, v18, v19
  v_mfma_f32_16x16x32_bf16 v[80:83], v[136:139], v[32:35], v[80:83]
  ds_read_b128 v[108:111], v190 offset:1024
  v_exp_f32 v22, v22
  v_exp_f32 v23, v23
  v_cvt_pk_bf16_f32 v42, v20, v21
  v_exp_f32 v24, v24
  v_mfma_f32_32x32x16_bf16 v[0:15], v[124:127], v[176:179], v[0:15]
  ds_read_b128 v[116:119], v190 offset:7168
  v_exp_f32 v25, v25
  v_cvt_pk_bf16_f32 v43, v22, v23
  v_exp_f32 v26, v26
  v_exp_f32 v27, v27
  v_mfma_f32_32x32x16_bf16 v[48:63], v[132:135], v[36:39], v[48:63]
  v_cvt_pk_bf16_f32 v44, v24, v25
  v_exp_f32 v28, v28
  v_exp_f32 v29, v29
  v_cvt_pk_bf16_f32 v45, v26, v27
  v_mfma_f32_16x16x32_bf16 v[80:83], v[136:139], v[36:39], v[80:83]
  v_exp_f32 v30, v30
  v_exp_f32 v31, v31
  v_cvt_pk_bf16_f32 v46, v28, v29
  v_cvt_pk_bf16_f32 v47, v30, v31
  s_cmp_eq_u32 s30, 6
  s_cbranch_scc1 p2_drainB
  v_mfma_f32_32x32x16_bf16 v[16:31], v[120:123], v[180:183], v[156:171]
  v_exp_f32 v0, v0
  v_exp_f32 v1, v1
  v_exp_f32 v2, v2
  v_exp_f32 v3, v3
  v_mfma_f32_32x32x16_bf16 v[64:79], v[128:131], v[40:43], v[64:79]
  v_cvt_pk_bf16_f32 v32, v0, v1
  v_exp_f32 v4, v4
  v_exp_f32 v5, v5
  v_cvt_pk_bf16_f32 v33, v2, v3
  v_mfma_f32_16x16x32_bf16 v[84:87], v[136:139], v[40:43], v[84:87]
  v_exp_f32 v6, v6
  v_exp_f32 v7, v7
  v_cvt_pk_bf16_f32 v34, v4, v5
  v_exp_f32 v8, v8
  v_mfma_f32_32x32x16_bf16 v[16:31], v[124:127], v[184:187], v[16:31]
  v_exp_f32 v9, v9
  v_cvt_pk_bf16_f32 v35, v6, v7
  v_exp_f32 v10, v10
  v_exp_f32 v11, v11
  v_mfma_f32_32x32x16_bf16 v[64:79], v[132:135], v[44:47], v[64:79]
  v_cvt_pk_bf16_f32 v36, v8, v9
  v_exp_f32 v12, v12
  v_exp_f32 v13, v13
  v_cvt_pk_bf16_f32 v37, v10, v11
  v_mfma_f32_16x16x32_bf16 v[84:87], v[136:139], v[44:47], v[84:87]
  v_exp_f32 v14, v14
  v_exp_f32 v15, v15
  v_cvt_pk_bf16_f32 v38, v12, v13
  v_cvt_pk_bf16_f32 v39, v14, v15
  s_waitcnt lgkmcnt(0)
  v_mfma_f32_32x32x16_bf16 v[0:15], v[104:107], v[172:175], v[156:171]
  ds_read_b128 v[128:131], v190 offset:2048
  v_exp_f32 v16, v16
  v_exp_f32 v17, v17
  v_exp_f32 v18, v18
  v_exp_f32 v19, v19
  v_mfma_f32_32x32x16_bf16 v[48:63], v[112:115], v[32:35], v[48:63]
  ds_read_b128 v[132:135], v190 offset:3072
  v_cvt_pk_bf16_f32 v40, v16, v17
  v_exp_f32 v20, v20
  v_exp_f32 v21, v21
  v_cvt_pk_bf16_f32 v41, v18, v19
  v_mfma_f32_16x16x32_bf16 v[80:83], v[136:139], v[32:35], v[80:83]
  v_exp_f32 v22, v22
  v_exp_f32 v23, v23
  v_cvt_pk_bf16_f32 v42, v20, v21
  v_exp_f32 v24, v24
  v_mfma_f32_32x32x16_bf16 v[0:15], v[108:111], v[176:179], v[0:15]
  v_exp_f32 v25, v25
  v_cvt_pk_bf16_f32 v43, v22, v23
  v_exp_f32 v26, v26
  v_exp_f32 v27, v27
  v_mfma_f32_32x32x16_bf16 v[48:63], v[116:119], v[36:39], v[48:63]
  v_cvt_pk_bf16_f32 v44, v24, v25
  v_exp_f32 v28, v28
  v_exp_f32 v29, v29
  v_cvt_pk_bf16_f32 v45, v26, v27
  v_mfma_f32_16x16x32_bf16 v[80:83], v[136:139], v[36:39], v[80:83]
  v_exp_f32 v30, v30
  v_exp_f32 v31, v31
  v_cvt_pk_bf16_f32 v46, v28, v29
  v_cvt_pk_bf16_f32 v47, v30, v31
  v_exp_f32 v0, v0
  v_exp_f32 v1, v1
  v_exp_f32 v2, v2
  v_exp_f32 v3, v3
  v_mfma_f32_32x32x16_bf16 v[64:79], v[112:115], v[40:43], v[64:79]
  v_cvt_pk_bf16_f32 v32, v0, v1
  v_exp_f32 v4, v4
  v_exp_f32 v5, v5
  v_cvt_pk_bf16_f32 v33, v2, v3
  v_mfma_f32_16x16x32_bf16 v[84:87], v[136:139], v[40:43], v[84:87]
  v_exp_f32 v6, v6
  v_exp_f32 v7, v7
  v_cvt_pk_bf16_f32 v34, v4, v5
  v_exp_f32 v8, v8
  v_exp_f32 v9, v9
  v_cvt_pk_bf16_f32 v35, v6, v7
  v_mfma_f32_32x32x16_bf16 v[64:79], v[116:119], v[44:47], v[64:79]
  v_exp_f32 v10, v10
  v_exp_f32 v11, v11
  v_cvt_pk_bf16_f32 v36, v8, v9
  v_exp_f32 v12, v12
  v_mfma_f32_16x16x32_bf16 v[84:87], v[136:139], v[44:47], v[84:87]
  v_exp_f32 v13, v13
  v_cvt_pk_bf16_f32 v37, v10, v11
  v_exp_f32 v14, v14
  v_exp_f32 v15, v15
  v_cvt_pk_bf16_f32 v38, v12, v13
  v_cvt_pk_bf16_f32 v39, v14, v15
  s_waitcnt lgkmcnt(0)
  v_mfma_f32_32x32x16_bf16 v[48:63], v[128:131], v[32:35], v[48:63]
  v_mfma_f32_16x16x32_bf16 v[80:83], v[136:139], v[32:35], v[80:83]
  v_mfma_f32_32x32x16_bf16 v[48:63], v[132:135], v[36:39], v[48:63]
  v_mfma_f32_16x16x32_bf16 v[80:83], v[136:139], v[36:39], v[80:83]
  s_branch p2_adone
p2_drainB:
  s_waitcnt lgkmcnt(0)
  v_mfma_f32_32x32x16_bf16 v[64:79], v[128:131], v[40:43], v[64:79]
  v_mfma_f32_16x16x32_bf16 v[84:87], v[136:139], v[40:43], v[84:87]
  v_mfma_f32_32x32x16_bf16 v[64:79], v[132:135], v[44:47], v[64:79]
  v_mfma_f32_16x16x32_bf16 v[84:87], v[136:139], v[44:47], v[84:87]
p2_adone:
  s_nop 7
  s_nop 7
  s_lshl_b32 s7, s12, 16
  s_lshl_b32 s19, s4, 11
  s_add_u32 s7, s7, s19
  s_add_u32 s7, s7, 20971520
  v_rcp_f32 v192, v80
  v_rcp_f32 v194, v84
  s_nop 0
  v_mov_b32 v193, v192
  v_mov_b32 v195, v194
  v_pk_mul_f32 v[48:49], v[48:49], v[192:193]
  v_pk_mul_f32 v[50:51], v[50:51], v[192:193]
  v_pk_mul_f32 v[52:53], v[52:53], v[192:193]
  v_pk_mul_f32 v[54:55], v[54:55], v[192:193]
  v_pk_mul_f32 v[56:57], v[56:57], v[192:193]
  v_pk_mul_f32 v[58:59], v[58:59], v[192:193]
  v_pk_mul_f32 v[60:61], v[60:61], v[192:193]
  v_pk_mul_f32 v[62:63], v[62:63], v[192:193]
  v_cvt_pk_bf16_f32 v48, v48, v49
  v_cvt_pk_bf16_f32 v49, v50, v51
  v_cvt_pk_bf16_f32 v50, v52, v53
  v_cvt_pk_bf16_f32 v51, v54, v55
  v_cvt_pk_bf16_f32 v52, v56, v57
  v_cvt_pk_bf16_f32 v53, v58, v59
  v_cvt_pk_bf16_f32 v54, v60, v61
  v_cvt_pk_bf16_f32 v55, v62, v63
  buffer_store_dwordx4 v[48:51], v188, s[8:11], s7 offen sc1
  buffer_store_dwordx4 v[52:55], v188, s[8:11], s7 offen offset:1024 sc1
  v_mfma_f32_16x16x32_bf16 v[244:247], v[240:243], v[48:51], 0
  v_mfma_f32_16x16x32_bf16 v[244:247], v[240:243], v[52:55], v[244:247]
  v_pk_mul_f32 v[64:65], v[64:65], v[194:195]
  v_pk_mul_f32 v[66:67], v[66:67], v[194:195]
  v_pk_mul_f32 v[68:69], v[68:69], v[194:195]
  v_pk_mul_f32 v[70:71], v[70:71], v[194:195]
  v_pk_mul_f32 v[72:73], v[72:73], v[194:195]
  v_pk_mul_f32 v[74:75], v[74:75], v[194:195]
  v_pk_mul_f32 v[76:77], v[76:77], v[194:195]
  v_pk_mul_f32 v[78:79], v[78:79], v[194:195]
  v_cvt_pk_bf16_f32 v64, v64, v65
  v_cvt_pk_bf16_f32 v65, v66, v67
  v_cvt_pk_bf16_f32 v66, v68, v69
  v_cvt_pk_bf16_f32 v67, v70, v71
  v_cvt_pk_bf16_f32 v68, v72, v73
  v_cvt_pk_bf16_f32 v69, v74, v75
  v_cvt_pk_bf16_f32 v70, v76, v77
  v_cvt_pk_bf16_f32 v71, v78, v79
  s_add_u32 s7, s7, 65536
  buffer_store_dwordx4 v[64:67], v188, s[8:11], s7 offen sc1
  buffer_store_dwordx4 v[68:71], v188, s[8:11], s7 offen offset:1024 sc1
  v_mfma_f32_16x16x32_bf16 v[244:247], v[240:243], v[64:67], v[244:247]
  v_mfma_f32_16x16x32_bf16 v[244:247], v[240:243], v[68:71], v[244:247]
  v_mov_b32 v196, 0x21800000
  v_mov_b32 v197, 0x5d800000
  v_cmp_gt_f32 s[26:27], v80, v196
  v_cmp_lt_f32 s[28:29], v80, v197
  s_nop 0
  s_and_b64 s[26:27], s[26:27], s[28:29]
  s_mov_b64 s[24:25], s[26:27]
  v_cmp_gt_f32 s[26:27], v84, v196
  v_cmp_lt_f32 s[28:29], v84, v197
  s_nop 0
  s_and_b64 s[26:27], s[26:27], s[28:29]
  s_and_b64 s[24:25], s[26:27], s[24:25]
  v_cmp_eq_f32 s[26:27], 0, v244
  s_nop 0
  s_and_b64 s[24:25], s[24:25], s[26:27]
  s_cmp_eq_u64 s[24:25], -1
  s_cbranch_scc0 p2_slowA
p2_backA:
  s_endpgm
p2_slowB:
  s_waitcnt vmcnt(0)
  s_add_u32 s35, s12, 0
  s_mov_b32 s32, 0
  s_mov_b32 s33, 63
  s_mov_b32 s34, 16777216
  v_lshrrev_b32 v197, 4, v188
  v_and_b32 v196, 31, v197
  v_lshrrev_b32 v197, 5, v197
  v_lshlrev_b32 v197, 2, v197
  v_sub_u32 v196, v196, v197
  s_lshl_b32 s7, s35, 5
  v_add_u32 v196, s7, v196
  v_mov_b32 v198, 0xff800000
  v_mov_b32 v199, 0xff800000
  s_mov_b32 s36, s32
p2_s1_1:
  s_lshl_b32 s7, s36, 12
  s_add_u32 s7, s7, s34
  buffer_load_dwordx4 v[224:227], v188, s[8:11], s7 offen offset:0
  buffer_load_dwordx4 v[228:231], v188, s[8:11], s7 offen offset:1024
  v_mov_b32 v208, 0
  v_mov_b32 v209, 0
  v_mov_b32 v210, 0
  v_mov_b32 v211, 0
  v_mov_b32 v212, 0
  v_mov_b32 v213, 0
  v_mov_b32 v214, 0
  v_mov_b32 v215, 0
  v_mov_b32 v216, 0
  v_mov_b32 v217, 0
  v_mov_b32 v218, 0
  v_mov_b32 v219, 0
  v_mov_b32 v220, 0
  v_mov_b32 v221, 0
  v_mov_b32 v222, 0
  v_mov_b32 v223, 0
  s_waitcnt vmcnt(0)
  s_nop 1
  v_mfma_f32_32x32x16_bf16 v[0:15], v[224:227], v[88:91], v[208:223]
  v_mfma_f32_32x32x16_bf16 v[0:15], v[228:231], v[92:95], v[0:15]
  s_nop 7
  s_nop 7
  v_max3_f32 v198, v0, v1, v198
  v_max3_f32 v198, v2, v3, v198
  v_max3_f32 v198, v4, v5, v198
  v_max3_f32 v198, v6, v7, v198
  v_max3_f32 v198, v8, v9, v198
  v_max3_f32 v198, v10, v11, v198
  v_max3_f32 v198, v12, v13, v198
  v_max3_f32 v198, v14, v15, v198
  s_add_u32 s36, s36, 1
  s_cmp_le_u32 s36, s33
  s_cbranch_scc1 p2_s1_1
  v_mov_b32 v200, v198
  s_nop 1
  v_permlane32_swap_b32 v198, v200
  s_nop 1
  v_max_f32 v198, v198, v200
  v_sub_f32 v198, 0, v198
  v_mov_b32 v48, 0
  v_mov_b32 v49, 0
  v_mov_b32 v50, 0
  v_mov_b32 v51, 0
  v_mov_b32 v52, 0
  v_mov_b32 v53, 0
  v_mov_b32 v54, 0
  v_mov_b32 v55, 0
  v_mov_b32 v56, 0
  v_mov_b32 v57, 0
  v_mov_b32 v58, 0
  v_mov_b32 v59, 0
  v_mov_b32 v60, 0
  v_mov_b32 v61, 0
  v_mov_b32 v62, 0
  v_mov_b32 v63, 0
  v_mov_b32 v80, 0
  v_mov_b32 v81, 0
  v_mov_b32 v82, 0
  v_mov_b32 v83, 0
  s_mov_b32 s36, s32
p2_s2_2:
  s_lshl_b32 s7, s36, 12
  s_add_u32 s7, s7, s34
  buffer_load_dwordx4 v[224:227], v188, s[8:11], s7 offen offset:0
  buffer_load_dwordx4 v[228:231], v188, s[8:11], s7 offen offset:1024
  buffer_load_dwordx4 v[232:235], v188, s[8:11], s7 offen offset:2048
  buffer_load_dwordx4 v[236:239], v188, s[8:11], s7 offen offset:3072
  v_mov_b32 v208, v198
  v_mov_b32 v209, v198
  v_mov_b32 v210, v198
  v_mov_b32 v211, v198
  v_mov_b32 v212, v198
  v_mov_b32 v213, v198
  v_mov_b32 v214, v198
  v_mov_b32 v215, v198
  v_mov_b32 v216, v198
  v_mov_b32 v217, v198
  v_mov_b32 v218, v198
  v_mov_b32 v219, v198
  v_mov_b32 v220, v198
  v_mov_b32 v221, v198
  v_mov_b32 v222, v198
  v_mov_b32 v223, v198
  s_waitcnt vmcnt(0)
  s_nop 1
  v_mfma_f32_32x32x16_bf16 v[0:15], v[224:227], v[88:91], v[208:223]
  v_mfma_f32_32x32x16_bf16 v[0:15], v[228:231], v[92:95], v[0:15]
  s_nop 7
  s_nop 7
  v_exp_f32 v0, v0
  v_exp_f32 v1, v1
  v_exp_f32 v2, v2
  v_exp_f32 v3, v3
  v_cvt_pk_bf16_f32 v32, v0, v1
  v_exp_f32 v4, v4
  v_exp_f32 v5, v5
  v_cvt_pk_bf16_f32 v33, v2, v3
  v_exp_f32 v6, v6
  v_exp_f32 v7, v7
  v_cvt_pk_bf16_f32 v34, v4, v5
  v_exp_f32 v8, v8
  v_exp_f32 v9, v9
  v_cvt_pk_bf16_f32 v35, v6, v7
  v_exp_f32 v10, v10
  v_exp_f32 v11, v11
  v_cvt_pk_bf16_f32 v36, v8, v9
  v_exp_f32 v12, v12
  v_exp_f32 v13, v13
  v_cvt_pk_bf16_f32 v37, v10, v11
  v_exp_f32 v14, v14
  v_exp_f32 v15, v15
  v_cvt_pk_bf16_f32 v38, v12, v13
  v_cvt_pk_bf16_f32 v39, v14, v15
  s_nop 1
  v_mfma_f32_32x32x16_bf16 v[48:63], v[232:235], v[32:35], v[48:63]
  v_mfma_f32_16x16x32_bf16 v[80:83], v[136:139], v[32:35], v[80:83]
  v_mfma_f32_32x32x16_bf16 v[48:63], v[236:239], v[36:39], v[48:63]
  v_mfma_f32_16x16x32_bf16 v[80:83], v[136:139], v[36:39], v[80:83]
  s_nop 7
  s_nop 7
  s_add_u32 s36, s36, 1
  s_cmp_le_u32 s36, s33
  s_cbranch_scc1 p2_s2_2
  s_add_u32 s35, s12, 1
  s_mov_b32 s32, 0
  s_mov_b32 s33, 63
  s_mov_b32 s34, 16777216
  v_lshrrev_b32 v197, 4, v188
  v_and_b32 v196, 31, v197
  v_lshrrev_b32 v197, 5, v197
  v_lshlrev_b32 v197, 2, v197
  v_sub_u32 v196, v196, v197
  s_lshl_b32 s7, s35, 5
  v_add_u32 v196, s7, v196
  v_mov_b32 v198, 0xff800000
  v_mov_b32 v199, 0xff800000
  s_mov_b32 s36, s32
p2_s1_3:
  s_lshl_b32 s7, s36, 12
  s_add_u32 s7, s7, s34
  buffer_load_dwordx4 v[224:227], v188, s[8:11], s7 offen offset:0
  buffer_load_dwordx4 v[228:231], v188, s[8:11], s7 offen offset:1024
  v_mov_b32 v208, 0
  v_mov_b32 v209, 0
  v_mov_b32 v210, 0
  v_mov_b32 v211, 0
  v_mov_b32 v212, 0
  v_mov_b32 v213, 0
  v_mov_b32 v214, 0
  v_mov_b32 v215, 0
  v_mov_b32 v216, 0
  v_mov_b32 v217, 0
  v_mov_b32 v218, 0
  v_mov_b32 v219, 0
  v_mov_b32 v220, 0
  v_mov_b32 v221, 0
  v_mov_b32 v222, 0
  v_mov_b32 v223, 0
  s_waitcnt vmcnt(0)
  s_nop 1
  v_mfma_f32_32x32x16_bf16 v[16:31], v[224:227], v[96:99], v[208:223]
  v_mfma_f32_32x32x16_bf16 v[16:31], v[228:231], v[100:103], v[16:31]
  s_nop 7
  s_nop 7
  v_max3_f32 v198, v16, v17, v198
  v_max3_f32 v198, v18, v19, v198
  v_max3_f32 v198, v20, v21, v198
  v_max3_f32 v198, v22, v23, v198
  v_max3_f32 v198, v24, v25, v198
  v_max3_f32 v198, v26, v27, v198
  v_max3_f32 v198, v28, v29, v198
  v_max3_f32 v198, v30, v31, v198
  s_add_u32 s36, s36, 1
  s_cmp_le_u32 s36, s33
  s_cbranch_scc1 p2_s1_3
  v_mov_b32 v200, v198
  s_nop 1
  v_permlane32_swap_b32 v198, v200
  s_nop 1
  v_max_f32 v198, v198, v200
  v_sub_f32 v198, 0, v198
  v_mov_b32 v64, 0
  v_mov_b32 v65, 0
  v_mov_b32 v66, 0
  v_mov_b32 v67, 0
  v_mov_b32 v68, 0
  v_mov_b32 v69, 0
  v_mov_b32 v70, 0
  v_mov_b32 v71, 0
  v_mov_b32 v72, 0
  v_mov_b32 v73, 0
  v_mov_b32 v74, 0
  v_mov_b32 v75, 0
  v_mov_b32 v76, 0
  v_mov_b32 v77, 0
  v_mov_b32 v78, 0
  v_mov_b32 v79, 0
  v_mov_b32 v84, 0
  v_mov_b32 v85, 0
  v_mov_b32 v86, 0
  v_mov_b32 v87, 0
  s_mov_b32 s36, s32
p2_s2_4:
  s_lshl_b32 s7, s36, 12
  s_add_u32 s7, s7, s34
  buffer_load_dwordx4 v[224:227], v188, s[8:11], s7 offen offset:0
  buffer_load_dwordx4 v[228:231], v188, s[8:11], s7 offen offset:1024
  buffer_load_dwordx4 v[232:235], v188, s[8:11], s7 offen offset:2048
  buffer_load_dwordx4 v[236:239], v188, s[8:11], s7 offen offset:3072
  v_mov_b32 v208, v198
  v_mov_b32 v209, v198
  v_mov_b32 v210, v198
  v_mov_b32 v211, v198
  v_mov_b32 v212, v198
  v_mov_b32 v213, v198
  v_mov_b32 v214, v198
  v_mov_b32 v215, v198
  v_mov_b32 v216, v198
  v_mov_b32 v217, v198
  v_mov_b32 v218, v198
  v_mov_b32 v219, v198
  v_mov_b32 v220, v198
  v_mov_b32 v221, v198
  v_mov_b32 v222, v198
  v_mov_b32 v223, v198
  s_waitcnt vmcnt(0)
  s_nop 1
  v_mfma_f32_32x32x16_bf16 v[16:31], v[224:227], v[96:99], v[208:223]
  v_mfma_f32_32x32x16_bf16 v[16:31], v[228:231], v[100:103], v[16:31]
  s_nop 7
  s_nop 7
  v_exp_f32 v16, v16
  v_exp_f32 v17, v17
  v_exp_f32 v18, v18
  v_exp_f32 v19, v19
  v_cvt_pk_bf16_f32 v40, v16, v17
  v_exp_f32 v20, v20
  v_exp_f32 v21, v21
  v_cvt_pk_bf16_f32 v41, v18, v19
  v_exp_f32 v22, v22
  v_exp_f32 v23, v23
  v_cvt_pk_bf16_f32 v42, v20, v21
  v_exp_f32 v24, v24
  v_exp_f32 v25, v25
  v_cvt_pk_bf16_f32 v43, v22, v23
  v_exp_f32 v26, v26
  v_exp_f32 v27, v27
  v_cvt_pk_bf16_f32 v44, v24, v25
  v_exp_f32 v28, v28
  v_exp_f32 v29, v29
  v_cvt_pk_bf16_f32 v45, v26, v27
  v_exp_f32 v30, v30
  v_exp_f32 v31, v31
  v_cvt_pk_bf16_f32 v46, v28, v29
  v_cvt_pk_bf16_f32 v47, v30, v31
  s_nop 1
  v_mfma_f32_32x32x16_bf16 v[64:79], v[232:235], v[40:43], v[64:79]
  v_mfma_f32_16x16x32_bf16 v[84:87], v[136:139], v[40:43], v[84:87]
  v_mfma_f32_32x32x16_bf16 v[64:79], v[236:239], v[44:47], v[64:79]
  v_mfma_f32_16x16x32_bf16 v[84:87], v[136:139], v[44:47], v[84:87]
  s_nop 7
  s_nop 7
  s_add_u32 s36, s36, 1
  s_cmp_le_u32 s36, s33
  s_cbranch_scc1 p2_s2_4
  s_nop 7
  s_nop 7
  s_lshl_b32 s7, s12, 16
  s_lshl_b32 s19, s4, 11
  s_add_u32 s7, s7, s19
  s_add_u32 s7, s7, 25165824
  v_rcp_f32 v192, v80
  v_rcp_f32 v194, v84
  s_nop 0
  v_mov_b32 v193, v192
  v_mov_b32 v195, v194
  v_pk_mul_f32 v[48:49], v[48:49], v[192:193]
  v_pk_mul_f32 v[50:51], v[50:51], v[192:193]
  v_pk_mul_f32 v[52:53], v[52:53], v[192:193]
  v_pk_mul_f32 v[54:55], v[54:55], v[192:193]
  v_pk_mul_f32 v[56:57], v[56:57], v[192:193]
  v_pk_mul_f32 v[58:59], v[58:59], v[192:193]
  v_pk_mul_f32 v[60:61], v[60:61], v[192:193]
  v_pk_mul_f32 v[62:63], v[62:63], v[192:193]
  v_cvt_pk_bf16_f32 v48, v48, v49
  v_cvt_pk_bf16_f32 v49, v50, v51
  v_cvt_pk_bf16_f32 v50, v52, v53
  v_cvt_pk_bf16_f32 v51, v54, v55
  v_cvt_pk_bf16_f32 v52, v56, v57
  v_cvt_pk_bf16_f32 v53, v58, v59
  v_cvt_pk_bf16_f32 v54, v60, v61
  v_cvt_pk_bf16_f32 v55, v62, v63
  buffer_store_dwordx4 v[48:51], v188, s[8:11], s7 offen sc1
  buffer_store_dwordx4 v[52:55], v188, s[8:11], s7 offen offset:1024 sc1
  v_pk_mul_f32 v[64:65], v[64:65], v[194:195]
  v_pk_mul_f32 v[66:67], v[66:67], v[194:195]
  v_pk_mul_f32 v[68:69], v[68:69], v[194:195]
  v_pk_mul_f32 v[70:71], v[70:71], v[194:195]
  v_pk_mul_f32 v[72:73], v[72:73], v[194:195]
  v_pk_mul_f32 v[74:75], v[74:75], v[194:195]
  v_pk_mul_f32 v[76:77], v[76:77], v[194:195]
  v_pk_mul_f32 v[78:79], v[78:79], v[194:195]
  v_cvt_pk_bf16_f32 v64, v64, v65
  v_cvt_pk_bf16_f32 v65, v66, v67
  v_cvt_pk_bf16_f32 v66, v68, v69
  v_cvt_pk_bf16_f32 v67, v70, v71
  v_cvt_pk_bf16_f32 v68, v72, v73
  v_cvt_pk_bf16_f32 v69, v74, v75
  v_cvt_pk_bf16_f32 v70, v76, v77
  v_cvt_pk_bf16_f32 v71, v78, v79
  s_add_u32 s7, s7, 65536
  buffer_store_dwordx4 v[64:67], v188, s[8:11], s7 offen sc1
  buffer_store_dwordx4 v[68:71], v188, s[8:11], s7 offen offset:1024 sc1
  s_branch p2_backB
p2_slowA:
  s_waitcnt vmcnt(0)
  s_add_u32 s35, s12, 0
  s_sub_u32 s32, s35, 8
  s_max_i32 s32, s32, 0
  s_mov_b32 s33, s35
  s_lshl_b32 s34, s4, 18
  s_add_u32 s34, s34, 4194304
  v_lshrrev_b32 v197, 4, v188
  v_and_b32 v196, 31, v197
  v_lshrrev_b32 v197, 5, v197
  v_lshlrev_b32 v197, 2, v197
  v_sub_u32 v196, v196, v197
  s_lshl_b32 s7, s35, 5
  v_add_u32 v196, s7, v196
  v_mov_b32 v198, 0xff800000
  v_mov_b32 v199, 0xff800000
  s_mov_b32 s36, s32
p2_s1_5:
  s_lshl_b32 s7, s36, 12
  s_add_u32 s7, s7, s34
  buffer_load_dwordx4 v[224:227], v188, s[8:11], s7 offen offset:0
  buffer_load_dwordx4 v[228:231], v188, s[8:11], s7 offen offset:1024
  s_lshl_b32 s7, s36, 5
  v_subrev_u32 v197, s7, v196
  v_subrev_u32 v201, 0, v197
  v_cmp_gt_u32 vcc, 0x100, v201
  s_nop 1
  v_cndmask_b32 v208, v199, 0, vcc
  v_subrev_u32 v201, 1, v197
  v_cmp_gt_u32 vcc, 0x100, v201
  s_nop 1
  v_cndmask_b32 v209, v199, 0, vcc
  v_subrev_u32 v201, 2, v197
  v_cmp_gt_u32 vcc, 0x100, v201
  s_nop 1
  v_cndmask_b32 v210, v199, 0, vcc
  v_subrev_u32 v201, 3, v197
  v_cmp_gt_u32 vcc, 0x100, v201
  s_nop 1
  v_cndmask_b32 v211, v199, 0, vcc
  v_subrev_u32 v201, 16, v197
  v_cmp_gt_u32 vcc, 0x100, v201
  s_nop 1
  v_cndmask_b32 v212, v199, 0, vcc
  v_subrev_u32 v201, 17, v197
  v_cmp_gt_u32 vcc, 0x100, v201
  s_nop 1
  v_cndmask_b32 v213, v199, 0, vcc
  v_subrev_u32 v201, 18, v197
  v_cmp_gt_u32 vcc, 0x100, v201
  s_nop 1
  v_cndmask_b32 v214, v199, 0, vcc
  v_subrev_u32 v201, 19, v197
  v_cmp_gt_u32 vcc, 0x100, v201
  s_nop 1
  v_cndmask_b32 v215, v199, 0, vcc
  v_subrev_u32 v201, 8, v197
  v_cmp_gt_u32 vcc, 0x100, v201
  s_nop 1
  v_cndmask_b32 v216, v199, 0, vcc
  v_subrev_u32 v201, 9, v197
  v_cmp_gt_u32 vcc, 0x100, v201
  s_nop 1
  v_cndmask_b32 v217, v199, 0, vcc
  v_subrev_u32 v201, 10, v197
  v_cmp_gt_u32 vcc, 0x100, v201
  s_nop 1
  v_cndmask_b32 v218, v199, 0, vcc
  v_subrev_u32 v201, 11, v197
  v_cmp_gt_u32 vcc, 0x100, v201
  s_nop 1
  v_cndmask_b32 v219, v199, 0, vcc
  v_subrev_u32 v201, 24, v197
  v_cmp_gt_u32 vcc, 0x100, v201
  s_nop 1
  v_cndmask_b32 v220, v199, 0, vcc
  v_subrev_u32 v201, 25, v197
  v_cmp_gt_u32 vcc, 0x100, v201
  s_nop 1
  v_cndmask_b32 v221, v199, 0, vcc
  v_subrev_u32 v201, 26, v197
  v_cmp_gt_u32 vcc, 0x100, v201
  s_nop 1
  v_cndmask_b32 v222, v199, 0, vcc
  v_subrev_u32 v201, 27, v197
  v_cmp_gt_u32 vcc, 0x100, v201
  s_nop 1
  v_cndmask_b32 v223, v199, 0, vcc
  s_waitcnt vmcnt(0)
  s_nop 1
  v_mfma_f32_32x32x16_bf16 v[0:15], v[224:227], v[172:175], v[208:223]
  v_mfma_f32_32x32x16_bf16 v[0:15], v[228:231], v[176:179], v[0:15]
  s_nop 7
  s_nop 7
  v_max3_f32 v198, v0, v1, v198
  v_max3_f32 v198, v2, v3, v198
  v_max3_f32 v198, v4, v5, v198
  v_max3_f32 v198, v6, v7, v198
  v_max3_f32 v198, v8, v9, v198
  v_max3_f32 v198, v10, v11, v198
  v_max3_f32 v198, v12, v13, v198
  v_max3_f32 v198, v14, v15, v198
  s_add_u32 s36, s36, 1
  s_cmp_le_u32 s36, s33
  s_cbranch_scc1 p2_s1_5
  v_mov_b32 v200, v198
  s_nop 1
  v_permlane32_swap_b32 v198, v200
  s_nop 1
  v_max_f32 v198, v198, v200
  v_sub_f32 v198, 0, v198
  v_mov_b32 v48, 0
  v_mov_b32 v49, 0
  v_mov_b32 v50, 0
  v_mov_b32 v51, 0
  v_mov_b32 v52, 0
  v_mov_b32 v53, 0
  v_mov_b32 v54, 0
  v_mov_b32 v55, 0
  v_mov_b32 v56, 0
  v_mov_b32 v57, 0
  v_mov_b32 v58, 0
  v_mov_b32 v59, 0
  v_mov_b32 v60, 0
  v_mov_b32 v61, 0
  v_mov_b32 v62, 0
  v_mov_b32 v63, 0
  v_mov_b32 v80, 0
  v_mov_b32 v81, 0
  v_mov_b32 v82, 0
  v_mov_b32 v83, 0
  s_mov_b32 s36, s32
p2_s2_6:
  s_lshl_b32 s7, s36, 12
  s_add_u32 s7, s7, s34
  buffer_load_dwordx4 v[224:227], v188, s[8:11], s7 offen offset:0
  buffer_load_dwordx4 v[228:231], v188, s[8:11], s7 offen offset:1024
  buffer_load_dwordx4 v[232:235], v188, s[8:11], s7 offen offset:2048
  buffer_load_dwordx4 v[236:239], v188, s[8:11], s7 offen offset:3072
  s_lshl_b32 s7, s36, 5
  v_subrev_u32 v197, s7, v196
  v_subrev_u32 v201, 0, v197
  v_cmp_gt_u32 vcc, 0x100, v201
  s_nop 1
  v_cndmask_b32 v208, v199, v198, vcc
  v_subrev_u32 v201, 1, v197
  v_cmp_gt_u32 vcc, 0x100, v201
  s_nop 1
  v_cndmask_b32 v209, v199, v198, vcc
  v_subrev_u32 v201, 2, v197
  v_cmp_gt_u32 vcc, 0x100, v201
  s_nop 1
  v_cndmask_b32 v210, v199, v198, vcc
  v_subrev_u32 v201, 3, v197
  v_cmp_gt_u32 vcc, 0x100, v201
  s_nop 1
  v_cndmask_b32 v211, v199, v198, vcc
  v_subrev_u32 v201, 16, v197
  v_cmp_gt_u32 vcc, 0x100, v201
  s_nop 1
  v_cndmask_b32 v212, v199, v198, vcc
  v_subrev_u32 v201, 17, v197
  v_cmp_gt_u32 vcc, 0x100, v201
  s_nop 1
  v_cndmask_b32 v213, v199, v198, vcc
  v_subrev_u32 v201, 18, v197
  v_cmp_gt_u32 vcc, 0x100, v201
  s_nop 1
  v_cndmask_b32 v214, v199, v198, vcc
  v_subrev_u32 v201, 19, v197
  v_cmp_gt_u32 vcc, 0x100, v201
  s_nop 1
  v_cndmask_b32 v215, v199, v198, vcc
  v_subrev_u32 v201, 8, v197
  v_cmp_gt_u32 vcc, 0x100, v201
  s_nop 1
  v_cndmask_b32 v216, v199, v198, vcc
  v_subrev_u32 v201, 9, v197
  v_cmp_gt_u32 vcc, 0x100, v201
  s_nop 1
  v_cndmask_b32 v217, v199, v198, vcc
  v_subrev_u32 v201, 10, v197
  v_cmp_gt_u32 vcc, 0x100, v201
  s_nop 1
  v_cndmask_b32 v218, v199, v198, vcc
  v_subrev_u32 v201, 11, v197
  v_cmp_gt_u32 vcc, 0x100, v201
  s_nop 1
  v_cndmask_b32 v219, v199, v198, vcc
  v_subrev_u32 v201, 24, v197
  v_cmp_gt_u32 vcc, 0x100, v201
  s_nop 1
  v_cndmask_b32 v220, v199, v198, vcc
  v_subrev_u32 v201, 25, v197
  v_cmp_gt_u32 vcc, 0x100, v201
  s_nop 1
  v_cndmask_b32 v221, v199, v198, vcc
  v_subrev_u32 v201, 26, v197
  v_cmp_gt_u32 vcc, 0x100, v201
  s_nop 1
  v_cndmask_b32 v222, v199, v198, vcc
  v_subrev_u32 v201, 27, v197
  v_cmp_gt_u32 vcc, 0x100, v201
  s_nop 1
  v_cndmask_b32 v223, v199, v198, vcc
  s_waitcnt vmcnt(0)
  s_nop 1
  v_mfma_f32_32x32x16_bf16 v[0:15], v[224:227], v[172:175], v[208:223]
  v_mfma_f32_32x32x16_bf16 v[0:15], v[228:231], v[176:179], v[0:15]
  s_nop 7
  s_nop 7
  v_exp_f32 v0, v0
  v_exp_f32 v1, v1
  v_exp_f32 v2, v2
  v_exp_f32 v3, v3
  v_cvt_pk_bf16_f32 v32, v0, v1
  v_exp_f32 v4, v4
  v_exp_f32 v5, v5
  v_cvt_pk_bf16_f32 v33, v2, v3
  v_exp_f32 v6, v6
  v_exp_f32 v7, v7
  v_cvt_pk_bf16_f32 v34, v4, v5
  v_exp_f32 v8, v8
  v_exp_f32 v9, v9
  v_cvt_pk_bf16_f32 v35, v6, v7
  v_exp_f32 v10, v10
  v_exp_f32 v11, v11
  v_cvt_pk_bf16_f32 v36, v8, v9
  v_exp_f32 v12, v12
  v_exp_f32 v13, v13
  v_cvt_pk_bf16_f32 v37, v10, v11
  v_exp_f32 v14, v14
  v_exp_f32 v15, v15
  v_cvt_pk_bf16_f32 v38, v12, v13
  v_cvt_pk_bf16_f32 v39, v14, v15
  s_nop 1
  v_mfma_f32_32x32x16_bf16 v[48:63], v[232:235], v[32:35], v[48:63]
  v_mfma_f32_16x16x32_bf16 v[80:83], v[136:139], v[32:35], v[80:83]
  v_mfma_f32_32x32x16_bf16 v[48:63], v[236:239], v[36:39], v[48:63]
  v_mfma_f32_16x16x32_bf16 v[80:83], v[136:139], v[36:39], v[80:83]
  s_nop 7
  s_nop 7
  s_add_u32 s36, s36, 1
  s_cmp_le_u32 s36, s33
  s_cbranch_scc1 p2_s2_6
  s_add_u32 s35, s12, 1
  s_sub_u32 s32, s35, 8
  s_max_i32 s32, s32, 0
  s_mov_b32 s33, s35
  s_lshl_b32 s34, s4, 18
  s_add_u32 s34, s34, 4194304
  v_lshrrev_b32 v197, 4, v188
  v_and_b32 v196, 31, v197
  v_lshrrev_b32 v197, 5, v197
  v_lshlrev_b32 v197, 2, v197
  v_sub_u32 v196, v196, v197
  s_lshl_b32 s7, s35, 5
  v_add_u32 v196, s7, v196
  v_mov_b32 v198, 0xff800000
  v_mov_b32 v199, 0xff800000
  s_mov_b32 s36, s32
p2_s1_7:
  s_lshl_b32 s7, s36, 12
  s_add_u32 s7, s7, s34
  buffer_load_dwordx4 v[224:227], v188, s[8:11], s7 offen offset:0
  buffer_load_dwordx4 v[228:231], v188, s[8:11], s7 offen offset:1024
  s_lshl_b32 s7, s36, 5
  v_subrev_u32 v197, s7, v196
  v_subrev_u32 v201, 0, v197
  v_cmp_gt_u32 vcc, 0x100, v201
  s_nop 1
  v_cndmask_b32 v208, v199, 0, vcc
  v_subrev_u32 v201, 1, v197
  v_cmp_gt_u32 vcc, 0x100, v201
  s_nop 1
  v_cndmask_b32 v209, v199, 0, vcc
  v_subrev_u32 v201, 2, v197
  v_cmp_gt_u32 vcc, 0x100, v201
  s_nop 1
  v_cndmask_b32 v210, v199, 0, vcc
  v_subrev_u32 v201, 3, v197
  v_cmp_gt_u32 vcc, 0x100, v201
  s_nop 1
  v_cndmask_b32 v211, v199, 0, vcc
  v_subrev_u32 v201, 16, v197
  v_cmp_gt_u32 vcc, 0x100, v201
  s_nop 1
  v_cndmask_b32 v212, v199, 0, vcc
  v_subrev_u32 v201, 17, v197
  v_cmp_gt_u32 vcc, 0x100, v201
  s_nop 1
  v_cndmask_b32 v213, v199, 0, vcc
  v_subrev_u32 v201, 18, v197
  v_cmp_gt_u32 vcc, 0x100, v201
  s_nop 1
  v_cndmask_b32 v214, v199, 0, vcc
  v_subrev_u32 v201, 19, v197
  v_cmp_gt_u32 vcc, 0x100, v201
  s_nop 1
  v_cndmask_b32 v215, v199, 0, vcc
  v_subrev_u32 v201, 8, v197
  v_cmp_gt_u32 vcc, 0x100, v201
  s_nop 1
  v_cndmask_b32 v216, v199, 0, vcc
  v_subrev_u32 v201, 9, v197
  v_cmp_gt_u32 vcc, 0x100, v201
  s_nop 1
  v_cndmask_b32 v217, v199, 0, vcc
  v_subrev_u32 v201, 10, v197
  v_cmp_gt_u32 vcc, 0x100, v201
  s_nop 1
  v_cndmask_b32 v218, v199, 0, vcc
  v_subrev_u32 v201, 11, v197
  v_cmp_gt_u32 vcc, 0x100, v201
  s_nop 1
  v_cndmask_b32 v219, v199, 0, vcc
  v_subrev_u32 v201, 24, v197
  v_cmp_gt_u32 vcc, 0x100, v201
  s_nop 1
  v_cndmask_b32 v220, v199, 0, vcc
  v_subrev_u32 v201, 25, v197
  v_cmp_gt_u32 vcc, 0x100, v201
  s_nop 1
  v_cndmask_b32 v221, v199, 0, vcc
  v_subrev_u32 v201, 26, v197
  v_cmp_gt_u32 vcc, 0x100, v201
  s_nop 1
  v_cndmask_b32 v222, v199, 0, vcc
  v_subrev_u32 v201, 27, v197
  v_cmp_gt_u32 vcc, 0x100, v201
  s_nop 1
  v_cndmask_b32 v223, v199, 0, vcc
  s_waitcnt vmcnt(0)
  s_nop 1
  v_mfma_f32_32x32x16_bf16 v[16:31], v[224:227], v[180:183], v[208:223]
  v_mfma_f32_32x32x16_bf16 v[16:31], v[228:231], v[184:187], v[16:31]
  s_nop 7
  s_nop 7
  v_max3_f32 v198, v16, v17, v198
  v_max3_f32 v198, v18, v19, v198
  v_max3_f32 v198, v20, v21, v198
  v_max3_f32 v198, v22, v23, v198
  v_max3_f32 v198, v24, v25, v198
  v_max3_f32 v198, v26, v27, v198
  v_max3_f32 v198, v28, v29, v198
  v_max3_f32 v198, v30, v31, v198
  s_add_u32 s36, s36, 1
  s_cmp_le_u32 s36, s33
  s_cbranch_scc1 p2_s1_7
  v_mov_b32 v200, v198
  s_nop 1
  v_permlane32_swap_b32 v198, v200
  s_nop 1
  v_max_f32 v198, v198, v200
  v_sub_f32 v198, 0, v198
  v_mov_b32 v64, 0
  v_mov_b32 v65, 0
  v_mov_b32 v66, 0
  v_mov_b32 v67, 0
  v_mov_b32 v68, 0
  v_mov_b32 v69, 0
  v_mov_b32 v70, 0
  v_mov_b32 v71, 0
  v_mov_b32 v72, 0
  v_mov_b32 v73, 0
  v_mov_b32 v74, 0
  v_mov_b32 v75, 0
  v_mov_b32 v76, 0
  v_mov_b32 v77, 0
  v_mov_b32 v78, 0
  v_mov_b32 v79, 0
  v_mov_b32 v84, 0
  v_mov_b32 v85, 0
  v_mov_b32 v86, 0
  v_mov_b32 v87, 0
  s_mov_b32 s36, s32
p2_s2_8:
  s_lshl_b32 s7, s36, 12
  s_add_u32 s7, s7, s34
  buffer_load_dwordx4 v[224:227], v188, s[8:11], s7 offen offset:0
  buffer_load_dwordx4 v[228:231], v188, s[8:11], s7 offen offset:1024
  buffer_load_dwordx4 v[232:235], v188, s[8:11], s7 offen offset:2048
  buffer_load_dwordx4 v[236:239], v188, s[8:11], s7 offen offset:3072
  s_lshl_b32 s7, s36, 5
  v_subrev_u32 v197, s7, v196
  v_subrev_u32 v201, 0, v197
  v_cmp_gt_u32 vcc, 0x100, v201
  s_nop 1
  v_cndmask_b32 v208, v199, v198, vcc
  v_subrev_u32 v201, 1, v197
  v_cmp_gt_u32 vcc, 0x100, v201
  s_nop 1
  v_cndmask_b32 v209, v199, v198, vcc
  v_subrev_u32 v201, 2, v197
  v_cmp_gt_u32 vcc, 0x100, v201
  s_nop 1
  v_cndmask_b32 v210, v199, v198, vcc
  v_subrev_u32 v201, 3, v197
  v_cmp_gt_u32 vcc, 0x100, v201
  s_nop 1
  v_cndmask_b32 v211, v199, v198, vcc
  v_subrev_u32 v201, 16, v197
  v_cmp_gt_u32 vcc, 0x100, v201
  s_nop 1
  v_cndmask_b32 v212, v199, v198, vcc
  v_subrev_u32 v201, 17, v197
  v_cmp_gt_u32 vcc, 0x100, v201
  s_nop 1
  v_cndmask_b32 v213, v199, v198, vcc
  v_subrev_u32 v201, 18, v197
  v_cmp_gt_u32 vcc, 0x100, v201
  s_nop 1
  v_cndmask_b32 v214, v199, v198, vcc
  v_subrev_u32 v201, 19, v197
  v_cmp_gt_u32 vcc, 0x100, v201
  s_nop 1
  v_cndmask_b32 v215, v199, v198, vcc
  v_subrev_u32 v201, 8, v197
  v_cmp_gt_u32 vcc, 0x100, v201
  s_nop 1
  v_cndmask_b32 v216, v199, v198, vcc
  v_subrev_u32 v201, 9, v197
  v_cmp_gt_u32 vcc, 0x100, v201
  s_nop 1
  v_cndmask_b32 v217, v199, v198, vcc
  v_subrev_u32 v201, 10, v197
  v_cmp_gt_u32 vcc, 0x100, v201
  s_nop 1
  v_cndmask_b32 v218, v199, v198, vcc
  v_subrev_u32 v201, 11, v197
  v_cmp_gt_u32 vcc, 0x100, v201
  s_nop 1
  v_cndmask_b32 v219, v199, v198, vcc
  v_subrev_u32 v201, 24, v197
  v_cmp_gt_u32 vcc, 0x100, v201
  s_nop 1
  v_cndmask_b32 v220, v199, v198, vcc
  v_subrev_u32 v201, 25, v197
  v_cmp_gt_u32 vcc, 0x100, v201
  s_nop 1
  v_cndmask_b32 v221, v199, v198, vcc
  v_subrev_u32 v201, 26, v197
  v_cmp_gt_u32 vcc, 0x100, v201
  s_nop 1
  v_cndmask_b32 v222, v199, v198, vcc
  v_subrev_u32 v201, 27, v197
  v_cmp_gt_u32 vcc, 0x100, v201
  s_nop 1
  v_cndmask_b32 v223, v199, v198, vcc
  s_waitcnt vmcnt(0)
  s_nop 1
  v_mfma_f32_32x32x16_bf16 v[16:31], v[224:227], v[180:183], v[208:223]
  v_mfma_f32_32x32x16_bf16 v[16:31], v[228:231], v[184:187], v[16:31]
  s_nop 7
  s_nop 7
  v_exp_f32 v16, v16
  v_exp_f32 v17, v17
  v_exp_f32 v18, v18
  v_exp_f32 v19, v19
  v_cvt_pk_bf16_f32 v40, v16, v17
  v_exp_f32 v20, v20
  v_exp_f32 v21, v21
  v_cvt_pk_bf16_f32 v41, v18, v19
  v_exp_f32 v22, v22
  v_exp_f32 v23, v23
  v_cvt_pk_bf16_f32 v42, v20, v21
  v_exp_f32 v24, v24
  v_exp_f32 v25, v25
  v_cvt_pk_bf16_f32 v43, v22, v23
  v_exp_f32 v26, v26
  v_exp_f32 v27, v27
  v_cvt_pk_bf16_f32 v44, v24, v25
  v_exp_f32 v28, v28
  v_exp_f32 v29, v29
  v_cvt_pk_bf16_f32 v45, v26, v27
  v_exp_f32 v30, v30
  v_exp_f32 v31, v31
  v_cvt_pk_bf16_f32 v46, v28, v29
  v_cvt_pk_bf16_f32 v47, v30, v31
  s_nop 1
  v_mfma_f32_32x32x16_bf16 v[64:79], v[232:235], v[40:43], v[64:79]
  v_mfma_f32_16x16x32_bf16 v[84:87], v[136:139], v[40:43], v[84:87]
  v_mfma_f32_32x32x16_bf16 v[64:79], v[236:239], v[44:47], v[64:79]
  v_mfma_f32_16x16x32_bf16 v[84:87], v[136:139], v[44:47], v[84:87]
  s_nop 7
  s_nop 7
  s_add_u32 s36, s36, 1
  s_cmp_le_u32 s36, s33
  s_cbranch_scc1 p2_s2_8
  s_nop 7
  s_nop 7
  s_lshl_b32 s7, s12, 16
  s_lshl_b32 s19, s4, 11
  s_add_u32 s7, s7, s19
  s_add_u32 s7, s7, 20971520
  v_rcp_f32 v192, v80
  v_rcp_f32 v194, v84
  s_nop 0
  v_mov_b32 v193, v192
  v_mov_b32 v195, v194
  v_pk_mul_f32 v[48:49], v[48:49], v[192:193]
  v_pk_mul_f32 v[50:51], v[50:51], v[192:193]
  v_pk_mul_f32 v[52:53], v[52:53], v[192:193]
  v_pk_mul_f32 v[54:55], v[54:55], v[192:193]
  v_pk_mul_f32 v[56:57], v[56:57], v[192:193]
  v_pk_mul_f32 v[58:59], v[58:59], v[192:193]
  v_pk_mul_f32 v[60:61], v[60:61], v[192:193]
  v_pk_mul_f32 v[62:63], v[62:63], v[192:193]
  v_cvt_pk_bf16_f32 v48, v48, v49
  v_cvt_pk_bf16_f32 v49, v50, v51
  v_cvt_pk_bf16_f32 v50, v52, v53
  v_cvt_pk_bf16_f32 v51, v54, v55
  v_cvt_pk_bf16_f32 v52, v56, v57
  v_cvt_pk_bf16_f32 v53, v58, v59
  v_cvt_pk_bf16_f32 v54, v60, v61
  v_cvt_pk_bf16_f32 v55, v62, v63
  buffer_store_dwordx4 v[48:51], v188, s[8:11], s7 offen sc1
  buffer_store_dwordx4 v[52:55], v188, s[8:11], s7 offen offset:1024 sc1
  v_pk_mul_f32 v[64:65], v[64:65], v[194:195]
  v_pk_mul_f32 v[66:67], v[66:67], v[194:195]
  v_pk_mul_f32 v[68:69], v[68:69], v[194:195]
  v_pk_mul_f32 v[70:71], v[70:71], v[194:195]
  v_pk_mul_f32 v[72:73], v[72:73], v[194:195]
  v_pk_mul_f32 v[74:75], v[74:75], v[194:195]
  v_pk_mul_f32 v[76:77], v[76:77], v[194:195]
  v_pk_mul_f32 v[78:79], v[78:79], v[194:195]
  v_cvt_pk_bf16_f32 v64, v64, v65
  v_cvt_pk_bf16_f32 v65, v66, v67
  v_cvt_pk_bf16_f32 v66, v68, v69
  v_cvt_pk_bf16_f32 v67, v70, v71
  v_cvt_pk_bf16_f32 v68, v72, v73
  v_cvt_pk_bf16_f32 v69, v74, v75
  v_cvt_pk_bf16_f32 v70, v76, v77
  v_cvt_pk_bf16_f32 v71, v78, v79
  s_add_u32 s7, s7, 65536
  buffer_store_dwordx4 v[64:67], v188, s[8:11], s7 offen sc1
  buffer_store_dwordx4 v[68:71], v188, s[8:11], s7 offen offset:1024 sc1
  s_branch p2_backA
p2_loader:
  s_sub_u32 s3, s3, 4
  s_lshl_b32 s15, s3, 12
  s_add_u32 s16, s15, 16779264
  s_add_u32 s17, s15, 65536
  s_add_u32 s24, s15, 131072
  s_lshl_b32 s7, s5, 3
  s_lshl_b32 s19, s3, 2
  s_add_u32 s7, s7, s19
  s_sub_u32 s7, s7, 8
  s_max_i32 s7, s7, 0
  s_lshl_b32 s7, s7, 12
  s_lshl_b32 s19, s4, 18
  s_add_u32 s7, s7, s19
  s_add_u32 s20, s7, 4194304
  s_lshl_b32 s21, s3, 14
  s_lshl_b32 s7, s5, 3
  s_lshl_b32 s19, s3, 1
  s_add_u32 s7, s7, s19
  s_lshl_b32 s7, s7, 11
  s_lshl_b32 s19, s4, 17
  s_add_u32 s7, s7, s19
  s_add_u32 s23, s7, 0
  s_bitcmp1_b32 s2, 2
  s_cbranch_scc1 p2_woB
  s_load_dwordx2 s[12:13], s[0:1], 16
  s_branch p2_woj
p2_woB:
  s_load_dwordx2 s[12:13], s[0:1], 56
p2_woj:
  s_mov_b32 s14, 0x200000
  s_mov_b32 s15, 0x20000
  s_lshr_b32 s7, s2, 3
  s_lshl_b32 s7, s7, 16
  s_lshl_b32 s19, s3, 14
  s_add_u32 s22, s7, s19
  v_lshlrev_b32 v1, 7, v0
  s_waitcnt lgkmcnt(0)
  s_add_u32 m0, s17, 0
  s_add_u32 s19, s16, 0
  buffer_load_dwordx4 v188, s[8:11], s19 offen offset:0 lds
  buffer_load_dwordx4 v188, s[8:11], s19 offen offset:1024 lds
  buffer_load_dwordx4 v188, s[8:11], s19 offen offset:2048 lds
  buffer_load_dwordx4 v188, s[8:11], s19 offen offset:3072 lds
  s_add_u32 m0, s17, 16384
  s_add_u32 s19, s16, 16384
  buffer_load_dwordx4 v188, s[8:11], s19 offen offset:0 lds
  buffer_load_dwordx4 v188, s[8:11], s19 offen offset:1024 lds
  buffer_load_dwordx4 v188, s[8:11], s19 offen offset:2048 lds
  buffer_load_dwordx4 v188, s[8:11], s19 offen offset:3072 lds
  s_waitcnt vmcnt(4)
  s_barrier
  s_add_u32 m0, s17, 32768
  s_add_u32 s19, s16, 32768
  buffer_load_dwordx4 v188, s[8:11], s19 offen offset:0 lds
  buffer_load_dwordx4 v188, s[8:11], s19 offen offset:1024 lds
  buffer_load_dwordx4 v188, s[8:11], s19 offen offset:2048 lds
  buffer_load_dwordx4 v188, s[8:11], s19 offen offset:3072 lds
  s_add_u32 m0, s17, 49152
  s_add_u32 s19, s16, 49152
  buffer_load_dwordx4 v188, s[8:11], s19 offen offset:0 lds
  buffer_load_dwordx4 v188, s[8:11], s19 offen offset:1024 lds
  buffer_load_dwordx4 v188, s[8:11], s19 offen offset:2048 lds
  buffer_load_dwordx4 v188, s[8:11], s19 offen offset:3072 lds
  s_add_u32 m0, s21, 0
  s_add_u32 s19, s20, 0
  buffer_load_dwordx4 v188, s[8:11], s19 offen offset:0 lds
  buffer_load_dwordx4 v188, s[8:11], s19 offen offset:1024 lds
  buffer_load_dwordx4 v188, s[8:11], s19 offen offset:2048 lds
  buffer_load_dwordx4 v188, s[8:11], s19 offen offset:3072 lds
  s_add_u32 m0, s21, 4096
  s_add_u32 s19, s20, 4096
  buffer_load_dwordx4 v188, s[8:11], s19 offen offset:0 lds
  buffer_load_dwordx4 v188, s[8:11], s19 offen offset:1024 lds
  buffer_load_dwordx4 v188, s[8:11], s19 offen offset:2048 lds
  buffer_load_dwordx4 v188, s[8:11], s19 offen offset:3072 lds
  s_add_u32 m0, s21, 8192
  s_add_u32 s19, s20, 8192
  buffer_load_dwordx4 v188, s[8:11], s19 offen offset:0 lds
  buffer_load_dwordx4 v188, s[8:11], s19 offen offset:1024 lds
  buffer_load_dwordx4 v188, s[8:11], s19 offen offset:2048 lds
  buffer_load_dwordx4 v188, s[8:11], s19 offen offset:3072 lds
  s_add_u32 m0, s21, 12288
  s_add_u32 s19, s20, 12288
  buffer_load_dwordx4 v188, s[8:11], s19 offen offset:0 lds
  buffer_load_dwordx4 v188, s[8:11], s19 offen offset:1024 lds
  buffer_load_dwordx4 v188, s[8:11], s19 offen offset:2048 lds
  buffer_load_dwordx4 v188, s[8:11], s19 offen offset:3072 lds
  s_mov_b32 m0, s24
  s_nop 0
  buffer_load_dwordx4 v188, s[8:11], s23 offen offset:0 lds
  buffer_load_dwordx4 v188, s[8:11], s23 offen offset:1024 lds
  buffer_load_dwordx4 v188, s[8:11], s23 offen offset:2048 lds
  buffer_load_dwordx4 v188, s[8:11], s23 offen offset:3072 lds
  s_waitcnt vmcnt(28)
  s_barrier
  s_add_u32 m0, s17, 0
  s_add_u32 s19, s16, 65536
  buffer_load_dwordx4 v188, s[8:11], s19 offen offset:0 lds
  buffer_load_dwordx4 v188, s[8:11], s19 offen offset:1024 lds
  buffer_load_dwordx4 v188, s[8:11], s19 offen offset:2048 lds
  buffer_load_dwordx4 v188, s[8:11], s19 offen offset:3072 lds
  s_waitcnt vmcnt(28)
  s_barrier
  s_add_u32 m0, s17, 16384
  s_add_u32 s19, s16, 81920
  buffer_load_dwordx4 v188, s[8:11], s19 offen offset:0 lds
  buffer_load_dwordx4 v188, s[8:11], s19 offen offset:1024 lds
  buffer_load_dwordx4 v188, s[8:11], s19 offen offset:2048 lds
  buffer_load_dwordx4 v188, s[8:11], s19 offen offset:3072 lds
  s_waitcnt vmcnt(28)
  s_barrier
  s_add_u32 m0, s17, 32768
  s_add_u32 s19, s16, 98304
  buffer_load_dwordx4 v188, s[8:11], s19 offen offset:0 lds
  buffer_load_dwordx4 v188, s[8:11], s19 offen offset:1024 lds
  buffer_load_dwordx4 v188, s[8:11], s19 offen offset:2048 lds
  buffer_load_dwordx4 v188, s[8:11], s19 offen offset:3072 lds
  s_waitcnt vmcnt(8)
  s_barrier
  s_add_u32 m0, s17, 49152
  s_add_u32 s19, s16, 114688
  buffer_load_dwordx4 v188, s[8:11], s19 offen offset:0 lds
  buffer_load_dwordx4 v188, s[8:11], s19 offen offset:1024 lds
  buffer_load_dwordx4 v188, s[8:11], s19 offen offset:2048 lds
  buffer_load_dwordx4 v188, s[8:11], s19 offen offset:3072 lds
  s_waitcnt vmcnt(8)
  s_barrier
  s_add_u32 m0, s17, 0
  s_add_u32 s19, s16, 131072
  buffer_load_dwordx4 v188, s[8:11], s19 offen offset:0 lds
  buffer_load_dwordx4 v188, s[8:11], s19 offen offset:1024 lds
  buffer_load_dwordx4 v188, s[8:11], s19 offen offset:2048 lds
  buffer_load_dwordx4 v188, s[8:11], s19 offen offset:3072 lds
  s_waitcnt vmcnt(8)
  s_barrier
  s_add_u32 m0, s17, 16384
  s_add_u32 s19, s16, 147456
  buffer_load_dwordx4 v188, s[8:11], s19 offen offset:0 lds
  buffer_load_dwordx4 v188, s[8:11], s19 offen offset:1024 lds
  buffer_load_dwordx4 v188, s[8:11], s19 offen offset:2048 lds
  buffer_load_dwordx4 v188, s[8:11], s19 offen offset:3072 lds
  s_add_u32 s19, s22, 0
  buffer_load_dword v2, v1, s[12:15], s19 offen
  s_waitcnt vmcnt(9)
  s_barrier
  s_add_u32 m0, s17, 32768
  s_add_u32 s19, s16, 163840
  buffer_load_dwordx4 v188, s[8:11], s19 offen offset:0 lds
  buffer_load_dwordx4 v188, s[8:11], s19 offen offset:1024 lds
  buffer_load_dwordx4 v188, s[8:11], s19 offen offset:2048 lds
  buffer_load_dwordx4 v188, s[8:11], s19 offen offset:3072 lds
  s_waitcnt vmcnt(9)
  s_barrier
  s_add_u32 m0, s17, 49152
  s_add_u32 s19, s16, 180224
  buffer_load_dwordx4 v188, s[8:11], s19 offen offset:0 lds
  buffer_load_dwordx4 v188, s[8:11], s19 offen offset:1024 lds
  buffer_load_dwordx4 v188, s[8:11], s19 offen offset:2048 lds
  buffer_load_dwordx4 v188, s[8:11], s19 offen offset:3072 lds
  s_waitcnt vmcnt(9)
  s_barrier
  s_add_u32 m0, s17, 0
  s_add_u32 s19, s16, 196608
  buffer_load_dwordx4 v188, s[8:11], s19 offen offset:0 lds
  buffer_load_dwordx4 v188, s[8:11], s19 offen offset:1024 lds
  buffer_load_dwordx4 v188, s[8:11], s19 offen offset:2048 lds
  buffer_load_dwordx4 v188, s[8:11], s19 offen offset:3072 lds
  s_waitcnt vmcnt(8)
  s_barrier
  s_add_u32 m0, s17, 16384
  s_add_u32 s19, s16, 212992
  buffer_load_dwordx4 v188, s[8:11], s19 offen offset:0 lds
  buffer_load_dwordx4 v188, s[8:11], s19 offen offset:1024 lds
  buffer_load_dwordx4 v188, s[8:11], s19 offen offset:2048 lds
  buffer_load_dwordx4 v188, s[8:11], s19 offen offset:3072 lds
  s_add_u32 s19, s22, 8192
  buffer_load_dword v3, v1, s[12:15], s19 offen
  s_waitcnt vmcnt(9)
  s_barrier
  s_add_u32 m0, s17, 32768
  s_add_u32 s19, s16, 229376
  buffer_load_dwordx4 v188, s[8:11], s19 offen offset:0 lds
  buffer_load_dwordx4 v188, s[8:11], s19 offen offset:1024 lds
  buffer_load_dwordx4 v188, s[8:11], s19 offen offset:2048 lds
  buffer_load_dwordx4 v188, s[8:11], s19 offen offset:3072 lds
  s_waitcnt vmcnt(9)
  s_barrier
  s_add_u32 m0, s17, 49152
  s_add_u32 s19, s16, 245760
  buffer_load_dwordx4 v188, s[8:11], s19 offen offset:0 lds
  buffer_load_dwordx4 v188, s[8:11], s19 offen offset:1024 lds
  buffer_load_dwordx4 v188, s[8:11], s19 offen offset:2048 lds
  buffer_load_dwordx4 v188, s[8:11], s19 offen offset:3072 lds
  s_getpc_b64 s[56:57]
ct_9:
  s_add_u32 s56, s56, concat_heads__sliding_block__grouped_kv_mqa__prompt_kernel-ct_9
  s_addc_u32 s57, s57, 0
  s_mov_b32 s58, p3_exit-concat_heads__sliding_block__grouped_kv_mqa__prompt_kernel
  s_mov_b32 s59, 0x20000
  s_lshl_b32 s7, s3, 13
  v_lshlrev_b32 v40, 7, v0
  v_add_u32 v40, s7, v40
  buffer_load_dword v41, v40, s[56:59], 0 offen
  s_waitcnt vmcnt(10)
  s_barrier
  s_waitcnt vmcnt(5)
  s_barrier
  s_waitcnt vmcnt(1)
  s_barrier
  s_waitcnt vmcnt(51)
  s_barrier
  s_waitcnt vmcnt(0)
  s_endpgm
p2_exit:
  s_endpgm
  .globl concat_heads__sliding_block__grouped_kv_mqa__prompt_kernel
  .p2align 8
  .type concat_heads__sliding_block__grouped_kv_mqa__prompt_kernel,@function
concat_heads__sliding_block__grouped_kv_mqa__prompt_kernel:
  s_cmp_ge_u32 s2, 256
  s_cbranch_scc1 p3_exit
  v_lshrrev_b32 v1, 6, v0
  v_and_b32 v0, 63, v0
  s_and_b32 s7, s2, 7
  v_readfirstlane_b32 s3, v1
  s_lshr_b32 s4, s7, 2
  s_and_b32 s7, s7, 3
  s_lshl_b32 s7, s7, 2
  s_lshr_b32 s6, s2, 3
  s_and_b32 s5, s6, 3
  s_add_u32 s5, s5, s7
  s_lshr_b32 s6, s6, 2
  s_load_dwordx2 s[8:9], s[0:1], 80
  s_load_dwordx2 s[20:21], s[0:1], 64
  s_cmp_eq_u32 s4, 1
  s_cbranch_scc1 p3_isB
  s_load_dwordx2 s[12:13], s[0:1], 16
  s_branch p3_ptrs
p3_isB:
  s_load_dwordx2 s[12:13], s[0:1], 56
p3_ptrs:
  s_mov_b32 s10, 0x2000000
  s_mov_b32 s11, 0x20000
  s_mov_b32 s14, 0x200000
  s_mov_b32 s15, 0x20000
  s_mov_b32 s22, 0x800000
  s_mov_b32 s23, 0x20000
  s_cmp_ge_u32 s3, 4
  s_cbranch_scc1 p3_loader
  s_lshr_b32 s24, s3, 1
  s_and_b32 s25, s3, 1
  v_mov_b32 v133, v0
  v_and_b32 v134, 15, v0
  v_lshrrev_b32 v135, 4, v0
  v_lshrrev_b32 v136, 1, v135
  v_and_b32 v137, 1, v135
  v_lshlrev_b32 v138, 10, v136
  v_lshl_add_u32 v138, v137, 9, v138
  v_lshl_add_u32 v138, v134, 4, v138
  s_lshl_b32 s7, s24, 13
  v_add_u32 v128, s7, v138
  v_lshrrev_b32 v138, 2, v0
  v_and_b32 v138, 3, v138
  v_lshl_add_u32 v138, v137, 2, v138
  v_lshl_add_u32 v139, v136, 4, v138
  v_and_b32 v140, 3, v0
  v_lshlrev_b32 v140, 3, v140
  v_lshl_add_u32 v139, v139, 8, v140
  v_add_u32 v139, 16384, v139
  s_lshl_b32 s7, s25, 2
  s_add_u32 s26, s7, 0
  v_xor_b32 v140, s26, v138
  v_lshl_add_u32 v129, v140, 5, v139
  s_add_u32 s26, s7, 1
  v_xor_b32 v140, s26, v138
  v_lshl_add_u32 v130, v140, 5, v139
  s_add_u32 s26, s7, 2
  v_xor_b32 v140, s26, v138
  v_lshl_add_u32 v131, v140, 5, v139
  s_add_u32 s26, s7, 3
  v_xor_b32 v140, s26, v138
  v_lshl_add_u32 v132, v140, 5, v139
  v_mov_b32 v0, 0
  v_mov_b32 v1, 0
  v_mov_b32 v2, 0
  v_mov_b32 v3, 0
  v_mov_b32 v4, 0
  v_mov_b32 v5, 0
  v_mov_b32 v6, 0
  v_mov_b32 v7, 0
  v_mov_b32 v8, 0
  v_mov_b32 v9, 0
  v_mov_b32 v10, 0
  v_mov_b32 v11, 0
  v_mov_b32 v12, 0
  v_mov_b32 v13, 0
  v_mov_b32 v14, 0
  v_mov_b32 v15, 0
  v_mov_b32 v16, 0
  v_mov_b32 v17, 0
  v_mov_b32 v18, 0
  v_mov_b32 v19, 0
  v_mov_b32 v20, 0
  v_mov_b32 v21, 0
  v_mov_b32 v22, 0
  v_mov_b32 v23, 0
  v_mov_b32 v24, 0
  v_mov_b32 v25, 0
  v_mov_b32 v26, 0
  v_mov_b32 v27, 0
  v_mov_b32 v28, 0
  v_mov_b32 v29, 0
  v_mov_b32 v30, 0
  v_mov_b32 v31, 0
  v_mov_b32 v32, 0
  v_mov_b32 v33, 0
  v_mov_b32 v34, 0
  v_mov_b32 v35, 0
  v_mov_b32 v36, 0
  v_mov_b32 v37, 0
  v_mov_b32 v38, 0
  v_mov_b32 v39, 0
  v_mov_b32 v40, 0
  v_mov_b32 v41, 0
  v_mov_b32 v42, 0
  v_mov_b32 v43, 0
  v_mov_b32 v44, 0
  v_mov_b32 v45, 0
  v_mov_b32 v46, 0
  v_mov_b32 v47, 0
  v_mov_b32 v48, 0
  v_mov_b32 v49, 0
  v_mov_b32 v50, 0
  v_mov_b32 v51, 0
  v_mov_b32 v52, 0
  v_mov_b32 v53, 0
  v_mov_b32 v54, 0
  v_mov_b32 v55, 0
  v_mov_b32 v56, 0
  v_mov_b32 v57, 0
  v_mov_b32 v58, 0
  v_mov_b32 v59, 0
  v_mov_b32 v60, 0
  v_mov_b32 v61, 0
  v_mov_b32 v62, 0
  v_mov_b32 v63, 0
  s_mov_b32 s26, 0
  s_mov_b32 s28, 15
  s_mov_b32 s50, -98304
  s_mov_b32 s51, 32768
  s_waitcnt lgkmcnt(0)
  s_barrier
  ds_read_b128 v[64:67], v128 offset:0
  ds_read_b64_tr_b16 v[96:97], v129 offset:0
  ds_read_b64_tr_b16 v[98:99], v129 offset:2048
  ds_read_b128 v[68:71], v128 offset:256
  ds_read_b64_tr_b16 v[100:101], v130 offset:0
  ds_read_b64_tr_b16 v[102:103], v130 offset:2048
  ds_read_b128 v[72:75], v128 offset:4096
  ds_read_b64_tr_b16 v[104:105], v131 offset:0
  ds_read_b64_tr_b16 v[106:107], v131 offset:2048
  ds_read_b128 v[76:79], v128 offset:4352
  ds_read_b64_tr_b16 v[108:109], v132 offset:0
  ds_read_b64_tr_b16 v[110:111], v132 offset:2048
  .p2align 6
p3_loop:
  s_waitcnt lgkmcnt(0)
  v_mfma_f32_16x16x32_bf16 v[0:3], v[96:99], v[64:67], v[0:3]
  ds_read_b128 v[80:83], v128 offset:2048
  v_mfma_f32_16x16x32_bf16 v[4:7], v[100:103], v[64:67], v[4:7]
  ds_read_b64_tr_b16 v[112:113], v129 offset:8192
  v_mfma_f32_16x16x32_bf16 v[8:11], v[104:107], v[64:67], v[8:11]
  ds_read_b64_tr_b16 v[114:115], v129 offset:10240
  v_mfma_f32_16x16x32_bf16 v[12:15], v[108:111], v[64:67], v[12:15]
  ds_read_b128 v[84:87], v128 offset:2304
  v_mfma_f32_16x16x32_bf16 v[16:19], v[96:99], v[68:71], v[16:19]
  ds_read_b64_tr_b16 v[116:117], v130 offset:8192
  v_mfma_f32_16x16x32_bf16 v[20:23], v[100:103], v[68:71], v[20:23]
  ds_read_b64_tr_b16 v[118:119], v130 offset:10240
  v_mfma_f32_16x16x32_bf16 v[24:27], v[104:107], v[68:71], v[24:27]
  ds_read_b128 v[88:91], v128 offset:6144
  v_mfma_f32_16x16x32_bf16 v[28:31], v[108:111], v[68:71], v[28:31]
  ds_read_b64_tr_b16 v[120:121], v131 offset:8192
  v_mfma_f32_16x16x32_bf16 v[32:35], v[96:99], v[72:75], v[32:35]
  ds_read_b64_tr_b16 v[122:123], v131 offset:10240
  v_mfma_f32_16x16x32_bf16 v[36:39], v[100:103], v[72:75], v[36:39]
  ds_read_b128 v[92:95], v128 offset:6400
  v_mfma_f32_16x16x32_bf16 v[40:43], v[104:107], v[72:75], v[40:43]
  ds_read_b64_tr_b16 v[124:125], v132 offset:8192
  v_mfma_f32_16x16x32_bf16 v[44:47], v[108:111], v[72:75], v[44:47]
  ds_read_b64_tr_b16 v[126:127], v132 offset:10240
  v_mfma_f32_16x16x32_bf16 v[48:51], v[96:99], v[76:79], v[48:51]
  v_mfma_f32_16x16x32_bf16 v[52:55], v[100:103], v[76:79], v[52:55]
  s_add_u32 s26, s26, 1
  s_cmp_eq_u32 s26, 4
  v_mfma_f32_16x16x32_bf16 v[56:59], v[104:107], v[76:79], v[56:59]
  s_cselect_b32 s27, s50, s51
  s_cselect_b32 s26, 0, s26
  v_mfma_f32_16x16x32_bf16 v[60:63], v[108:111], v[76:79], v[60:63]
  s_waitcnt lgkmcnt(0)
  s_barrier
  v_mfma_f32_16x16x32_bf16 v[0:3], v[112:115], v[80:83], v[0:3]
  v_add_u32 v128, s27, v128
  v_add_u32 v129, s27, v129
  v_mfma_f32_16x16x32_bf16 v[4:7], v[116:119], v[80:83], v[4:7]
  ds_read_b128 v[64:67], v128 offset:0
  ds_read_b64_tr_b16 v[96:97], v129 offset:0
  v_mfma_f32_16x16x32_bf16 v[8:11], v[120:123], v[80:83], v[8:11]
  ds_read_b64_tr_b16 v[98:99], v129 offset:2048
  v_add_u32 v130, s27, v130
  v_mfma_f32_16x16x32_bf16 v[12:15], v[124:127], v[80:83], v[12:15]
  ds_read_b128 v[68:71], v128 offset:256
  ds_read_b64_tr_b16 v[100:101], v130 offset:0
  v_mfma_f32_16x16x32_bf16 v[16:19], v[112:115], v[84:87], v[16:19]
  ds_read_b64_tr_b16 v[102:103], v130 offset:2048
  v_add_u32 v131, s27, v131
  v_mfma_f32_16x16x32_bf16 v[20:23], v[116:119], v[84:87], v[20:23]
  ds_read_b128 v[72:75], v128 offset:4096
  ds_read_b64_tr_b16 v[104:105], v131 offset:0
  v_mfma_f32_16x16x32_bf16 v[24:27], v[120:123], v[84:87], v[24:27]
  ds_read_b64_tr_b16 v[106:107], v131 offset:2048
  v_add_u32 v132, s27, v132
  v_mfma_f32_16x16x32_bf16 v[28:31], v[124:127], v[84:87], v[28:31]
  ds_read_b128 v[76:79], v128 offset:4352
  ds_read_b64_tr_b16 v[108:109], v132 offset:0
  v_mfma_f32_16x16x32_bf16 v[32:35], v[112:115], v[88:91], v[32:35]
  ds_read_b64_tr_b16 v[110:111], v132 offset:2048
  v_mfma_f32_16x16x32_bf16 v[36:39], v[116:119], v[88:91], v[36:39]
  s_sub_u32 s28, s28, 1
  v_mfma_f32_16x16x32_bf16 v[40:43], v[120:123], v[88:91], v[40:43]
  s_cmp_lg_u32 s28, 0
  v_mfma_f32_16x16x32_bf16 v[44:47], v[124:127], v[88:91], v[44:47]
  v_mfma_f32_16x16x32_bf16 v[48:51], v[112:115], v[92:95], v[48:51]
  v_mfma_f32_16x16x32_bf16 v[52:55], v[116:119], v[92:95], v[52:55]
  v_mfma_f32_16x16x32_bf16 v[56:59], v[120:123], v[92:95], v[56:59]
  v_mfma_f32_16x16x32_bf16 v[60:63], v[124:127], v[92:95], v[60:63]
  s_cbranch_scc1 p3_loop
  s_waitcnt lgkmcnt(0)
  v_mfma_f32_16x16x32_bf16 v[0:3], v[96:99], v[64:67], v[0:3]
  ds_read_b128 v[80:83], v128 offset:2048
  v_mfma_f32_16x16x32_bf16 v[4:7], v[100:103], v[64:67], v[4:7]
  ds_read_b64_tr_b16 v[112:113], v129 offset:8192
  v_mfma_f32_16x16x32_bf16 v[8:11], v[104:107], v[64:67], v[8:11]
  ds_read_b64_tr_b16 v[114:115], v129 offset:10240
  v_mfma_f32_16x16x32_bf16 v[12:15], v[108:111], v[64:67], v[12:15]
  ds_read_b128 v[84:87], v128 offset:2304
  v_mfma_f32_16x16x32_bf16 v[16:19], v[96:99], v[68:71], v[16:19]
  ds_read_b64_tr_b16 v[116:117], v130 offset:8192
  v_mfma_f32_16x16x32_bf16 v[20:23], v[100:103], v[68:71], v[20:23]
  ds_read_b64_tr_b16 v[118:119], v130 offset:10240
  v_mfma_f32_16x16x32_bf16 v[24:27], v[104:107], v[68:71], v[24:27]
  ds_read_b128 v[88:91], v128 offset:6144
  v_mfma_f32_16x16x32_bf16 v[28:31], v[108:111], v[68:71], v[28:31]
  ds_read_b64_tr_b16 v[120:121], v131 offset:8192
  v_mfma_f32_16x16x32_bf16 v[32:35], v[96:99], v[72:75], v[32:35]
  ds_read_b64_tr_b16 v[122:123], v131 offset:10240
  v_mfma_f32_16x16x32_bf16 v[36:39], v[100:103], v[72:75], v[36:39]
  ds_read_b128 v[92:95], v128 offset:6400
  v_mfma_f32_16x16x32_bf16 v[40:43], v[104:107], v[72:75], v[40:43]
  ds_read_b64_tr_b16 v[124:125], v132 offset:8192
  v_mfma_f32_16x16x32_bf16 v[44:47], v[108:111], v[72:75], v[44:47]
  ds_read_b64_tr_b16 v[126:127], v132 offset:10240
  v_mfma_f32_16x16x32_bf16 v[48:51], v[96:99], v[76:79], v[48:51]
  v_mfma_f32_16x16x32_bf16 v[52:55], v[100:103], v[76:79], v[52:55]
  v_mfma_f32_16x16x32_bf16 v[56:59], v[104:107], v[76:79], v[56:59]
  v_mfma_f32_16x16x32_bf16 v[60:63], v[108:111], v[76:79], v[60:63]
  s_waitcnt lgkmcnt(0)
  v_mfma_f32_16x16x32_bf16 v[0:3], v[112:115], v[80:83], v[0:3]
  v_mfma_f32_16x16x32_bf16 v[4:7], v[116:119], v[80:83], v[4:7]
  v_mfma_f32_16x16x32_bf16 v[8:11], v[120:123], v[80:83], v[8:11]
  v_mfma_f32_16x16x32_bf16 v[12:15], v[124:127], v[80:83], v[12:15]
  v_mfma_f32_16x16x32_bf16 v[16:19], v[112:115], v[84:87], v[16:19]
  v_mfma_f32_16x16x32_bf16 v[20:23], v[116:119], v[84:87], v[20:23]
  v_mfma_f32_16x16x32_bf16 v[24:27], v[120:123], v[84:87], v[24:27]
  v_mfma_f32_16x16x32_bf16 v[28:31], v[124:127], v[84:87], v[28:31]
  v_mfma_f32_16x16x32_bf16 v[32:35], v[112:115], v[88:91], v[32:35]
  v_mfma_f32_16x16x32_bf16 v[36:39], v[116:119], v[88:91], v[36:39]
  v_mfma_f32_16x16x32_bf16 v[40:43], v[120:123], v[88:91], v[40:43]
  v_mfma_f32_16x16x32_bf16 v[44:47], v[124:127], v[88:91], v[44:47]
  v_mfma_f32_16x16x32_bf16 v[48:51], v[112:115], v[92:95], v[48:51]
  v_mfma_f32_16x16x32_bf16 v[52:55], v[116:119], v[92:95], v[52:55]
  v_mfma_f32_16x16x32_bf16 v[56:59], v[120:123], v[92:95], v[56:59]
  v_mfma_f32_16x16x32_bf16 v[60:63], v[124:127], v[92:95], v[60:63]
  v_and_b32 v134, 15, v133
  v_lshrrev_b32 v135, 4, v133
  v_and_b32 v136, 7, v133
  v_lshrrev_b32 v138, 1, v135
  v_xor_b32 v136, v136, v138
  v_and_b32 v135, 1, v135
  v_lshlrev_b32 v137, 7, v134
  v_lshl_add_u32 v137, v135, 3, v137
  s_lshl_b32 s7, s3, 13
  v_add_u32 v137, s7, v137
  v_xor_b32 v138, 0, v136
  v_lshl_add_u32 v142, v138, 4, v137
  v_xor_b32 v138, 2, v136
  v_lshl_add_u32 v143, v138, 4, v137
  v_xor_b32 v138, 4, v136
  v_lshl_add_u32 v144, v138, 4, v137
  v_xor_b32 v138, 6, v136
  v_lshl_add_u32 v145, v138, 4, v137
  v_cvt_pk_bf16_f32 v0, v0, v1
  v_cvt_pk_bf16_f32 v1, v2, v3
  ds_write_b64 v142, v[0:1] offset:0
  v_cvt_pk_bf16_f32 v4, v4, v5
  v_cvt_pk_bf16_f32 v5, v6, v7
  ds_write_b64 v143, v[4:5] offset:0
  v_cvt_pk_bf16_f32 v8, v8, v9
  v_cvt_pk_bf16_f32 v9, v10, v11
  ds_write_b64 v144, v[8:9] offset:0
  v_cvt_pk_bf16_f32 v12, v12, v13
  v_cvt_pk_bf16_f32 v13, v14, v15
  ds_write_b64 v145, v[12:13] offset:0
  v_cvt_pk_bf16_f32 v16, v16, v17
  v_cvt_pk_bf16_f32 v17, v18, v19
  ds_write_b64 v142, v[16:17] offset:2048
  v_cvt_pk_bf16_f32 v20, v20, v21
  v_cvt_pk_bf16_f32 v21, v22, v23
  ds_write_b64 v143, v[20:21] offset:2048
  v_cvt_pk_bf16_f32 v24, v24, v25
  v_cvt_pk_bf16_f32 v25, v26, v27
  ds_write_b64 v144, v[24:25] offset:2048
  v_cvt_pk_bf16_f32 v28, v28, v29
  v_cvt_pk_bf16_f32 v29, v30, v31
  ds_write_b64 v145, v[28:29] offset:2048
  v_cvt_pk_bf16_f32 v32, v32, v33
  v_cvt_pk_bf16_f32 v33, v34, v35
  ds_write_b64 v142, v[32:33] offset:4096
  v_cvt_pk_bf16_f32 v36, v36, v37
  v_cvt_pk_bf16_f32 v37, v38, v39
  ds_write_b64 v143, v[36:37] offset:4096
  v_cvt_pk_bf16_f32 v40, v40, v41
  v_cvt_pk_bf16_f32 v41, v42, v43
  ds_write_b64 v144, v[40:41] offset:4096
  v_cvt_pk_bf16_f32 v44, v44, v45
  v_cvt_pk_bf16_f32 v45, v46, v47
  ds_write_b64 v145, v[44:45] offset:4096
  v_cvt_pk_bf16_f32 v48, v48, v49
  v_cvt_pk_bf16_f32 v49, v50, v51
  ds_write_b64 v142, v[48:49] offset:6144
  v_cvt_pk_bf16_f32 v52, v52, v53
  v_cvt_pk_bf16_f32 v53, v54, v55
  ds_write_b64 v143, v[52:53] offset:6144
  v_cvt_pk_bf16_f32 v56, v56, v57
  v_cvt_pk_bf16_f32 v57, v58, v59
  ds_write_b64 v144, v[56:57] offset:6144
  v_cvt_pk_bf16_f32 v60, v60, v61
  v_cvt_pk_bf16_f32 v61, v62, v63
  ds_write_b64 v145, v[60:61] offset:6144
  v_lshrrev_b32 v134, 3, v133
  v_and_b32 v135, 7, v133
  v_xor_b32 v136, v134, v135
  v_and_b32 v136, 7, v136
  v_lshlrev_b32 v136, 4, v136
  v_lshl_add_u32 v136, v134, 7, v136
  s_lshl_b32 s7, s3, 13
  v_add_u32 v136, s7, v136
  v_lshlrev_b32 v137, 12, v134
  v_lshl_add_u32 v137, v135, 4, v137
  s_lshl_b32 s7, s5, 7
  s_lshl_b32 s26, s24, 6
  s_add_u32 s7, s7, s26
  s_lshl_b32 s7, s7, 12
  s_lshl_b32 s26, s4, 11
  s_add_u32 s7, s7, s26
  s_lshl_b32 s26, s6, 8
  s_add_u32 s7, s7, s26
  s_lshl_b32 s26, s25, 7
  s_add_u32 s7, s7, s26
  s_waitcnt lgkmcnt(0)
  ds_read_b128 v[0:3], v136 offset:0
  ds_read_b128 v[4:7], v136 offset:1024
  ds_read_b128 v[8:11], v136 offset:2048
  ds_read_b128 v[12:15], v136 offset:3072
  ds_read_b128 v[16:19], v136 offset:4096
  ds_read_b128 v[20:23], v136 offset:5120
  ds_read_b128 v[24:27], v136 offset:6144
  ds_read_b128 v[28:31], v136 offset:7168
  s_waitcnt lgkmcnt(7)
  buffer_store_dwordx4 v[0:3], v137, s[20:23], s7 offen sc1
  s_add_u32 s7, s7, 32768
  s_waitcnt lgkmcnt(6)
  buffer_store_dwordx4 v[4:7], v137, s[20:23], s7 offen sc1
  s_add_u32 s7, s7, 32768
  s_waitcnt lgkmcnt(5)
  buffer_store_dwordx4 v[8:11], v137, s[20:23], s7 offen sc1
  s_add_u32 s7, s7, 32768
  s_waitcnt lgkmcnt(4)
  buffer_store_dwordx4 v[12:15], v137, s[20:23], s7 offen sc1
  s_add_u32 s7, s7, 32768
  s_waitcnt lgkmcnt(3)
  buffer_store_dwordx4 v[16:19], v137, s[20:23], s7 offen sc1
  s_add_u32 s7, s7, 32768
  s_waitcnt lgkmcnt(2)
  buffer_store_dwordx4 v[20:23], v137, s[20:23], s7 offen sc1
  s_add_u32 s7, s7, 32768
  s_waitcnt lgkmcnt(1)
  buffer_store_dwordx4 v[24:27], v137, s[20:23], s7 offen sc1
  s_add_u32 s7, s7, 32768
  s_waitcnt lgkmcnt(0)
  buffer_store_dwordx4 v[28:31], v137, s[20:23], s7 offen sc1
  s_endpgm
p3_loader:
  s_sub_u32 s24, s3, 4
  v_lshlrev_b32 v1, 4, v0
  s_lshl_b32 s7, s5, 2
  s_add_u32 s7, s7, s24
  s_lshl_b32 s7, s7, 16
  s_cmp_eq_u32 s4, 1
  s_mov_b32 s26, 20971520
  s_cselect_b32 s26, 25165824, s26
  s_add_u32 s7, s7, s26
  v_add_u32 v1, s7, v1
  v_lshrrev_b32 v5, 4, v0
  s_and_b32 s7, s24, 1
  s_lshl_b32 s7, s7, 2
  v_add_u32 v4, s7, v5
  v_lshlrev_b32 v4, 1, v4
  v_and_b32 v6, 15, v0
  v_xor_b32 v4, v4, v6
  v_lshlrev_b32 v4, 4, v4
  s_lshl_b32 s7, s24, 2
  v_add_u32 v5, s7, v5
  v_lshl_add_u32 v2, v5, 11, v4
  s_lshl_b32 s7, s6, 8
  v_add_u32 v2, s7, v2
  s_lshl_b32 s40, s24, 12
  s_lshl_b32 s39, s24, 10
  s_mov_b32 s42, 0
  s_mov_b32 s41, 0
  s_waitcnt lgkmcnt(0)
  s_lshl_b32 s43, s41, 12
  s_lshl_b32 s44, s41, 17
  s_add_u32 s46, s42, s39
  s_add_u32 m0, s42, s40
  s_nop 0
  buffer_load_dwordx4 v1, s[8:11], s43 offen offset:0 lds
  buffer_load_dwordx4 v1, s[8:11], s43 offen offset:1024 lds
  buffer_load_dwordx4 v1, s[8:11], s43 offen offset:2048 lds
  buffer_load_dwordx4 v1, s[8:11], s43 offen offset:3072 lds
  s_add_u32 m0, s46, 16384
  s_add_u32 s45, s44, 0
  buffer_load_dwordx4 v2, s[12:15], s45 offen lds
  s_add_u32 m0, s46, 20480
  s_add_u32 s45, s44, 32768
  buffer_load_dwordx4 v2, s[12:15], s45 offen lds
  s_add_u32 m0, s46, 24576
  s_add_u32 s45, s44, 65536
  buffer_load_dwordx4 v2, s[12:15], s45 offen lds
  s_add_u32 m0, s46, 28672
  s_add_u32 s45, s44, 98304
  buffer_load_dwordx4 v2, s[12:15], s45 offen lds
  s_add_u32 s41, s41, 1
  s_and_b32 s41, s41, 15
  s_add_u32 s42, s42, 32768
  s_cmp_ge_u32 s42, 131072
  s_cselect_b32 s42, 0, s42
  s_lshl_b32 s43, s41, 12
  s_lshl_b32 s44, s41, 17
  s_add_u32 s46, s42, s39
  s_add_u32 m0, s42, s40
  s_nop 0
  buffer_load_dwordx4 v1, s[8:11], s43 offen offset:0 lds
  buffer_load_dwordx4 v1, s[8:11], s43 offen offset:1024 lds
  buffer_load_dwordx4 v1, s[8:11], s43 offen offset:2048 lds
  buffer_load_dwordx4 v1, s[8:11], s43 offen offset:3072 lds
  s_add_u32 m0, s46, 16384
  s_add_u32 s45, s44, 0
  buffer_load_dwordx4 v2, s[12:15], s45 offen lds
  s_add_u32 m0, s46, 20480
  s_add_u32 s45, s44, 32768
  buffer_load_dwordx4 v2, s[12:15], s45 offen lds
  s_add_u32 m0, s46, 24576
  s_add_u32 s45, s44, 65536
  buffer_load_dwordx4 v2, s[12:15], s45 offen lds
  s_add_u32 m0, s46, 28672
  s_add_u32 s45, s44, 98304
  buffer_load_dwordx4 v2, s[12:15], s45 offen lds
  s_add_u32 s41, s41, 1
  s_and_b32 s41, s41, 15
  s_add_u32 s42, s42, 32768
  s_cmp_ge_u32 s42, 131072
  s_cselect_b32 s42, 0, s42
  s_lshl_b32 s43, s41, 12
  s_lshl_b32 s44, s41, 17
  s_add_u32 s46, s42, s39
  s_add_u32 m0, s42, s40
  s_nop 0
  buffer_load_dwordx4 v1, s[8:11], s43 offen offset:0 lds
  buffer_load_dwordx4 v1, s[8:11], s43 offen offset:1024 lds
  buffer_load_dwordx4 v1, s[8:11], s43 offen offset:2048 lds
  buffer_load_dwordx4 v1, s[8:11], s43 offen offset:3072 lds
  s_add_u32 m0, s46, 16384
  s_add_u32 s45, s44, 0
  buffer_load_dwordx4 v2, s[12:15], s45 offen lds
  s_add_u32 m0, s46, 20480
  s_add_u32 s45, s44, 32768
  buffer_load_dwordx4 v2, s[12:15], s45 offen lds
  s_add_u32 m0, s46, 24576
  s_add_u32 s45, s44, 65536
  buffer_load_dwordx4 v2, s[12:15], s45 offen lds
  s_add_u32 m0, s46, 28672
  s_add_u32 s45, s44, 98304
  buffer_load_dwordx4 v2, s[12:15], s45 offen lds
  s_add_u32 s41, s41, 1
  s_and_b32 s41, s41, 15
  s_add_u32 s42, s42, 32768
  s_cmp_ge_u32 s42, 131072
  s_cselect_b32 s42, 0, s42
  s_mov_b32 s47, 13
p3_ld:
  s_waitcnt vmcnt(16)
  s_barrier
  s_lshl_b32 s43, s41, 12
  s_lshl_b32 s44, s41, 17
  s_add_u32 s46, s42, s39
  s_add_u32 m0, s42, s40
  s_nop 0
  buffer_load_dwordx4 v1, s[8:11], s43 offen offset:0 lds
  buffer_load_dwordx4 v1, s[8:11], s43 offen offset:1024 lds
  buffer_load_dwordx4 v1, s[8:11], s43 offen offset:2048 lds
  buffer_load_dwordx4 v1, s[8:11], s43 offen offset:3072 lds
  s_add_u32 m0, s46, 16384
  s_add_u32 s45, s44, 0
  buffer_load_dwordx4 v2, s[12:15], s45 offen lds
  s_add_u32 m0, s46, 20480
  s_add_u32 s45, s44, 32768
  buffer_load_dwordx4 v2, s[12:15], s45 offen lds
  s_add_u32 m0, s46, 24576
  s_add_u32 s45, s44, 65536
  buffer_load_dwordx4 v2, s[12:15], s45 offen lds
  s_add_u32 m0, s46, 28672
  s_add_u32 s45, s44, 98304
  buffer_load_dwordx4 v2, s[12:15], s45 offen lds
  s_add_u32 s41, s41, 1
  s_and_b32 s41, s41, 15
  s_add_u32 s42, s42, 32768
  s_cmp_ge_u32 s42, 131072
  s_cselect_b32 s42, 0, s42
  s_sub_u32 s47, s47, 1
  s_cmp_lg_u32 s47, 0
  s_cbranch_scc1 p3_ld
  s_waitcnt vmcnt(16)
  s_barrier
  s_waitcnt vmcnt(8)
  s_barrier
  s_waitcnt vmcnt(0)
  s_barrier
  s_endpgm
p3_exit:
  s_endpgm
.section .rodata,"a"
.p2align 6
.amdhsa_kernel p1_kernel
  .amdhsa_next_free_vgpr 256
  .amdhsa_next_free_sgpr 102
  .amdhsa_accum_offset 256
  .amdhsa_group_segment_fixed_size 0
  .amdhsa_kernarg_size 88
  .amdhsa_user_sgpr_count 2
  .amdhsa_user_sgpr_kernarg_segment_ptr 1
  .amdhsa_system_sgpr_workgroup_id_x 1
.end_amdhsa_kernel
.p2align 6
.amdhsa_kernel p2_kernel
  .amdhsa_next_free_vgpr 256
  .amdhsa_next_free_sgpr 102
  .amdhsa_accum_offset 256
  .amdhsa_group_segment_fixed_size 0
  .amdhsa_kernarg_size 88
  .amdhsa_user_sgpr_count 2
  .amdhsa_user_sgpr_kernarg_segment_ptr 1
  .amdhsa_system_sgpr_workgroup_id_x 1
.end_amdhsa_kernel
.p2align 6
.amdhsa_kernel concat_heads__sliding_block__grouped_kv_mqa__prompt_kernel
  .amdhsa_next_free_vgpr 160
  .amdhsa_next_free_sgpr 102
  .amdhsa_accum_offset 160
  .amdhsa_group_segment_fixed_size 0
  .amdhsa_kernarg_size 88
  .amdhsa_user_sgpr_count 2
  .amdhsa_user_sgpr_kernarg_segment_ptr 1
  .amdhsa_system_sgpr_workgroup_id_x 1
.end_amdhsa_kernel
```
